```python
import torch

def _softmax(x, axis=-1):
    return torch.softmax(x, dim=axis)
def _gelu(x):
    return torch.nn.functional.gelu(x, approximate="tanh")
def _silu(x):
    return torch.nn.functional.silu(x)
def _sigmoid(x):
    return torch.sigmoid(x)
def _layernorm(x, axis=-1, eps=1e-5):
    m = x.mean(dim=axis, keepdim=True)
    v = x.var(dim=axis, keepdim=True, unbiased=False)
    return (x - m) / torch.sqrt(v + eps)
def _scatter_add(tgt, idx, src, axis=0):
    return tgt.clone().index_add_(axis, idx, src)
def _segment_sum(src, seg, n):
    out = torch.zeros((n,) + src.shape[1:], dtype=src.dtype)
    return out.index_add_(0, seg, src)
def _pad(x, pw):
    flat = tuple(v for pair in reversed(pw) for v in pair)
    return torch.nn.functional.pad(x, flat)

kernel_name = 'parallel_sum__spectral_fnet__moe_arch_mod__prompt'

def setup_inputs():

    _w = (lambda a: (lambda t: t.to(torch.bfloat16) if t.is_floating_point() else t)(torch.as_tensor(a)))
    def _A_setup():
        B, S, D = 1, 2048, 512
        ns = torch.arange(S)[:, None] * torch.arange(S)[None, :]
        nd = torch.arange(D)[:, None] * torch.arange(D)[None, :]
        Ws_re = torch.cos(-2.0 * torch.pi * ns / S).to(float)
        Ws_im = torch.sin(-2.0 * torch.pi * ns / S).to(float)
        Wd_re = torch.cos(-2.0 * torch.pi * nd / D).to(float)
        Wd_im = torch.sin(-2.0 * torch.pi * nd / D).to(float)
        return {
            "x": _w((lambda *s: torch.randn(*s, dtype=torch.bfloat16) * 0.1)(B, S, D)),
            "dft_seq_re": _w(Ws_re),
            "dft_seq_im": _w(Ws_im),
            "dft_hid_re": _w(Wd_re),
            "dft_hid_im": _w(Wd_im),
        }
    _A_in = _A_setup()

    def _B_setup():
        B, S, D, F, C = 1, 2048, 512, 1792, 8
        return {
            "x": _w((lambda *s: torch.randn(*s, dtype=torch.bfloat16) * 0.1)(B, S, D)),
            "w_r": _w((lambda *s: torch.randn(*s, dtype=torch.bfloat16) * 0.4)(D)),
            "w_gate": _w((lambda *s: torch.randn(*s, dtype=torch.bfloat16) * 0.4)(D, F)),
            "w_up": _w((lambda *s: torch.randn(*s, dtype=torch.bfloat16) * 0.4)(D, F)),
            "w_down": _w((lambda *s: torch.randn(*s, dtype=torch.bfloat16) * 0.4)(F, D)),
        }
    _B_in = _B_setup()

    return {
        "A_x": _A_in["x"],
        "A_dft_seq_re": _A_in["dft_seq_re"],
        "A_dft_seq_im": _A_in["dft_seq_im"],
        "A_dft_hid_re": _A_in["dft_hid_re"],
        "A_dft_hid_im": _A_in["dft_hid_im"],
        "B_x": _B_in["x"],
        "B_w_r": _B_in["w_r"],
        "B_w_gate": _B_in["w_gate"],
        "B_w_up": _B_in["w_up"],
        "B_w_down": _B_in["w_down"],
    }

def reference(A_x, A_dft_seq_re, A_dft_seq_im, A_dft_hid_re, A_dft_hid_im, B_x, B_w_r, B_w_gate, B_w_up, B_w_down):
    def _A_ref(x, dft_seq_re, dft_seq_im, dft_hid_re, dft_hid_im):
        a = torch.einsum("bsd,ed->bse", x, dft_hid_re)
        b = torch.einsum("bsd,ed->bse", x, dft_hid_im)
        y = torch.einsum("ts,bse->bte", dft_seq_re, a) - torch.einsum("ts,bse->bte", dft_seq_im, b)
        return y

    def _B_ref(x, w_r, w_gate, w_up, w_down):
        B, S, D = x.shape
        C = 8
        r = x @ w_r
        idx = torch.argsort(-r, axis=-1)[:, :C]
        idx_e = (lambda x, n, axis: torch.repeat_interleave(x, n, dim=axis))(idx.reshape(B, C, 1), D, axis=2)
        x_sel = (lambda x, i, axis: torch.take_along_dim(x, i, dim=axis))(x, idx_e, axis=1)
        g = _silu(x_sel @ w_gate)
        u = x_sel @ w_up
        y = (g * u) @ w_down
        r_sel = _sigmoid((lambda x, i, axis: torch.take_along_dim(x, i, dim=axis))(r, idx, axis=1))
        y = y * r_sel.reshape(B, C, 1)
        b_off = (torch.arange(B) * S).reshape(B, 1)
        flat_idx = (idx + b_off).reshape(B * C)
        zero = (x * 0.0).reshape(B * S, D)
        upd = _scatter_add(zero, flat_idx, y.reshape(B * C, D), axis=0)
        return x + upd.reshape(B, S, D)

    x = A_x
    xn = _layernorm(x, axis=-1)
    return x + _A_ref(xn, A_dft_seq_re, A_dft_seq_im, A_dft_hid_re, A_dft_hid_im) + _B_ref(xn, B_w_r, B_w_gate, B_w_up, B_w_down)
```

```asm
; @launch grid=(256,1,1) block=(1024,1,1) lds=108032
.amdgcn_target "amdgcn-amd-amdhsa--gfx950"
.text
.globl parallel_sum__spectral_fnet__moe_arch_mod__prompt_kernel
.p2align 8
.type parallel_sum__spectral_fnet__moe_arch_mod__prompt_kernel,@function
parallel_sum__spectral_fnet__moe_arch_mod__prompt_kernel:
    s_cmp_lt_u32 s2, 128
    s_cbranch_scc1 L_row
    s_cmp_lt_u32 s2, 184
    s_cbranch_scc1 L_moe
    s_cmp_eq_u32 s2, 184
    s_cbranch_scc1 L_ag
    s_sub_u32 s3, s2, 192
    s_cmp_lt_u32 s3, 64
    s_cbranch_scc1 L_pf
L_exit:
    s_endpgm
L_row:
    s_load_dwordx2 s[4:5], s[0:1], 0
    s_load_dwordx2 s[8:9], s[0:1], 48
    v_lshrrev_b32 v3, 6, v0
    v_and_b32 v1, 63, v0
    s_getpc_b64 s[16:17]
L_f_pc:
    v_readfirstlane_b32 s24, v3
    s_mov_b32 s18, 0x20000
    s_mov_b32 s19, 0x20000
    v_lshlrev_b32 v2, 4, v1
    s_lshl_b32 s26, s24, 10
    s_cmp_gt_u32 s24, 8
    s_cbranch_scc1 L_f_cp
    s_add_u32 s27, s26, 35072
    s_mov_b32 m0, s27
    s_add_u32 s27, s26, T_fft-L_f_pc
    buffer_load_dwordx4 v2, s[16:19], s27 offen lds
    s_branch L_f_cpj
L_f_cp:
    s_cmp_lg_u32 s24, 15
    s_cbranch_scc1 L_f_cpj
    v_lshlrev_b32 v4, 7, v1
    buffer_load_dword v6, v4, s[16:19], 0 offen
L_f_cpj:
    s_and_b32 s28, s2, 7
    s_lshr_b32 s27, s2, 3
    s_lshl4_add_u32 s25, s28, s27
    s_mov_b32 s10, 1024
    s_mov_b32 s11, 0x20000
    s_mov_b32 s6, 0x200000
    s_mov_b32 s7, 0x20000
    s_lshl_b32 s26, s26, 7
    s_lshl_b32 s27, s25, 10
    s_add_u32 s26, s26, s27
    s_waitcnt lgkmcnt(0)
    buffer_load_dwordx4 v[12:15], v2, s[8:11], 0 offen
    buffer_load_dwordx4 v[8:11], v2, s[4:7], s26 offen
    s_load_dwordx2 s[12:13], s[0:1], 96
    s_load_dwordx2 s[20:21], s[0:1], 80
    s_waitcnt lgkmcnt(0)
    s_add_u32 s34, s12, 0x250000
    s_addc_u32 s35, s13, 0
    s_load_dword s32, s[34:35], 0
    s_mov_b32 s14, 0x1000000
    s_mov_b32 s15, 0x20000
    s_cmp_lg_u32 s24, 14
    s_cbranch_scc1 L_f_ntl
    v_mov_b32 v3, 0x250000
    buffer_load_dword v6, v3, s[12:15], 0 offen
    s_waitcnt vmcnt(2)
L_f_ntl:
    s_mov_b32 s29, 0x3f803f80
    s_mov_b32 s30, 0x00003f80
    s_mov_b32 s31, 0x3f800000
    s_mov_b32 s45, 0x00030003
    s_lshl2_add_u32 s26, s24, 34816
    v_mov_b32 v7, s26
    s_lshl3_add_u32 s26, s24, 34944
    v_mov_b32 v16, s26
    s_lshl_b32 s42, s25, 8
    s_add_u32 s42, s42, 0x242000
    v_lshlrev_b32 v17, 3, v1
    s_and_b32 s46, s2, 15
    s_lshr_b32 s47, s2, 4
    s_waitcnt lgkmcnt(0)
    s_add_u32 s32, s32, 1
    v_mov_b32 v35, s32
    s_mov_b32 s43, 0xffff
    s_mov_b32 s48, 0x80000000
    s_and_b32 s44, s32, 3
    s_mul_i32 s44, s44, 0x10001
    s_waitcnt vmcnt(1)
    v_dot2_f32_bf16 v31, v12, s29, 0
    v_dot2_f32_bf16 v31, v13, s29, v31
    v_dot2_f32_bf16 v31, v14, s29, v31
    v_dot2_f32_bf16 v31, v15, s29, v31
    s_nop 2
    v_add_f32_dpp v31, v31, v31 row_ror:8 row_mask:0xf bank_mask:0xf
    s_nop 1
    v_add_f32_dpp v31, v31, v31 row_ror:4 row_mask:0xf bank_mask:0xf
    s_nop 1
    v_add_f32_dpp v31, v31, v31 row_ror:2 row_mask:0xf bank_mask:0xf
    s_nop 1
    v_add_f32_dpp v31, v31, v31 row_ror:1 row_mask:0xf bank_mask:0xf
    s_nop 1
    v_add_f32_dpp v31, v31, v31 row_bcast:15 row_mask:0xa bank_mask:0xf
    s_nop 1
    v_add_f32_dpp v31, v31, v31 row_bcast:31 row_mask:0xc bank_mask:0xf
    s_waitcnt vmcnt(0)
    v_readfirstlane_b32 s26, v8
    v_dot2_f32_bf16 v30, v8, v12, 0
    s_lshl_b32 s26, s26, 16
    s_xor_b32 s26, s26, 0x80000000
    v_mov_b32 v32, s26
    v_dot2_f32_bf16 v30, v9, v13, v30
    v_dot2_f32_bf16 v30, v10, v14, v30
    v_dot2_f32_bf16 v30, v11, v15, v30
    v_dot2_f32_bf16 v18, v8, s30, v32
    v_dot2_f32_bf16 v19, v8, s31, v32
    v_dot2_f32_bf16 v20, v9, s30, v32
    v_dot2_f32_bf16 v21, v9, s31, v32
    v_dot2_f32_bf16 v22, v10, s30, v32
    v_dot2_f32_bf16 v23, v10, s31, v32
    v_dot2_f32_bf16 v24, v11, s30, v32
    v_dot2_f32_bf16 v25, v11, s31, v32
    v_pk_add_f32 v[26:27], v[18:19], v[20:21]
    v_pk_mul_f32 v[28:29], v[18:19], v[18:19]
    v_pk_fma_f32 v[28:29], v[20:21], v[20:21], v[28:29]
    v_pk_add_f32 v[26:27], v[26:27], v[22:23]
    v_pk_fma_f32 v[28:29], v[22:23], v[22:23], v[28:29]
    v_pk_add_f32 v[26:27], v[26:27], v[24:25]
    v_pk_fma_f32 v[28:29], v[24:25], v[24:25], v[28:29]
    v_add_f32 v26, v26, v27
    v_add_f32 v28, v28, v29
    v_add_f32_dpp v30, v30, v30 row_ror:8 row_mask:0xf bank_mask:0xf
    v_add_f32_dpp v26, v26, v26 row_ror:8 row_mask:0xf bank_mask:0xf
    v_add_f32_dpp v28, v28, v28 row_ror:8 row_mask:0xf bank_mask:0xf
    v_add_f32_dpp v30, v30, v30 row_ror:4 row_mask:0xf bank_mask:0xf
    v_add_f32_dpp v26, v26, v26 row_ror:4 row_mask:0xf bank_mask:0xf
    v_add_f32_dpp v28, v28, v28 row_ror:4 row_mask:0xf bank_mask:0xf
    v_add_f32_dpp v30, v30, v30 row_ror:2 row_mask:0xf bank_mask:0xf
    v_add_f32_dpp v26, v26, v26 row_ror:2 row_mask:0xf bank_mask:0xf
    v_add_f32_dpp v28, v28, v28 row_ror:2 row_mask:0xf bank_mask:0xf
    v_add_f32_dpp v30, v30, v30 row_ror:1 row_mask:0xf bank_mask:0xf
    v_add_f32_dpp v26, v26, v26 row_ror:1 row_mask:0xf bank_mask:0xf
    v_add_f32_dpp v28, v28, v28 row_ror:1 row_mask:0xf bank_mask:0xf
    v_add_f32_dpp v30, v30, v30 row_bcast:15 row_mask:0xa bank_mask:0xf
    v_add_f32_dpp v26, v26, v26 row_bcast:15 row_mask:0xa bank_mask:0xf
    v_add_f32_dpp v28, v28, v28 row_bcast:15 row_mask:0xa bank_mask:0xf
    v_add_f32_dpp v30, v30, v30 row_bcast:31 row_mask:0xc bank_mask:0xf
    v_add_f32_dpp v26, v26, v26 row_bcast:31 row_mask:0xc bank_mask:0xf
    v_add_f32_dpp v28, v28, v28 row_bcast:31 row_mask:0xc bank_mask:0xf
    v_mul_f32 v26, 0x3b000000, v26
    v_mul_f32 v28, 0x3b000000, v28
    v_sub_f32 v27, v26, v32
    v_fma_f32 v28, -v26, v26, v28
    v_cvt_pk_bf16_f32 v27, v28, v27
    v_lshlrev_b32 v28, 16, v27
    v_and_b32 v27, 0xffff0000, v27
    v_add_f32 v28, 0x3727c5ac, v28
    v_fma_f32 v30, -v27, v31, v30
    v_cvt_pk_bf16_f32 v28, v28, v28
    v_and_b32 v28, 0xffff0000, v28
    v_sqrt_f32 v28, v28
    s_mov_b32 exec_lo, 0
    s_mov_b32 exec_hi, 0x80000000
    v_cvt_pk_bf16_f32 v34, v28, v27
    v_lshlrev_b32 v28, 16, v34
    v_rcp_f32 v28, v28
    ds_write_b64 v16, v[34:35]
    v_mul_f32 v30, v30, v28
    v_cvt_pk_bf16_f32 v30, v30, v30
    v_ashrrev_i32 v31, 31, v30
    v_bitop3_b32 v30, v30, v31, s48 bitop3:0x1e
    v_bfi_b32 v30, s43, v35, v30
    ds_write_b32 v7, v30
    s_mov_b64 exec, -1
    v_readlane_b32 s40, v27, 63
    v_readlane_b32 s41, v28, 63
    s_waitcnt lgkmcnt(0)
    s_barrier
    s_cmp_lg_u32 s24, 0
    s_cbranch_scc1 L_f_nokey
    ds_read_b64 v[36:37], v17 offset:34816
    s_mov_b32 exec_lo, -1
    s_mov_b32 exec_hi, 0
    s_waitcnt lgkmcnt(0)
    buffer_store_dwordx2 v[36:37], v17, s[12:15], s42 offen sc1
    s_mov_b64 exec, -1
L_f_nokey:
    ds_read_b128 v[40:43], v2 offset:35072
    ds_read_b128 v[44:47], v2 offset:36096
    ds_read_b128 v[48:51], v2 offset:37120
    ds_read_b128 v[52:55], v2 offset:38144
    s_lshl_b32 s26, s24, 10
    s_cmp_lt_u32 s24, 12
    s_cbranch_scc1 L_f_nt2
    s_add_u32 s27, s26, 32000
    s_mov_b32 m0, s27
    s_mul_i32 s28, s46, 3072
    s_cmp_eq_u32 s24, 12
    s_cselect_b32 s28, 0, s28
    s_add_u32 s27, s26, T_fft-L_f_pc-3072
    s_add_u32 s27, s27, s28
    buffer_load_dwordx4 v2, s[16:19], s27 offen lds
L_f_nt2:
    v_add_u32 v7, s26, v2
    v_add_u32 v12, s26, v17
    v_sub_f32_e64 v26, -v32, s40
    v_mov_b32 v28, s41
    v_pk_add_f32 v[18:19], v[18:19], v[26:27] op_sel_hi:[1,0]
    v_pk_add_f32 v[20:21], v[20:21], v[26:27] op_sel_hi:[1,0]
    v_pk_add_f32 v[22:23], v[22:23], v[26:27] op_sel_hi:[1,0]
    v_pk_add_f32 v[24:25], v[24:25], v[26:27] op_sel_hi:[1,0]
    v_cvt_pk_bf16_f32 v68, v18, v19
    v_cvt_pk_bf16_f32 v69, v20, v21
    v_cvt_pk_bf16_f32 v70, v22, v23
    v_cvt_pk_bf16_f32 v71, v24, v25
    v_lshlrev_b32 v18, 16, v68
    v_and_b32 v19, 0xffff0000, v68
    v_lshlrev_b32 v20, 16, v69
    v_and_b32 v21, 0xffff0000, v69
    v_lshlrev_b32 v22, 16, v70
    v_and_b32 v23, 0xffff0000, v70
    v_lshlrev_b32 v24, 16, v71
    v_and_b32 v25, 0xffff0000, v71
    v_pk_mul_f32 v[18:19], v[18:19], v[28:29] op_sel_hi:[1,0]
    v_pk_mul_f32 v[20:21], v[20:21], v[28:29] op_sel_hi:[1,0]
    v_pk_mul_f32 v[22:23], v[22:23], v[28:29] op_sel_hi:[1,0]
    v_pk_mul_f32 v[24:25], v[24:25], v[28:29] op_sel_hi:[1,0]
    v_cvt_pk_bf16_f32 v68, v18, v19
    v_cvt_pk_bf16_f32 v69, v20, v21
    v_cvt_pk_bf16_f32 v70, v22, v23
    v_cvt_pk_bf16_f32 v71, v24, v25
    ds_write_b128 v7, v[68:71]
    ds_read_b64_tr_b16 v[72:73], v12
    ds_read_b64_tr_b16 v[74:75], v12 offset:512
    s_and_b32 s26, s24, 1
    s_lshl_b32 s26, s26, 10
    v_add_u32 v3, s26, v2
    ds_read_b128 v[56:59], v2 offset:39168
    ds_read_b128 v[64:67], v2 offset:41216
    ds_read_b128 v[60:63], v2 offset:40192
    ds_read_b128 v[8:11], v3 offset:42240
    v_and_b32 v7, 15, v1
    v_lshrrev_b32 v12, 4, v1
    v_and_b32 v13, 7, v1
    v_bfe_u32 v14, v1, 3, 1
    v_cmp_gt_u32 vcc, 8, v7
    v_mov_b32 v3, 0xbc003c00
    v_mov_b32 v22, 0
    v_mov_b32 v23, 0
    v_cndmask_b32 v20, 0, v3, vcc
    v_cndmask_b32 v21, 0, v3, vcc
    s_waitcnt lgkmcnt(4)
    v_mfma_f32_16x16x32_bf16 v[24:27], v[72:75], v[40:43], 0
    v_mfma_f32_16x16x32_bf16 v[32:35], v[72:75], v[44:47], 0
    v_mfma_f32_16x16x32_bf16 v[28:31], v[72:75], v[48:51], 0
    v_mfma_f32_16x16x32_bf16 v[76:79], v[72:75], v[52:55], 0
    v_lshrrev_b32 v3, 1, v13
    v_xor_b32 v3, v3, v12
    v_lshlrev_b32 v3, 3, v3
    v_lshl_add_u32 v3, v13, 6, v3
    v_mul_u32_u24 v4, 544, v14
    s_mul_i32 s26, s24, 1088
    s_add_u32 s26, s26, 16384
    v_add3_u32 v15, v3, v4, s26
    s_waitcnt lgkmcnt(0)
    v_cvt_pk_f16_f32 v68, v24, v25
    v_cvt_pk_f16_f32 v69, v26, v27
    v_cvt_pk_f16_f32 v70, v32, v33
    v_cvt_pk_f16_f32 v71, v34, v35
    v_pk_mul_f16 v84, v68, v56
    v_pk_mul_f16 v86, v70, v56
    v_pk_mul_f16 v85, v69, v57
    v_pk_mul_f16 v87, v71, v57
    v_pk_fma_f16 v84, v70, v58, v84
    v_pk_fma_f16 v86, v68, v58, v86 neg_lo:[1,0,0] neg_hi:[1,0,0]
    v_pk_fma_f16 v85, v71, v59, v85
    v_pk_fma_f16 v87, v69, v59, v87 neg_lo:[1,0,0] neg_hi:[1,0,0]
    s_nop 1
    v_mfma_f32_16x16x32_f16 v[92:95], v[84:87], v[64:67], 0
    v_mfma_f32_16x16x32_f16 v[72:75], v[84:87], v[20:23], 0
    v_cvt_pk_f16_f32 v68, v28, v29
    v_cvt_pk_f16_f32 v69, v30, v31
    v_cvt_pk_f16_f32 v70, v76, v77
    v_cvt_pk_f16_f32 v71, v78, v79
    v_pk_mul_f16 v88, v68, v60
    v_pk_mul_f16 v90, v70, v60
    v_pk_mul_f16 v89, v69, v61
    v_pk_mul_f16 v91, v71, v61
    v_pk_fma_f16 v88, v70, v62, v88
    v_pk_fma_f16 v90, v68, v62, v90 neg_lo:[1,0,0] neg_hi:[1,0,0]
    v_pk_fma_f16 v89, v71, v63, v89
    v_pk_fma_f16 v91, v69, v63, v91 neg_lo:[1,0,0] neg_hi:[1,0,0]
    s_nop 1
    v_mfma_f32_16x16x32_f16 v[96:99], v[88:91], v[64:67], 0
    v_lshrrev_b32 v3, 2, v1
    v_mul_u32_u24 v3, 544, v3
    s_lshr_b32 s26, s24, 2
    v_and_b32 v4, 3, v1
    v_xor_b32 v4, s26, v4
    v_lshl_add_u32 v3, v4, 3, v3
    v_cvt_pk_f16_f32 v68, v92, v93
    v_cvt_pk_f16_f32 v69, v94, v95
    ds_write_b64 v15, v[68:69] offset:0
    v_cvt_f16_f32 v39, v72
    s_mov_b64 exec, 0x101
    ds_write_b16 v15, v39 offset:512
    s_mov_b64 exec, -1
    s_lshr_b32 s28, s24, 1
    s_lshl_b32 s26, s28, 6
    s_add_u32 s26, s26, 16384
    v_add_u32 v38, s26, v3
    v_cvt_pk_f16_f32 v70, v96, v97
    v_cvt_pk_f16_f32 v71, v98, v99
    ds_write_b64 v15, v[70:71] offset:32
    s_lshr_b32 s50, s24, 3
    v_bfe_u32 v3, v0, 2, 7
    v_and_b32 v19, 3, v0
    v_lshl_add_u32 v4, v3, 4, s46
    v_sub_u32 v5, 0x800, v4
    v_and_b32 v5, 0x7ff, v5
    s_lshl_b32 s26, s47, 6
    s_sub_u32 s27, 960, s26
    s_cmp_eq_u32 s50, 0
    s_cselect_b32 s49, s26, s27
    s_cselect_b64 vcc, -1, 0
    v_cndmask_b32 v4, v5, v4, vcc
    v_lshl_add_u32 v16, v4, 10, s49
    v_lshl_add_u32 v16, v19, 4, v16
    v_and_b32 v5, 127, v4
    v_lshlrev_b32 v5, 8, v5
    v_lshrrev_b32 v4, 7, v4
    v_lshl_add_u32 v18, v4, 3, v5
    buffer_load_dwordx4 v[80:83], v16, s[4:7], 0 offen
    s_mov_b32 s26, 0x48000
    v_mul_lo_u32 v3, s26, v12
    v_mov_b32 v100, s44
    v_lshl_add_u32 v39, v7, 3, v3
    s_and_b32 s26, s24, 1
    s_mul_i32 s26, s26, 0x120000
    s_lshl_b32 s27, s25, 7
    s_add_u32 s26, s26, s27
    s_add_u32 s26, s26, 0x1000
    s_lshl_b32 s28, s28, 14
    s_add_u32 s36, s26, s28
    s_add_u32 s37, s36, 0x24000
    s_add_u32 s38, s26, 0x20000
    s_add_u32 s39, s38, 0x24000
    s_cmp_lt_u32 s24, 12
    s_cbranch_scc1 L_f_nw2
    s_waitcnt vmcnt(1)
L_f_nw2:
    s_waitcnt lgkmcnt(0)
    s_barrier
    ds_read_b64_tr_b16 v[20:21], v38 offset:0
    ds_read_b64_tr_b16 v[22:23], v38 offset:8704
    ds_read_b64_tr_b16 v[24:25], v38 offset:32
    ds_read_b64_tr_b16 v[26:27], v38 offset:8736
    v_mov_b32 v57, 0
    v_mov_b32 v58, s32
    v_lshlrev_b32 v56, 2, v0
    s_cmp_gt_u32 s24, 1
    s_cbranch_scc1 L_f_nony
    ds_read_b64_tr_b16 v[28:29], v38 offset:512
    ds_read_b64_tr_b16 v[30:31], v38 offset:9216
    s_waitcnt lgkmcnt(0)
    v_mfma_f32_16x16x32_f16 v[44:47], v[8:11], v[28:31], 0
L_f_nony:
    s_waitcnt lgkmcnt(2)
    v_mfma_f32_16x16x32_f16 v[32:35], v[8:11], v[20:23], 0
    s_waitcnt lgkmcnt(0)
    v_mfma_f32_16x16x32_f16 v[40:43], v[8:11], v[24:27], 0
    ds_write_b32 v56, v57 offset:48384
    s_nop 4
    v_cvt_pk_f16_f32 v48, v32, v33
    v_bfi_b32 v48, s45, v100, v48
    v_cvt_pk_f16_f32 v49, v40, v41
    v_bfi_b32 v49, s45, v100, v49
    buffer_store_dwordx2 v[48:49], v39, s[12:15], s36 offen sc1
    v_cvt_pk_f16_f32 v50, v34, v35
    v_bfi_b32 v50, s45, v100, v50
    v_cvt_pk_f16_f32 v51, v42, v43
    v_bfi_b32 v51, s45, v100, v51
    buffer_store_dwordx2 v[50:51], v39, s[12:15], s37 offen sc1
    s_cmp_gt_u32 s24, 1
    s_cbranch_scc1 L_f_nony2
    v_cvt_pk_f16_f32 v52, v44, v45
    v_bfi_b32 v52, s45, v100, v52
    v_mov_b32 v53, v100
    buffer_store_dwordx2 v[52:53], v39, s[12:15], s38 offen sc1
    v_cvt_pk_f16_f32 v54, v46, v47
    v_bfi_b32 v54, s45, v100, v54
    v_mov_b32 v55, v100
    buffer_store_dwordx2 v[54:55], v39, s[12:15], s39 offen sc1
L_f_nony2:
    s_waitcnt lgkmcnt(0)
    s_barrier
    v_bfe_u32 v3, v0, 2, 7
    s_mov_b32 s51, 0x242080
    s_cmp_eq_u32 s24, 15
    s_cbranch_scc1 L_f_nx
    buffer_load_dwordx2 v[14:15], v18, s[12:15], s51 offen sc1
L_f_nx:
    ds_read_b128 v[60:63], v2 offset:44288
    ds_read_b128 v[64:67], v2 offset:45312
    ds_read_b128 v[68:71], v2 offset:46336
    ds_read_b128 v[72:75], v2 offset:47360
    v_lshrrev_b32 v11, 2, v0
    v_lshlrev_b32 v11, 2, v11
    v_lshrrev_b32 v4, 2, v3
    v_lshrrev_b32 v5, 5, v3
    v_xor_b32 v4, v4, v5
    v_and_b32 v3, 3, v3
    v_lshlrev_b32 v3, 2, v3
    v_lshl_add_u32 v3, v4, 4, v3
    s_mul_i32 s27, s50, 3
    v_xor_b32 v4, s27, v19
    v_lshlrev_b32 v5, 5, v4
    v_xor_b32 v8, v3, v5
    v_lshl_add_u32 v8, v4, 12, v8
    v_add_u32 v4, 1, v4
    v_and_b32 v5, 3, v4
    v_lshlrev_b32 v5, 5, v5
    v_xor_b32 v9, v3, v5
    v_lshl_add_u32 v9, v4, 12, v9
    s_lshr_b32 s27, s24, 2
    s_lshl_b32 s28, s24, 1
    s_and_b32 s28, s28, 6
    v_lshrrev_b32 v3, 5, v1
    v_add_u32 v3, s28, v3
    v_bfe_u32 v4, v1, 3, 2
    v_lshl_add_u32 v5, v4, 3, v3
    s_lshl_b32 s28, s27, 12
    v_lshl_add_u32 v33, v5, 7, s28
    v_lshl_add_u32 v33, v13, 4, v33
    s_lshl_b32 s28, s27, 8
    v_lshl_add_u32 v3, v3, 4, s28
    v_lshl_add_u32 v3, v4, 2, v3
    v_mul_u32_u24 v4, 2080, v13
    v_add_u32 v32, v3, v4
    s_and_b32 s27, s24, 3
    s_lshl_b32 s28, s27, 12
    v_lshrrev_b32 v3, 1, v1
    v_and_b32 v4, 1, v1
    v_lshl_add_u32 v35, v3, 7, s28
    v_lshl_add_u32 v35, v4, 4, v35
    s_lshl_b32 s28, s27, 8
    v_and_b32 v5, 7, v3
    v_lshl_add_u32 v5, v4, 3, v5
    v_lshl_add_u32 v34, v5, 4, s28
    v_lshl_add_u32 v34, v12, 2, v34
    s_mul_i32 s27, s24, 1040
    v_add_u32 v30, s27, v2
    v_lshl_add_u32 v3, v13, 2, v12
    v_lshrrev_b32 v4, 1, v13
    v_xor_b32 v3, v3, v4
    v_lshlrev_b32 v3, 4, v3
    v_and_b32 v4, 8, v1
    v_lshl_add_u32 v38, v4, 6, v3
    s_lshr_b32 s27, s24, 2
    s_lshl_b32 s27, s27, 5
    v_xor_b32 v31, s27, v38
    s_lshl_b32 s27, s24, 10
    v_add_u32 v31, s27, v31
    s_mul_i32 s27, s46, 0x24000
    s_lshl_b32 s28, s47, 14
    s_add_u32 s36, s27, s28
    s_add_u32 s36, s36, 0x1000
    s_mov_b32 s22, 0x200000
    s_mov_b32 s23, 0x20000
    s_and_b32 s26, s24, 7
    s_lshl_b32 s26, s26, 2
    v_mov_b32 v5, s26
    s_mov_b32 s38, 0
    s_cmp_lg_u32 s24, 15
    s_cbranch_scc1 L_f_gw
    s_and_b32 s26, s2, 7
    s_lshl_b32 s26, s26, 7
    s_add_u32 s26, s26, 0x254400
    s_mov_b64 exec, 0xff
L_f_pw:
    buffer_load_dwordx2 v[76:77], v17, s[12:15], s26 offen sc1
    s_add_u32 s38, s38, 1
    s_cmp_gt_u32 s38, 0x40000
    s_waitcnt vmcnt(0)
    s_cbranch_scc1 L_f_pw_d
L_f_pw_c:
    v_cmp_ne_u32 vcc, s32, v77
    s_cbranch_vccz L_f_pw_d
    s_branch L_f_pw
L_f_pw_d:
    v_lshlrev_b32 v3, 2, v1
    ds_write_b32 v3, v76 offset:52480
    s_mov_b64 exec, -1
    buffer_load_dwordx2 v[14:15], v18, s[12:15], s51 offen sc1
    s_waitcnt lgkmcnt(0)
L_f_gw:
    s_barrier
    ds_read_b32 v4, v5 offset:52480
    buffer_load_dwordx4 v[40:43], v33, s[12:15], s36 offen sc1
    s_mov_b32 s38, 0
    s_add_u32 s28, s36, 16384
    s_cmp_lt_u32 s24, 12
    s_cbranch_scc1 L_f_i1
    buffer_load_dwordx4 v[44:47], v35, s[12:15], s28 offen sc1
    s_waitcnt vmcnt(2) lgkmcnt(0)
    s_branch L_f_i2
L_f_i1:
    s_waitcnt vmcnt(1) lgkmcnt(0)
L_f_i2:
    v_readfirstlane_b32 s41, v4
    s_branch L_f_ps_c
L_f_ps:
    buffer_load_dwordx2 v[14:15], v18, s[12:15], s51 offen sc1
    s_add_u32 s38, s38, 1
    s_cmp_gt_u32 s38, 0x40000
    s_waitcnt vmcnt(0)
    s_cbranch_scc1 L_f_ps_d
L_f_ps_c:
    v_cmp_ne_u32 vcc, s32, v15
    s_mov_b64 exec, vcc
    s_cbranch_execnz L_f_ps
L_f_ps_d:
    s_mov_b64 exec, -1
    v_lshlrev_b32 v28, 16, v14
    v_rcp_f32 v28, v28
    v_and_b32 v14, 0xffff0000, v14
    v_xor_b32 v3, 0x80000000, v14
    v_add_f32 v28, 1.0, v28
    v_dot2_f32_bf16 v20, v80, s30, v3
    v_dot2_f32_bf16 v21, v80, s31, v3
    v_dot2_f32_bf16 v22, v81, s30, v3
    v_dot2_f32_bf16 v23, v81, s31, v3
    v_dot2_f32_bf16 v24, v82, s30, v3
    v_dot2_f32_bf16 v25, v82, s31, v3
    v_dot2_f32_bf16 v26, v83, s30, v3
    v_dot2_f32_bf16 v27, v83, s31, v3
    v_pk_fma_f32 v[20:21], v[20:21], v[28:29], v[14:15] op_sel_hi:[1,0,0]
    v_pk_fma_f32 v[22:23], v[22:23], v[28:29], v[14:15] op_sel_hi:[1,0,0]
    v_pk_fma_f32 v[24:25], v[24:25], v[28:29], v[14:15] op_sel_hi:[1,0,0]
    v_pk_fma_f32 v[26:27], v[26:27], v[28:29], v[14:15] op_sel_hi:[1,0,0]
    s_mov_b32 s38, 0
    s_cmp_lt_u32 s24, 12
    s_waitcnt vmcnt(0)
    s_cbranch_scc0 L_f_l9c
    s_branch L_f_lp_c
L_f_lp:
    buffer_load_dwordx4 v[40:43], v33, s[12:15], s36 offen sc1
    s_add_u32 s38, s38, 1
    s_cmp_gt_u32 s38, 0x40000
    s_waitcnt vmcnt(0)
    s_cbranch_scc1 L_f_lp_d
L_f_lp_c:
    v_xor_b32 v40, s44, v40
    v_xor_b32 v41, s44, v41
    v_xor_b32 v42, s44, v42
    v_xor_b32 v43, s44, v43
    v_or3_b32 v3, v40, v41, v42
    v_bitop3_b32 v3, v3, v43, s45 bitop3:0xa8
    s_nop 1
    v_or_b32_dpp v3, v3, v3 quad_perm:[1,0,3,2] row_mask:0xf bank_mask:0xf
    v_cmp_ne_u32 vcc, 0, v3
    s_mov_b64 exec, vcc
    s_cbranch_execz L_f_lp_d
    s_branch L_f_lp
L_f_l9p:
    buffer_load_dwordx4 v[40:43], v33, s[12:15], s36 offen sc1
    buffer_load_dwordx4 v[44:47], v35, s[12:15], s28 offen sc1
    s_add_u32 s38, s38, 1
    s_cmp_gt_u32 s38, 0x40000
    s_waitcnt vmcnt(0)
    s_cbranch_scc1 L_f_l9p_d
L_f_l9c:
    v_xor_b32 v40, s44, v40
    v_xor_b32 v41, s44, v41
    v_xor_b32 v42, s44, v42
    v_xor_b32 v43, s44, v43
    v_xor_b32 v44, s44, v44
    v_xor_b32 v45, s44, v45
    v_xor_b32 v46, s44, v46
    v_xor_b32 v47, s44, v47
    v_or3_b32 v3, v40, v41, v42
    v_or3_b32 v3, v3, v44, v45
    v_or3_b32 v3, v3, v46, v47
    v_bitop3_b32 v3, v3, v43, s45 bitop3:0xa8
    s_nop 1
    v_or_b32_dpp v3, v3, v3 quad_perm:[1,0,3,2] row_mask:0xf bank_mask:0xf
    v_cmp_ne_u32 vcc, 0, v3
    s_mov_b64 exec, vcc
    s_cbranch_execz L_f_l9p_d
    s_branch L_f_l9p
L_f_l9p_d:
    s_mov_b32 exec_lo, 0xaaaaaaaa
    s_mov_b32 exec_hi, 0xaaaaaaaa
    v_mov_b32 v44, 0
    s_mov_b64 exec, -1
    ds_write_b32 v34, v44 offset:16640
L_f_lp_d:
    s_mov_b64 exec, -1
    ds_write_b32 v32, v40 offset:0
    ds_write_b32 v32, v41 offset:128
    ds_write_b32 v32, v42 offset:1040
    ds_write_b32 v32, v43 offset:1168
    s_not_b32 s26, s41
    s_add_u32 s27, s41, 1
    s_cmp_eq_u32 s50, 0
    s_cselect_b32 s26, s26, s27
    s_mul_i32 s42, s24, 144
    s_add_u32 s42, s42, 49408
    s_xor_b32 s28, s26, s46
    s_and_b32 s28, s28, 15
    s_cbranch_scc1 L_f_nm
    s_bfe_u32 s26, s26, 458756
    s_lshl_b32 s27, s50, 7
    s_add_u32 s26, s26, s27
    s_lshl_b32 s26, s26, 2
    v_mov_b32 v4, s26
    v_mov_b32 v5, s42
    ds_write_b32 v4, v5 offset:48384
L_f_nm:
    s_waitcnt lgkmcnt(0)
    s_barrier
    ds_read_b128 v[40:43], v30 offset:0
    ds_read_b128 v[44:47], v2 offset:16640
    s_waitcnt lgkmcnt(1)
    v_mfma_f32_16x16x32_f16 v[76:79], v[40:43], v[64:67], 0
    v_mfma_f32_16x16x32_f16 v[84:87], v[40:43], v[68:71], 0
    s_nop 6
    v_cvt_pk_f16_f32 v92, v76, v77
    v_cvt_pk_f16_f32 v93, v78, v79
    v_cvt_pk_f16_f32 v94, v84, v85
    v_cvt_pk_f16_f32 v95, v86, v87
    v_pk_mul_f16 v88, v92, v72
    v_pk_mul_f16 v90, v94, v72
    v_pk_mul_f16 v89, v93, v73
    v_pk_mul_f16 v91, v95, v73
    v_pk_fma_f16 v88, v94, v74, v88
    v_pk_fma_f16 v90, v92, v74, v90 neg_lo:[1,0,0] neg_hi:[1,0,0]
    v_pk_fma_f16 v89, v95, v75, v89
    v_pk_fma_f16 v91, v93, v75, v91 neg_lo:[1,0,0] neg_hi:[1,0,0]
    s_nop 1
    v_mfma_f32_16x16x32_f16 v[96:99], v[88:91], v[60:63], 0
    s_nop 7
    ds_write_b128 v31, v[96:99] offset:17920
    s_cmp_lg_u32 s24, 0
    s_cbranch_scc1 L_f_n17
    s_waitcnt lgkmcnt(1)
    v_mfma_f32_16x16x32_f16 v[76:79], v[44:47], v[64:67], 0
    v_mfma_f32_16x16x32_f16 v[84:87], v[44:47], v[68:71], 0
    s_nop 6
    v_cvt_pk_f16_f32 v92, v76, v77
    v_cvt_pk_f16_f32 v93, v78, v79
    v_cvt_pk_f16_f32 v94, v84, v85
    v_cvt_pk_f16_f32 v95, v86, v87
    v_pk_mul_f16 v88, v92, v72
    v_pk_mul_f16 v90, v94, v72
    v_pk_mul_f16 v89, v93, v73
    v_pk_mul_f16 v91, v95, v73
    v_pk_fma_f16 v88, v94, v74, v88
    v_pk_fma_f16 v90, v92, v74, v90 neg_lo:[1,0,0] neg_hi:[1,0,0]
    v_pk_fma_f16 v89, v95, v75, v89
    v_pk_fma_f16 v91, v93, v75, v91 neg_lo:[1,0,0] neg_hi:[1,0,0]
    s_nop 1
    v_mfma_f32_16x16x32_f16 v[96:99], v[88:91], v[60:63], 0
    s_nop 7
    ds_write_b128 v38, v[96:99] offset:34304
L_f_n17:
    s_cmp_lg_u32 s28, 0
    s_cbranch_scc1 L_f_ng
    s_setprio 3
    v_lshrrev_b32 v3, 3, v1
    v_lshlrev_b32 v3, 14, v3
    v_lshl_add_u32 v32, v13, 4, v3
    s_and_b32 s26, s24, 7
    s_lshl_b32 s26, s26, 11
    s_lshl1_add_u32 s36, s49, s26
    s_add_u32 s36, s36, 0x260000
    s_and_b32 s43, s32, 0xff
    s_movk_i32 s29, 0xff
    s_add_u32 s39, s36, 786432
    s_mov_b64 exec, 1
    buffer_load_dword v33, v32, s[12:15], s39 offen sc1
    s_mov_b64 exec, -1
L_f_ng:
    s_waitcnt lgkmcnt(0)
    s_barrier
    s_cmp_lg_u32 s28, 0
    s_cbranch_scc1 L_f_epi
    s_mov_b64 exec, 1
    s_mov_b32 s38, 0
L_f_pg:
    s_waitcnt vmcnt(0)
    v_bitop3_b32 v33, v33, v58, s29 bitop3:0x28
    v_cmp_ne_u32 vcc, 0, v33
    s_cbranch_vccz L_f_pg_ok0
    buffer_load_dword v33, v32, s[12:15], s39 offen sc1
    s_add_u32 s38, s38, 1
    s_cmp_lt_u32 s38, 0x40000
    s_cbranch_scc1 L_f_pg
L_f_pg_ok0:
L_f_pg_d:
    s_mov_b64 exec, -1
    s_mov_b32 s26, s36
    buffer_load_dwordx4 v[84:87], v32, s[12:15], s26 offen sc1
    s_add_u32 s26, s26, 131072
    buffer_load_dwordx4 v[88:91], v32, s[12:15], s26 offen sc1
    s_add_u32 s26, s26, 131072
    buffer_load_dwordx4 v[92:95], v32, s[12:15], s26 offen sc1
    s_add_u32 s26, s26, 131072
    buffer_load_dwordx4 v[96:99], v32, s[12:15], s26 offen sc1
    s_add_u32 s26, s26, 131072
    buffer_load_dwordx4 v[100:103], v32, s[12:15], s26 offen sc1
    s_add_u32 s26, s26, 131072
    buffer_load_dwordx4 v[104:107], v32, s[12:15], s26 offen sc1
    s_add_u32 s26, s26, 131072
    buffer_load_dwordx4 v[108:111], v32, s[12:15], s26 offen sc1
L_f_epi:
    ds_read_b32 v10, v11 offset:48384
    s_cmp_eq_u32 s50, 0
    s_cbranch_scc0 L_f_mir
    ds_read_b32 v40, v8 offset:17920
    ds_read_b32 v41, v8 offset:18432
    ds_read_b32 v42, v8 offset:18944
    ds_read_b32 v43, v8 offset:19456
    ds_read_b32 v44, v8 offset:19968
    ds_read_b32 v45, v8 offset:20480
    ds_read_b32 v46, v8 offset:20992
    ds_read_b32 v47, v8 offset:21504
    s_branch L_f_fin
L_f_mir:
    ds_read_b32 v40, v9 offset:17920
    ds_read_b32 v41, v8 offset:21504
    ds_read_b32 v42, v8 offset:20992
    ds_read_b32 v43, v8 offset:20480
    ds_read_b32 v44, v8 offset:19968
    ds_read_b32 v45, v8 offset:19456
    ds_read_b32 v46, v8 offset:18944
    ds_read_b32 v47, v8 offset:18432
L_f_fin:
    s_waitcnt lgkmcnt(8)
    v_cmp_eq_u32 s[34:35], 0, v10
    s_waitcnt lgkmcnt(6)
    v_add_f32 v40, v40, v20
    v_add_f32 v41, v41, v21
    v_cvt_pk_bf16_f32 v60, v40, v41
    s_waitcnt lgkmcnt(4)
    v_add_f32 v42, v42, v22
    v_add_f32 v43, v43, v23
    v_cvt_pk_bf16_f32 v61, v42, v43
    s_waitcnt lgkmcnt(2)
    v_add_f32 v44, v44, v24
    v_add_f32 v45, v45, v25
    v_cvt_pk_bf16_f32 v62, v44, v45
    s_waitcnt lgkmcnt(0)
    v_add_f32 v46, v46, v26
    v_add_f32 v47, v47, v27
    v_cvt_pk_bf16_f32 v63, v46, v47
    s_mov_b64 exec, s[34:35]
    buffer_store_dwordx4 v[60:63], v16, s[20:23], 0 offen
    s_not_b64 exec, s[34:35]
    s_cbranch_execz L_f_nb
    v_lshl_add_u32 v4, v19, 5, v10
    v_mov_b32 v5, 1
    ds_write_b128 v4, v[40:43]
    ds_write_b128 v4, v[44:47] offset:16
    ds_write_b32 v10, v5 offset:128
L_f_nb:
    s_cmp_lg_u32 s28, 0
    s_cbranch_scc1 L_f_end
    s_mov_b64 exec, -1
    s_ashr_i32 s27, s41, 31
    s_not_b32 s27, s27
    s_or_b32 s27, s27, 0x80000000
    s_xor_b32 s27, s27, s41
    s_and_b32 s27, s27, 0xffff0000
    v_mov_b32 v30, 0xbfb8aa3b
    v_mul_f32 v30, s27, v30
    v_exp_f32 v30, v30
    s_nop 0
    v_add_f32 v30, 1.0, v30
    v_rcp_f32 v30, v30
    s_nop 0
    v_cvt_pk_bf16_f32 v30, v30, v30
    v_and_b32 v30, 0xffff0000, v30
    v_add_u32 v3, s42, v2
    v_mov_b32 v4, s42
    s_andn2_b32 s26, 0x7ff, s41
    s_lshl_b32 s26, s26, 10
    s_add_u32 s39, s26, s49
    s_mov_b32 s27, 0
    s_mov_b64 exec, 0xff
L_f_bw:
    ds_read_b32 v5, v4 offset:128
    ds_read_b128 v[40:43], v3
    s_add_u32 s27, s27, 1
    s_cmp_gt_u32 s27, 0x100000
    s_waitcnt lgkmcnt(0)
    s_cbranch_scc1 L_f_bw_d
    v_cmp_eq_u32 vcc, 0, v5
    s_cbranch_vccnz L_f_bw
L_f_bw_d:
    s_mov_b64 exec, -1
    s_mov_b32 s38, 0
    s_branch L_f_pck
L_f_pl:
    s_mov_b32 s26, s36
    buffer_load_dwordx4 v[84:87], v32, s[12:15], s26 offen sc1
    s_add_u32 s26, s26, 131072
    buffer_load_dwordx4 v[88:91], v32, s[12:15], s26 offen sc1
    s_add_u32 s26, s26, 131072
    buffer_load_dwordx4 v[92:95], v32, s[12:15], s26 offen sc1
    s_add_u32 s26, s26, 131072
    buffer_load_dwordx4 v[96:99], v32, s[12:15], s26 offen sc1
    s_add_u32 s26, s26, 131072
    buffer_load_dwordx4 v[100:103], v32, s[12:15], s26 offen sc1
    s_add_u32 s26, s26, 131072
    buffer_load_dwordx4 v[104:107], v32, s[12:15], s26 offen sc1
    s_add_u32 s26, s26, 131072
    buffer_load_dwordx4 v[108:111], v32, s[12:15], s26 offen sc1
    s_waitcnt vmcnt(0)
L_f_pck:
    s_add_u32 s38, s38, 1
    v_mov_b32 v5, 0
    s_waitcnt vmcnt(7)
    v_xor_b32 v84, s43, v84
    v_xor_b32 v86, s43, v86
    v_or3_b32 v5, v5, v84, v86
    s_waitcnt vmcnt(6)
    v_xor_b32 v88, s43, v88
    v_xor_b32 v90, s43, v90
    v_or3_b32 v5, v5, v88, v90
    v_pk_add_f32 v[84:85], v[84:85], v[88:89]
    v_pk_add_f32 v[86:87], v[86:87], v[90:91]
    s_waitcnt vmcnt(5)
    v_xor_b32 v92, s43, v92
    v_xor_b32 v94, s43, v94
    v_or3_b32 v5, v5, v92, v94
    v_pk_add_f32 v[84:85], v[84:85], v[92:93]
    v_pk_add_f32 v[86:87], v[86:87], v[94:95]
    s_waitcnt vmcnt(4)
    v_xor_b32 v96, s43, v96
    v_xor_b32 v98, s43, v98
    v_or3_b32 v5, v5, v96, v98
    v_pk_add_f32 v[84:85], v[84:85], v[96:97]
    v_pk_add_f32 v[86:87], v[86:87], v[98:99]
    s_waitcnt vmcnt(3)
    v_xor_b32 v100, s43, v100
    v_xor_b32 v102, s43, v102
    v_or3_b32 v5, v5, v100, v102
    v_pk_add_f32 v[84:85], v[84:85], v[100:101]
    v_pk_add_f32 v[86:87], v[86:87], v[102:103]
    s_waitcnt vmcnt(2)
    v_xor_b32 v104, s43, v104
    v_xor_b32 v106, s43, v106
    v_or3_b32 v5, v5, v104, v106
    v_pk_add_f32 v[84:85], v[84:85], v[104:105]
    v_pk_add_f32 v[86:87], v[86:87], v[106:107]
    s_waitcnt vmcnt(1)
    v_xor_b32 v108, s43, v108
    v_xor_b32 v110, s43, v110
    v_or3_b32 v5, v5, v108, v110
    v_pk_add_f32 v[84:85], v[84:85], v[108:109]
    v_pk_add_f32 v[86:87], v[86:87], v[110:111]
    v_and_b32 v5, 0xff, v5
    v_cmp_ne_u32 vcc, 0, v5
    s_cmp_gt_u32 s38, 0x40000
    s_cbranch_scc1 L_f_plok
    s_cbranch_vccnz L_f_pl
L_f_plok:
    v_add_f32_dpp v84, v84, v84 row_ror:8 row_mask:0xf bank_mask:0xf
    v_add_f32_dpp v85, v85, v85 row_ror:8 row_mask:0xf bank_mask:0xf
    v_add_f32_dpp v86, v86, v86 row_ror:8 row_mask:0xf bank_mask:0xf
    v_add_f32_dpp v87, v87, v87 row_ror:8 row_mask:0xf bank_mask:0xf
    v_mov_b32 v88, v84
    v_mov_b32 v89, v85
    v_mov_b32 v90, v86
    v_mov_b32 v91, v87
    v_permlane16_swap_b32 v84, v88
    v_permlane16_swap_b32 v85, v89
    v_permlane16_swap_b32 v86, v90
    v_permlane16_swap_b32 v87, v91
    v_pk_add_f32 v[84:85], v[84:85], v[88:89]
    v_pk_add_f32 v[86:87], v[86:87], v[90:91]
    v_mov_b32 v88, v84
    v_mov_b32 v89, v85
    v_mov_b32 v90, v86
    v_mov_b32 v91, v87
    v_permlane32_swap_b32 v84, v88
    v_permlane32_swap_b32 v85, v89
    v_permlane32_swap_b32 v86, v90
    v_permlane32_swap_b32 v87, v91
    v_pk_add_f32 v[84:85], v[84:85], v[88:89]
    v_pk_add_f32 v[86:87], v[86:87], v[90:91]
    v_pk_fma_f32 v[84:85], v[84:85], v[30:31], v[40:41] op_sel_hi:[1,0,1]
    v_pk_fma_f32 v[86:87], v[86:87], v[30:31], v[42:43] op_sel_hi:[1,0,1]
    s_mov_b64 exec, 0xff
    v_cvt_pk_bf16_f32 v88, v84, v85
    v_cvt_pk_bf16_f32 v89, v86, v87
    buffer_store_dwordx2 v[88:89], v17, s[20:23], s39 offen
    s_or_b32 s26, s47, s24
    s_cmp_lg_u32 s26, 0
    s_cbranch_scc1 L_f_end
    s_mov_b64 exec, 1
    s_mov_b32 s26, 0x250000
    buffer_store_dword v58, v57, s[12:15], s26 offen sc1
L_f_end:
    s_endpgm
L_moe:
    s_load_dwordx4 s[24:27], s[0:1], 56
    s_load_dwordx2 s[12:13], s[0:1], 96
    s_load_dwordx2 s[8:9], s[0:1], 72
    s_load_dwordx2 s[4:5], s[0:1], 0
    v_and_b32 v1, 63, v0
    v_lshrrev_b32 v3, 6, v0
    s_getpc_b64 s[20:21]
    s_mov_b32 s22, 0x10000
    s_mov_b32 s23, 0x20000
    v_lshlrev_b32 v7, 6, v1
    v_readfirstlane_b32 s30, v3
    s_sub_u32 s32, s2, 128
    s_and_b32 s31, s32, 7
    s_cmp_lt_u32 s30, 8
    s_cbranch_scc0 L_moe_sel
    s_barrier
    s_mul_i32 s31, s31, 7
    s_lshr_b32 s32, s32, 3
    s_add_u32 s31, s31, s32
    v_lshrrev_b32 v3, 2, v1
    v_mul_u32_u24 v3, 3584, v3
    v_and_b32 v4, 3, v1
    v_lshl_add_u32 v6, v4, 4, v3
    s_and_b32 s34, s30, 3
    s_mul_i32 s32, s34, 458752
    s_lshl_b32 s33, s31, 6
    s_add_u32 s32, s32, s33
    s_lshl_b32 s33, s30, 13
    s_add_u32 s33, s33, 9728
    s_mov_b32 m0, s33
    s_mov_b32 s18, 1835008
    s_mov_b32 s19, 0x20000
    s_cmp_lt_u32 s30, 4
    s_waitcnt lgkmcnt(0)
    s_cselect_b32 s16, s24, s26
    s_cselect_b32 s17, s25, s27
    s_add_u32 s28, s12, 0x250000
    s_addc_u32 s29, s13, 0
    s_load_dword s35, s[28:29], 0
    buffer_load_dwordx4 v6, s[16:19], s32 offen offset:0 lds
    s_add_u32 s32, s32, 56320
    buffer_load_dwordx4 v6, s[16:19], s32 offen offset:1024 lds
    s_add_u32 s32, s32, 56320
    buffer_load_dwordx4 v6, s[16:19], s32 offen offset:2048 lds
    s_add_u32 s32, s32, 56320
    buffer_load_dwordx4 v6, s[16:19], s32 offen offset:3072 lds
    s_add_u32 s32, s32, 56320
    s_add_u32 s33, s33, 4096
    s_mov_b32 m0, s33
    s_add_u32 s32, s32, 4096
    buffer_load_dwordx4 v6, s[16:19], s32 offen offset:0 lds
    s_add_u32 s32, s32, 56320
    buffer_load_dwordx4 v6, s[16:19], s32 offen offset:1024 lds
    s_add_u32 s32, s32, 56320
    buffer_load_dwordx4 v6, s[16:19], s32 offen offset:2048 lds
    s_add_u32 s32, s32, 56320
    buffer_load_dwordx4 v6, s[16:19], s32 offen offset:3072 lds
    s_mov_b32 s14, 0x1000000
    s_mov_b32 s15, 0x20000
    s_mov_b32 s10, 0x1c0000
    s_mov_b32 s11, 0x20000
    v_lshrrev_b32 v2, 4, v1
    v_lshlrev_b32 v6, 4, v1
    v_and_b32 v5, 7, v1
    v_mov_b32 v16, 0
    v_and_b32 v4, 15, v1
    v_lshlrev_b32 v4, 4, v4
    v_lshlrev_b32 v3, 5, v2
    v_xor_b32 v4, v3, v4
    v_lshl_add_u32 v14, v2, 10, v4
    v_xor_b32 v15, 128, v14
    s_lshl_b32 s36, s31, 15
    s_lshl_b32 s33, s30, 8
    s_add_u32 s36, s36, s33
    s_lshl_b32 s39, s30, 13
    s_add_u32 s39, s39, 75264
    v_lshlrev_b32 v3, 9, v2
    v_bfe_u32 v4, v1, 2, 2
    v_lshl_add_u32 v3, v4, 6, v3
    v_and_b32 v4, 3, v1
    v_lshl_add_u32 v3, v4, 3, v3
    s_lshl_b32 s32, s30, 13
    s_add_u32 s32, s32, 9728
    v_add_u32 v8, s32, v3
    v_add_u32 v10, s32, v6
    v_add_u32 v11, 9728, v6
    v_lshrrev_b32 v3, 2, v1
    v_lshlrev_b32 v9, 8, v3
    v_and_b32 v3, 7, v3
    v_lshl_add_u32 v9, v3, 5, v9
    v_lshl_add_u32 v9, v4, 3, v9
    v_add_u32 v9, s39, v9
    v_mul_u32_u24 v3, 1056, v5
    v_lshl_add_u32 v3, v2, 4, v3
    s_lshl_b32 s32, s34, 8
    s_add_u32 s32, s32, 576
    v_add_u32 v12, s32, v3
    v_lshlrev_b32 v3, 11, v5
    v_lshl_add_u32 v13, v2, 4, v3
    v_and_b32 v3, 8, v1
    v_lshl_add_u32 v13, v3, 3, v13
    v_lshlrev_b32 v5, 2, v5
    s_lshl_b32 s37, s31, 14
    s_lshl_b32 s33, s30, 9
    s_add_u32 s37, s37, s33
    s_add_u32 s37, s37, 0x260000
    s_movk_i32 s38, 0xff
    v_xor_b32 v18, 32, v9
    v_xor_b32 v19, 64, v9
    v_xor_b32 v96, 96, v9
    v_mov_b32 v84, 0x3f803f80
    v_mov_b32 v85, 0x3f803f80
    v_mov_b32 v86, 0x3f803f80
    v_mov_b32 v87, 0x3f803f80
    s_waitcnt lgkmcnt(0)
    s_add_u32 s35, s35, 1
    v_mov_b32 v17, s35
    s_waitcnt vmcnt(6)
    ds_read_b64_tr_b16 v[20:21], v8 offset:0
    ds_read_b64_tr_b16 v[22:23], v8 offset:256
    ds_read_b64_tr_b16 v[24:25], v8 offset:32
    ds_read_b64_tr_b16 v[26:27], v8 offset:288
    s_waitcnt vmcnt(4)
    ds_read_b64_tr_b16 v[28:29], v8 offset:2048
    ds_read_b64_tr_b16 v[30:31], v8 offset:2304
    ds_read_b64_tr_b16 v[32:33], v8 offset:2080
    ds_read_b64_tr_b16 v[34:35], v8 offset:2336
    s_waitcnt lgkmcnt(4)
    v_mfma_f32_16x16x32_bf16 v[88:91], v[20:23], v[84:87], 0
    v_mfma_f32_16x16x32_bf16 v[92:95], v[24:27], v[84:87], 0
    s_waitcnt vmcnt(2)
    ds_read_b64_tr_b16 v[36:37], v8 offset:4096
    ds_read_b64_tr_b16 v[38:39], v8 offset:4352
    ds_read_b64_tr_b16 v[40:41], v8 offset:4128
    ds_read_b64_tr_b16 v[42:43], v8 offset:4384
    s_waitcnt lgkmcnt(4)
    v_mfma_f32_16x16x32_bf16 v[88:91], v[28:31], v[84:87], v[88:91]
    v_mfma_f32_16x16x32_bf16 v[92:95], v[32:35], v[84:87], v[92:95]
    s_waitcnt vmcnt(0)
    ds_read_b64_tr_b16 v[44:45], v8 offset:6144
    ds_read_b64_tr_b16 v[46:47], v8 offset:6400
    ds_read_b64_tr_b16 v[48:49], v8 offset:6176
    ds_read_b64_tr_b16 v[50:51], v8 offset:6432
    s_waitcnt lgkmcnt(4)
    v_mfma_f32_16x16x32_bf16 v[88:91], v[36:39], v[84:87], v[88:91]
    v_mfma_f32_16x16x32_bf16 v[92:95], v[40:43], v[84:87], v[92:95]
    s_waitcnt lgkmcnt(0)
    v_mfma_f32_16x16x32_bf16 v[88:91], v[44:47], v[84:87], v[88:91]
    v_mfma_f32_16x16x32_bf16 v[92:95], v[48:51], v[84:87], v[92:95]
    s_mov_b32 exec_lo, 0x00ff00ff
    s_mov_b32 exec_hi, 0x00ff00ff
    s_nop 4
    ds_write_b128 v10, v[88:91]
    ds_write_b128 v10, v[92:95] offset:128
    s_mov_b64 exec, -1
    s_waitcnt lgkmcnt(0)
    s_barrier
    s_sub_u32 s32, s30, 0
    s_cmp_ge_u32 s32, 4
    s_cbranch_scc1 L_moe_ndc
    s_mov_b32 m0, s39
    s_nop 0
    buffer_load_dwordx4 v14, s[8:11], s36 offen offset:0 lds
    s_add_u32 s36, s36, 3072
    buffer_load_dwordx4 v15, s[8:11], s36 offen offset:1024 lds
    s_add_u32 s36, s36, 3072
    buffer_load_dwordx4 v14, s[8:11], s36 offen offset:2048 lds
    s_add_u32 s36, s36, 3072
    buffer_load_dwordx4 v15, s[8:11], s36 offen offset:3072 lds
    s_add_u32 s36, s36, 3072
    s_add_u32 s39, s39, 4096
    s_mov_b32 m0, s39
    s_add_u32 s36, s36, 4096
    buffer_load_dwordx4 v14, s[8:11], s36 offen offset:0 lds
    s_add_u32 s36, s36, 3072
    buffer_load_dwordx4 v15, s[8:11], s36 offen offset:1024 lds
    s_add_u32 s36, s36, 3072
    buffer_load_dwordx4 v14, s[8:11], s36 offen offset:2048 lds
    s_add_u32 s36, s36, 3072
    buffer_load_dwordx4 v15, s[8:11], s36 offen offset:3072 lds
L_moe_ndc:
    s_cmp_gt_u32 s30, 3
    s_cbranch_scc1 L_moe_ncs
    ds_read_b128 v[100:103], v11 offset:0
    ds_read_b128 v[104:107], v11 offset:8192
    ds_read_b128 v[108:111], v11 offset:16384
    ds_read_b128 v[112:115], v11 offset:24576
    s_waitcnt lgkmcnt(0)
    v_pk_add_f32 v[100:101], v[100:101], v[104:105]
    v_pk_add_f32 v[108:109], v[108:109], v[112:113]
    v_pk_add_f32 v[102:103], v[102:103], v[106:107]
    v_pk_add_f32 v[110:111], v[110:111], v[114:115]
    v_pk_add_f32 v[88:89], v[100:101], v[108:109]
    v_pk_add_f32 v[90:91], v[102:103], v[110:111]
    ds_read_b128 v[100:103], v11 offset:32768
    ds_read_b128 v[104:107], v11 offset:40960
    ds_read_b128 v[108:111], v11 offset:49152
    ds_read_b128 v[112:115], v11 offset:57344
    s_waitcnt lgkmcnt(0)
    v_pk_add_f32 v[100:101], v[100:101], v[104:105]
    v_pk_add_f32 v[108:109], v[108:109], v[112:113]
    v_pk_add_f32 v[102:103], v[102:103], v[106:107]
    v_pk_add_f32 v[110:111], v[110:111], v[114:115]
    v_pk_add_f32 v[92:93], v[100:101], v[108:109]
    v_pk_add_f32 v[94:95], v[102:103], v[110:111]
L_moe_ncs:
    s_cmp_gt_u32 s30, 3
    s_cbranch_scc1 L_moe_nr
    s_waitcnt vmcnt(0)
    ds_read_b64_tr_b16 v[52:53], v9 offset:0
    ds_read_b64_tr_b16 v[54:55], v9 offset:4096
    ds_read_b64_tr_b16 v[56:57], v18 offset:0
    ds_read_b64_tr_b16 v[58:59], v18 offset:4096
    ds_read_b64_tr_b16 v[60:61], v19 offset:0
    ds_read_b64_tr_b16 v[62:63], v19 offset:4096
    ds_read_b64_tr_b16 v[64:65], v96 offset:0
    ds_read_b64_tr_b16 v[66:67], v96 offset:4096
    v_xor_b32 v9, 128, v9
    v_xor_b32 v18, 128, v18
    v_xor_b32 v19, 128, v19
    v_xor_b32 v96, 128, v96
    s_waitcnt lgkmcnt(0)
    ds_read_b64_tr_b16 v[68:69], v9 offset:0
    ds_read_b64_tr_b16 v[70:71], v9 offset:4096
    ds_read_b64_tr_b16 v[72:73], v18 offset:0
    ds_read_b64_tr_b16 v[74:75], v18 offset:4096
    ds_read_b64_tr_b16 v[76:77], v19 offset:0
    ds_read_b64_tr_b16 v[78:79], v19 offset:4096
    ds_read_b64_tr_b16 v[80:81], v96 offset:0
    ds_read_b64_tr_b16 v[82:83], v96 offset:4096
    s_waitcnt lgkmcnt(0)
L_moe_nr:
    s_barrier
L_moe_x:
    ds_read_b128 v[100:103], v12 offset:0
    ds_read_b128 v[104:107], v12 offset:64
    ds_read_b128 v[108:111], v12 offset:128
    ds_read_b128 v[112:115], v12 offset:192
    ds_read_b32 v14, v5 offset:9024
    ds_read_b32 v8, v16 offset:9056
    s_waitcnt lgkmcnt(5)
    v_mfma_f32_16x16x32_bf16 v[116:119], v[20:23], v[100:103], 0
    v_mfma_f32_16x16x32_bf16 v[120:123], v[24:27], v[100:103], 0
    s_waitcnt lgkmcnt(4)
    v_mfma_f32_16x16x32_bf16 v[116:119], v[28:31], v[104:107], v[116:119]
    v_mfma_f32_16x16x32_bf16 v[120:123], v[32:35], v[104:107], v[120:123]
    s_waitcnt lgkmcnt(3)
    v_mfma_f32_16x16x32_bf16 v[116:119], v[36:39], v[108:111], v[116:119]
    v_mfma_f32_16x16x32_bf16 v[120:123], v[40:43], v[108:111], v[120:123]
    s_waitcnt lgkmcnt(2)
    v_mfma_f32_16x16x32_bf16 v[116:119], v[44:47], v[112:115], v[116:119]
    v_mfma_f32_16x16x32_bf16 v[120:123], v[48:51], v[112:115], v[120:123]
    s_waitcnt lgkmcnt(0)
    v_cmp_ne_u32 vcc, 0, v8
    v_lshlrev_b32 v86, 16, v14
    v_rcp_f32 v86, v86
    s_cbranch_vccnz L_moe_redo
    s_mov_b32 exec_lo, 0x00ff00ff
    s_mov_b32 exec_hi, 0x00ff00ff
    ds_write_b128 v10, v[116:119]
    ds_write_b128 v10, v[120:123] offset:128
    s_mov_b64 exec, -1
    v_and_b32 v84, 0xffff0000, v14
    v_mul_f32 v84, v84, v86
    v_pk_mul_f32 v[88:89], v[88:89], v[84:85] op_sel_hi:[1,0]
    v_pk_mul_f32 v[90:91], v[90:91], v[84:85] op_sel_hi:[1,0]
    v_pk_mul_f32 v[92:93], v[92:93], v[84:85] op_sel_hi:[1,0]
    v_pk_mul_f32 v[94:95], v[94:95], v[84:85] op_sel_hi:[1,0]
    v_mov_b32 v100, 0
    v_mov_b32 v101, 0
    v_mov_b32 v102, 0
    v_mov_b32 v103, 0
    v_mov_b32 v104, 0
    v_mov_b32 v105, 0
    v_mov_b32 v106, 0
    v_mov_b32 v107, 0
    v_mov_b32 v84, 0xbfb8aa3b
    s_cmp_gt_u32 s30, 3
    s_waitcnt lgkmcnt(0)
    s_barrier
    s_cbranch_scc1 L_moe_fin
    ds_read_b128 v[20:23], v11 offset:0
    ds_read_b128 v[24:27], v11 offset:8192
    ds_read_b128 v[28:31], v11 offset:16384
    ds_read_b128 v[32:35], v11 offset:24576
    ds_read_b128 v[36:39], v11 offset:32768
    ds_read_b128 v[40:43], v11 offset:40960
    ds_read_b128 v[44:47], v11 offset:49152
    ds_read_b128 v[48:51], v11 offset:57344
    s_waitcnt lgkmcnt(4)
    v_pk_add_f32 v[20:21], v[20:21], v[24:25]
    v_pk_add_f32 v[28:29], v[28:29], v[32:33]
    v_pk_add_f32 v[22:23], v[22:23], v[26:27]
    v_pk_add_f32 v[30:31], v[30:31], v[34:35]
    v_pk_add_f32 v[20:21], v[20:21], v[28:29]
    v_pk_add_f32 v[22:23], v[22:23], v[30:31]
    v_pk_fma_f32 v[20:21], v[20:21], v[86:87], v[88:89] op_sel_hi:[1,0,1] neg_lo:[0,0,1] neg_hi:[0,0,1]
    v_pk_fma_f32 v[22:23], v[22:23], v[86:87], v[90:91] op_sel_hi:[1,0,1] neg_lo:[0,0,1] neg_hi:[0,0,1]
    v_pk_mul_f32 v[24:25], v[20:21], v[84:85] op_sel_hi:[1,0]
    v_pk_mul_f32 v[26:27], v[22:23], v[84:85] op_sel_hi:[1,0]
    v_exp_f32 v24, v24
    v_exp_f32 v25, v25
    v_exp_f32 v26, v26
    v_exp_f32 v27, v27
    s_waitcnt lgkmcnt(0)
    v_pk_add_f32 v[36:37], v[36:37], v[40:41]
    v_pk_add_f32 v[44:45], v[44:45], v[48:49]
    v_pk_add_f32 v[38:39], v[38:39], v[42:43]
    v_pk_add_f32 v[46:47], v[46:47], v[50:51]
    v_pk_add_f32 v[36:37], v[36:37], v[44:45]
    v_pk_add_f32 v[38:39], v[38:39], v[46:47]
    v_pk_fma_f32 v[36:37], v[36:37], v[86:87], v[92:93] op_sel_hi:[1,0,1] neg_lo:[0,0,1] neg_hi:[0,0,1]
    v_pk_fma_f32 v[38:39], v[38:39], v[86:87], v[94:95] op_sel_hi:[1,0,1] neg_lo:[0,0,1] neg_hi:[0,0,1]
    v_pk_add_f32 v[24:25], v[24:25], 1.0 op_sel_hi:[1,0]
    v_pk_add_f32 v[26:27], v[26:27], 1.0 op_sel_hi:[1,0]
    v_rcp_f32 v24, v24
    v_rcp_f32 v25, v25
    v_rcp_f32 v26, v26
    v_rcp_f32 v27, v27
    v_pk_mul_f32 v[36:37], v[36:37], v[20:21]
    v_pk_mul_f32 v[38:39], v[38:39], v[22:23]
    v_pk_mul_f32 v[24:25], v[24:25], v[36:37]
    v_pk_mul_f32 v[26:27], v[26:27], v[38:39]
    v_cvt_pk_bf16_f32 v28, v24, v25
    v_cvt_pk_bf16_f32 v29, v26, v27
    s_nop 0
    v_mov_b32_dpp v100, v28 quad_perm:[0,1,2,3] row_mask:0xf bank_mask:0x3
    v_mov_b32_dpp v102, v28 row_ror:8 row_mask:0xf bank_mask:0x3
    v_mov_b32_dpp v101, v29 quad_perm:[0,1,2,3] row_mask:0xf bank_mask:0x3
    v_mov_b32_dpp v103, v29 row_ror:8 row_mask:0xf bank_mask:0x3
    v_mov_b32_dpp v104, v28 row_ror:8 row_mask:0xf bank_mask:0xc
    v_mov_b32_dpp v106, v28 quad_perm:[0,1,2,3] row_mask:0xf bank_mask:0xc
    v_mov_b32_dpp v105, v29 row_ror:8 row_mask:0xf bank_mask:0xc
    v_mov_b32_dpp v107, v29 quad_perm:[0,1,2,3] row_mask:0xf bank_mask:0xc
    s_waitcnt lgkmcnt(0)
    v_mfma_f32_16x16x32_bf16 v[116:119], v[52:55], v[100:103], 0
    v_mfma_f32_16x16x32_bf16 v[116:119], v[56:59], v[104:107], v[116:119]
    v_mfma_f32_16x16x32_bf16 v[120:123], v[60:63], v[100:103], 0
    v_mfma_f32_16x16x32_bf16 v[120:123], v[64:67], v[104:107], v[120:123]
    v_mfma_f32_16x16x32_bf16 v[108:111], v[68:71], v[100:103], 0
    v_mfma_f32_16x16x32_bf16 v[108:111], v[72:75], v[104:107], v[108:111]
    v_mfma_f32_16x16x32_bf16 v[112:115], v[76:79], v[100:103], 0
    v_mfma_f32_16x16x32_bf16 v[112:115], v[80:83], v[104:107], v[112:115]
    s_nop 1
    v_bfi_b32 v116, s38, v17, v116
    v_bfi_b32 v118, s38, v17, v118
    buffer_store_dwordx4 v[116:119], v13, s[12:15], s37 offen offset:0 sc1
    v_bfi_b32 v120, s38, v17, v120
    v_bfi_b32 v122, s38, v17, v122
    buffer_store_dwordx4 v[120:123], v13, s[12:15], s37 offen offset:128 sc1
    v_bfi_b32 v108, s38, v17, v108
    v_bfi_b32 v110, s38, v17, v110
    buffer_store_dwordx4 v[108:111], v13, s[12:15], s37 offen offset:256 sc1
    v_bfi_b32 v112, s38, v17, v112
    v_bfi_b32 v114, s38, v17, v114
    buffer_store_dwordx4 v[112:115], v13, s[12:15], s37 offen offset:384 sc1
L_moe_fin:
    s_endpgm
L_moe_redo:
    s_barrier
    s_barrier
    s_barrier
    s_branch L_moe_x
L_moe_sel:
    s_setprio 3
    s_sub_u32 s44, s30, 8
    v_mov_b32 v5, 0
    v_lshlrev_b32 v13, 2, v1
    s_lshl_b32 s45, s44, 5
    s_add_u32 s45, s45, 64
    v_add_u32 v12, s45, v13
    ds_write_b32 v13, v5 offset:320
    ds_write_b32 v5, v5 offset:9060
    s_mov_b64 exec, 0xff
    ds_write_b32 v12, v5
    s_mov_b64 exec, -1
    ds_write_b32 v5, v5 offset:9056
    s_waitcnt lgkmcnt(0)
    s_barrier
    s_add_u32 s28, s12, 0x250000
    s_addc_u32 s29, s13, 0
    s_load_dword s42, s[28:29], 0
    s_cmp_lg_u32 s44, 0
    s_cbranch_scc1 L_moe_ncp
    buffer_load_dword v7, v7, s[20:23], 0 offen
L_moe_ncp:
    s_mov_b32 s14, 0x1000000
    s_mov_b32 s15, 0x20000
    s_mov_b32 s6, 0x200000
    s_mov_b32 s7, 0x20000
    v_bfe_u32 v2, v0, 2, 7
    v_and_b32 v3, 3, v0
    v_lshlrev_b32 v4, 8, v2
    v_lshl_add_u32 v4, v3, 4, v4
    v_lshl_add_u32 v2, v3, 9, v2
    v_sub_u32 v8, 0x7ff, v2
    v_subrev_u32 v9, 128, v8
    v_subrev_u32 v10, 256, v8
    v_subrev_u32 v11, 384, v8
    s_lshl_b32 s40, s44, 2
    v_mov_b32 v14, s40
    v_mov_b32 v15, s45
    v_mov_b32 v6, 1
    v_lshlrev_b32 v16, 4, v1
    s_mov_b32 s46, 0
    s_mul_i32 s40, s44, 1056
    s_add_u32 s40, s40, 576
    s_mov_b32 m0, s40
    v_lshrrev_b32 v2, 4, v1
    v_lshl_add_u32 v17, v2, 3, s45
    v_lshrrev_b32 v2, 3, v1
    v_lshl_add_u32 v18, v2, 2, s45
    v_and_b32 v19, 7, v1
    v_lshlrev_b32 v19, 7, v19
    s_movk_i32 s47, 0x7ff
    s_mov_b32 s48, 0x00010001
    s_mov_b32 s49, 0x00010001
    s_lshl_b32 s40, s31, 2
    s_add_u32 s40, s40, 0
    s_lshl_b64 exec, 15, s40
    s_not_b64 s[50:51], exec
    s_mov_b32 s40, 0x242000
    s_mov_b32 s43, 0
    s_mov_b32 s41, 0xffff
    s_waitcnt lgkmcnt(0)
    s_add_u32 s42, s42, 1
L_moe_kp:
    buffer_load_dwordx4 v[20:23], v4, s[12:15], s40 offen sc1
    s_add_u32 s43, s43, 1
    s_cmp_gt_u32 s43, 0x40000
    s_waitcnt vmcnt(0)
    s_cbranch_scc1 L_moe_kp_d
    v_xor_b32 v26, s42, v20
    v_xor_b32 v27, s42, v21
    v_xor_b32 v28, s42, v22
    v_xor_b32 v29, s42, v23
    v_or3_b32 v24, v26, v27, v28
    v_or_b32 v24, v24, v29
    v_cmp_ne_u16 vcc, 0, v24
    s_mov_b64 exec, vcc
    s_cbranch_execnz L_moe_kp
    s_mov_b64 exec, s[50:51]
    s_mov_b64 s[50:51], 0
    s_cbranch_execnz L_moe_kp
L_moe_kp_d:
    s_mov_b64 exec, -1
    v_bfi_b32 v20, s41, v8, v20
    v_bfi_b32 v21, s41, v9, v21
    v_bfi_b32 v22, s41, v10, v22
    v_bfi_b32 v23, s41, v11, v23
    v_max3_u32 v34, v20, v21, v22
    v_med3_u32 v33, v20, v21, v22
    v_max_u32 v32, v34, v23
    v_med3_u32 v33, v34, v33, v23
    s_nop 0
    v_mov_b32_dpp v35, v32 row_ror:8 row_mask:0xf bank_mask:0xf
    v_max_u32_dpp v36, v33, v33 row_ror:8 row_mask:0xf bank_mask:0xf
    v_max_u32 v34, v32, v35
    v_med3_u32 v33, v32, v35, v36
    s_nop 0
    v_mov_b32_dpp v35, v34 row_ror:4 row_mask:0xf bank_mask:0xf
    v_max_u32_dpp v36, v33, v33 row_ror:4 row_mask:0xf bank_mask:0xf
    v_max_u32 v32, v34, v35
    v_med3_u32 v33, v34, v35, v36
    s_nop 0
    v_mov_b32_dpp v35, v32 row_ror:2 row_mask:0xf bank_mask:0xf
    v_max_u32_dpp v36, v33, v33 row_ror:2 row_mask:0xf bank_mask:0xf
    v_max_u32 v34, v32, v35
    v_med3_u32 v33, v32, v35, v36
    s_nop 0
    v_mov_b32_dpp v35, v34 row_ror:1 row_mask:0xf bank_mask:0xf
    v_max_u32_dpp v36, v33, v33 row_ror:1 row_mask:0xf bank_mask:0xf
    v_max_u32 v32, v34, v35
    v_med3_u32 v33, v34, v35, v36
    s_mov_b64 exec, s[48:49]
    ds_write_b64 v17, v[32:33]
    s_branch L_moe_cand
L_moe_slow:
    v_max3_u32 v24, v20, v21, v22
    v_max_u32 v24, v24, v23
    s_nop 1
    v_max_u32_dpp v24, v24, v24 row_ror:8 row_mask:0xf bank_mask:0xf
    s_nop 1
    v_max_u32_dpp v24, v24, v24 row_ror:4 row_mask:0xf bank_mask:0xf
    s_nop 1
    v_max_u32_dpp v24, v24, v24 row_ror:2 row_mask:0xf bank_mask:0xf
    s_nop 1
    v_max_u32_dpp v24, v24, v24 row_ror:1 row_mask:0xf bank_mask:0xf
    s_nop 1
    v_max_u32_dpp v24, v24, v24 row_bcast:15 row_mask:0xa bank_mask:0xf
    s_nop 1
    v_max_u32_dpp v24, v24, v24 row_bcast:31 row_mask:0xc bank_mask:0xf
    s_mov_b32 exec_lo, 0
    s_mov_b32 exec_hi, 0x80000000
    ds_write_b32 v14, v24 offset:0
    s_mov_b64 exec, -1
    s_waitcnt lgkmcnt(0)
    s_barrier
    ds_read_b128 v[32:35], v5 offset:0
    ds_read_b128 v[36:39], v5 offset:16
    ds_write_b32 v5, v5 offset:9056
    s_waitcnt lgkmcnt(0)
    v_min3_u32 v32, v32, v33, v34
    v_min3_u32 v35, v35, v36, v37
    v_min3_u32 v32, v32, v38, v39
    v_min_u32 v32, v32, v35
    v_cmp_ge_u32 s[52:53], v20, v32
    v_cmp_ge_u32 s[54:55], v21, v32
    v_cmp_ge_u32 s[56:57], v22, v32
    v_cmp_ge_u32 s[58:59], v23, v32
    s_bcnt1_i32_b64 s60, s[52:53]
    s_bcnt1_i32_b64 s61, s[54:55]
    s_bcnt1_i32_b64 s62, s[56:57]
    s_bcnt1_i32_b64 s63, s[58:59]
    s_add_u32 s61, s61, s60
    s_add_u32 s62, s62, s61
    s_add_u32 s63, s63, s62
    s_cmp_gt_u32 s63, 8
    s_cbranch_scc1 L_moe_many
    s_mov_b64 exec, s[52:53]
    s_cbranch_execz L_moe_c0
    v_mbcnt_lo_u32_b32 v33, exec_lo, 0
    v_mbcnt_hi_u32_b32 v33, exec_hi, v33
    v_lshl_add_u32 v33, v33, 2, s45
    ds_write_b32 v33, v20
L_moe_c0:
    s_mov_b64 exec, s[54:55]
    s_cbranch_execz L_moe_c1
    v_mbcnt_lo_u32_b32 v33, exec_lo, 0
    v_mbcnt_hi_u32_b32 v33, exec_hi, v33
    s_lshl2_add_u32 s41, s60, s45
    v_lshl_add_u32 v33, v33, 2, s41
    ds_write_b32 v33, v21
L_moe_c1:
    s_mov_b64 exec, s[56:57]
    s_cbranch_execz L_moe_c2
    v_mbcnt_lo_u32_b32 v33, exec_lo, 0
    v_mbcnt_hi_u32_b32 v33, exec_hi, v33
    s_lshl2_add_u32 s41, s61, s45
    v_lshl_add_u32 v33, v33, 2, s41
    ds_write_b32 v33, v22
L_moe_c2:
    s_mov_b64 exec, s[58:59]
    s_cbranch_execz L_moe_c3
    v_mbcnt_lo_u32_b32 v33, exec_lo, 0
    v_mbcnt_hi_u32_b32 v33, exec_hi, v33
    s_lshl2_add_u32 s41, s62, s45
    v_lshl_add_u32 v33, v33, 2, s41
    ds_write_b32 v33, v23
L_moe_c3:
L_moe_cand:
    s_mov_b64 exec, -1
    s_waitcnt lgkmcnt(0)
    s_barrier
    ds_read_b32 v25, v13 offset:64
    ds_read_b128 v[32:35], v15
    ds_read_b128 v[36:39], v15 offset:16
    v_mov_b32 v24, 0
    s_waitcnt lgkmcnt(0)
    v_cmp_gt_u32 s[52:53], v32, v25
    v_cmp_gt_u32 s[54:55], v33, v25
    v_cmp_gt_u32 s[56:57], v34, v25
    v_cmp_gt_u32 s[58:59], v35, v25
    v_addc_co_u32 v24, vcc, 0, v24, s[52:53]
    v_addc_co_u32 v24, vcc, 0, v24, s[54:55]
    v_addc_co_u32 v24, vcc, 0, v24, s[56:57]
    v_addc_co_u32 v24, vcc, 0, v24, s[58:59]
    v_cmp_gt_u32 s[52:53], v36, v25
    v_cmp_gt_u32 s[54:55], v37, v25
    v_cmp_gt_u32 s[56:57], v38, v25
    v_cmp_gt_u32 s[58:59], v39, v25
    v_addc_co_u32 v24, vcc, 0, v24, s[52:53]
    v_addc_co_u32 v24, vcc, 0, v24, s[54:55]
    v_addc_co_u32 v24, vcc, 0, v24, s[56:57]
    v_addc_co_u32 v24, vcc, 0, v24, s[58:59]
    ds_add_u32 v13, v24 offset:320
    s_mov_b64 exec, 1
    ds_add_u32 v5, v6 offset:9060
    s_mov_b64 exec, -1
    s_mov_b32 s43, 0
L_moe_w3:
    ds_read_b32 v2, v5 offset:9060
    ds_read_b32 v24, v13 offset:320
    s_add_u32 s43, s43, 1
    s_cmp_gt_u32 s43, 0x100000
    s_waitcnt lgkmcnt(0)
    s_cbranch_scc1 L_moe_w3_d
    v_cmp_gt_u32 vcc, 8, v2
    s_cbranch_vccnz L_moe_w3
L_moe_w3_d:
    v_cmp_eq_u32 vcc, s44, v24
    s_ff1_i32_b64 s40, vcc
    s_and_b32 s40, s40, 63
    v_readlane_b32 s40, v25, s40
    v_cmp_eq_u32 s[52:53], 7, v24
    v_cmp_gt_u32 s[54:55], 8, v24
    s_andn2_b32 s40, 0x7ff, s40
    s_lshl_b32 s41, s40, 10
    s_and_b32 s60, s40, 127
    buffer_load_dwordx4 v16, s[4:7], s41 offen lds
    s_lshl_b32 s60, s60, 8
    s_lshr_b32 s40, s40, 7
    s_lshl3_add_u32 s40, s40, s60
    s_add_u32 s40, s40, 0x242080
    s_mov_b32 s43, 0
    buffer_load_dwordx2 v[30:31], v5, s[12:15], s40 offen sc1
    s_cmp_lg_u32 s46, 0
    s_cbranch_scc1 L_moe_nv
    s_ff1_i32_b64 s41, s[52:53]
    s_and_b32 s41, s41, 63
    v_readlane_b32 s41, v25, s41
    s_lshl_b32 s60, s44, 3
    s_lshr_b64 s[54:55], s[54:55], s60
    s_and_b32 s60, s54, 0xff
    s_bcnt1_i32_b32 s60, s60
    v_cmp_le_u32 vcc, s41, v20
    s_bcnt1_i32_b64 s61, vcc
    s_sub_u32 s60, s60, s61
    v_cmp_le_u32 vcc, s41, v21
    s_bcnt1_i32_b64 s61, vcc
    s_sub_u32 s60, s60, s61
    v_cmp_le_u32 vcc, s41, v22
    s_bcnt1_i32_b64 s61, vcc
    s_sub_u32 s60, s60, s61
    v_cmp_le_u32 vcc, s41, v23
    s_bcnt1_i32_b64 s61, vcc
    s_sub_u32 s60, s60, s61
    s_cmp_eq_u32 s60, 0
    s_cbranch_scc1 L_moe_nv
    ds_write_b32 v5, v6 offset:9056
L_moe_nv:
    s_waitcnt vmcnt(0)
    s_branch L_moe_sp_c
L_moe_sp:
    buffer_load_dwordx2 v[30:31], v5, s[12:15], s40 offen sc1
    s_add_u32 s43, s43, 1
    s_cmp_gt_u32 s43, 0x40000
    s_waitcnt vmcnt(0)
    s_cbranch_scc1 L_moe_sp_d
L_moe_sp_c:
    v_cmp_ne_u32 vcc, s42, v31
    s_cbranch_vccnz L_moe_sp
L_moe_sp_d:
    ds_write_b32 v14, v30 offset:9024
    s_waitcnt lgkmcnt(0)
    s_barrier
    s_cmp_lg_u32 s46, 0
    s_cbranch_scc1 L_moe_sfin
    ds_read_b32 v2, v5 offset:9056
    s_waitcnt lgkmcnt(0)
    v_cmp_ne_u32 vcc, 0, v2
    s_cbranch_vccz L_moe_sfin
    s_mov_b32 s46, 1
    ds_write_b32 v13, v5 offset:320
    ds_write_b32 v5, v5 offset:9060
    s_mov_b64 exec, 0xff
    ds_write_b32 v12, v5
    s_mov_b64 exec, -1
    s_branch L_moe_slow
L_moe_sfin:
    s_endpgm
L_moe_many:
    s_mov_b32 s60, 0
    s_mov_b32 s61, 1
L_moe_mloop:
    v_subrev_u32 v33, s60, v20
    v_subrev_u32 v34, s60, v21
    v_subrev_u32 v35, s60, v22
    v_subrev_u32 v36, s60, v23
    v_max3_u32 v24, v33, v34, v35
    v_max_u32 v24, v24, v36
    s_nop 1
    v_max_u32_dpp v24, v24, v24 row_ror:8 row_mask:0xf bank_mask:0xf
    s_nop 1
    v_max_u32_dpp v24, v24, v24 row_ror:4 row_mask:0xf bank_mask:0xf
    s_nop 1
    v_max_u32_dpp v24, v24, v24 row_ror:2 row_mask:0xf bank_mask:0xf
    s_nop 1
    v_max_u32_dpp v24, v24, v24 row_ror:1 row_mask:0xf bank_mask:0xf
    s_nop 1
    v_max_u32_dpp v24, v24, v24 row_bcast:15 row_mask:0xa bank_mask:0xf
    s_nop 1
    v_max_u32_dpp v24, v24, v24 row_bcast:31 row_mask:0xc bank_mask:0xf
    s_nop 0
    v_readlane_b32 s40, v24, 63
    s_add_u32 s60, s60, s40
    s_mov_b32 exec_lo, s61
    s_mov_b32 exec_hi, 0
    v_mov_b32 v37, s60
    s_mov_b64 exec, -1
    s_lshl_b32 s61, s61, 1
    s_cmp_lt_u32 s61, 256
    s_cbranch_scc1 L_moe_mloop
    s_mov_b64 exec, 0xff
    ds_write_b32 v12, v37
    s_branch L_moe_cand
L_ag:
    s_setprio 3
    s_load_dwordx2 s[4:5], s[0:1], 96
    v_and_b32 v1, 63, v0
    v_lshrrev_b32 v2, 6, v0
    s_getpc_b64 s[8:9]
    s_mov_b32 s10, 0x10000
    s_mov_b32 s11, 0x20000
    v_lshlrev_b32 v6, 6, v1
    v_readfirstlane_b32 s14, v2
    s_cmp_gt_u32 s14, 7
    s_cbranch_scc1 L_exit
    s_cmp_lg_u32 s14, 0
    s_cbranch_scc1 L_ag_ncp
    buffer_load_dword v6, v6, s[8:11], 0 offen
L_ag_ncp:
    s_waitcnt lgkmcnt(0)
    s_add_u32 s12, s4, 0x250000
    s_addc_u32 s13, s5, 0
    s_load_dword s17, s[12:13], 0
    s_mov_b32 s6, 0x1000000
    s_mov_b32 s7, 0x20000
    v_mov_b32 v5, 0
    v_lshrrev_b32 v2, 2, v0
    v_and_b32 v3, 3, v0
    v_lshlrev_b32 v4, 8, v2
    v_lshl_add_u32 v4, v3, 4, v4
    v_lshl_add_u32 v2, v3, 9, v2
    v_sub_u32 v8, 0x7ff, v2
    v_subrev_u32 v9, 128, v8
    v_subrev_u32 v10, 256, v8
    v_subrev_u32 v11, 384, v8
    v_lshlrev_b32 v12, 2, v1
    s_lshl_b32 s15, s14, 5
    s_add_u32 s15, s15, 64
    v_add_u32 v7, s15, v12
    s_mov_b64 exec, 0xff
    ds_write_b32 v7, v5
    s_mov_b64 exec, -1
    ds_write_b32 v12, v5 offset:576
    v_mov_b32 v16, s15
    s_lshl_b32 s19, s14, 5
    s_add_u32 s19, s19, 320
    v_and_b32 v3, 7, v1
    v_lshl_add_u32 v14, v3, 2, s19
    s_lshl_b32 s15, s14, 2
    v_mov_b32 v13, s15
    v_lshrrev_b32 v2, 3, v1
    v_lshlrev_b32 v2, 7, v2
    v_lshl_add_u32 v15, v3, 3, v2
    s_waitcnt lgkmcnt(0)
    s_add_u32 s17, s17, 1
    v_mov_b32 v19, s17
    s_mov_b32 s15, 0x242000
    s_mov_b32 s18, 0
    s_mov_b32 s16, 0xffff
L_ag_poll:
    buffer_load_dwordx4 v[20:23], v4, s[4:7], s15 offen sc1
    s_add_u32 s18, s18, 1
    s_cmp_gt_u32 s18, 0x40000
    s_waitcnt vmcnt(0)
    s_cbranch_scc1 L_ag_poll_d
    v_xor_b32 v24, s17, v20
    v_xor_b32 v25, s17, v21
    v_xor_b32 v26, s17, v22
    v_xor_b32 v27, s17, v23
    v_or3_b32 v17, v24, v25, v26
    v_or_b32 v17, v17, v27
    v_cmp_ne_u16 vcc, 0, v17
    s_mov_b64 exec, vcc
    s_cbranch_execnz L_ag_poll
L_ag_poll_d:
    s_mov_b64 exec, -1
    v_bfi_b32 v20, s16, v8, v20
    v_bfi_b32 v21, s16, v9, v21
    v_bfi_b32 v22, s16, v10, v22
    v_bfi_b32 v23, s16, v11, v23
    v_max3_u32 v17, v20, v21, v22
    v_max_u32 v17, v17, v23
    s_nop 1
    v_max_u32_dpp v17, v17, v17 row_ror:8 row_mask:0xf bank_mask:0xf
    s_nop 1
    v_max_u32_dpp v17, v17, v17 row_ror:4 row_mask:0xf bank_mask:0xf
    s_nop 1
    v_max_u32_dpp v17, v17, v17 row_ror:2 row_mask:0xf bank_mask:0xf
    s_nop 1
    v_max_u32_dpp v17, v17, v17 row_ror:1 row_mask:0xf bank_mask:0xf
    s_nop 1
    v_max_u32_dpp v17, v17, v17 row_bcast:15 row_mask:0xa bank_mask:0xf
    s_nop 1
    v_max_u32_dpp v17, v17, v17 row_bcast:31 row_mask:0xc bank_mask:0xf
    s_mov_b32 exec_lo, 0
    s_mov_b32 exec_hi, 0x80000000
    ds_write_b32 v13, v17 offset:0
    s_mov_b64 exec, -1
    s_waitcnt lgkmcnt(0)
    s_barrier
    ds_read_b128 v[28:31], v5 offset:0
    ds_read_b128 v[32:35], v5 offset:16
    s_sub_u32 s15, s19, 256
    s_waitcnt lgkmcnt(0)
    v_min3_u32 v28, v28, v29, v30
    v_min3_u32 v31, v31, v32, v33
    v_min3_u32 v28, v28, v34, v35
    v_min_u32 v28, v28, v31
    v_cmp_ge_u32 s[22:23], v20, v28
    v_cmp_ge_u32 s[24:25], v21, v28
    v_cmp_ge_u32 s[26:27], v22, v28
    v_cmp_ge_u32 s[28:29], v23, v28
    s_bcnt1_i32_b64 s30, s[22:23]
    s_bcnt1_i32_b64 s31, s[24:25]
    s_bcnt1_i32_b64 s32, s[26:27]
    s_bcnt1_i32_b64 s33, s[28:29]
    s_add_u32 s31, s31, s30
    s_add_u32 s32, s32, s31
    s_add_u32 s33, s33, s32
    s_cmp_gt_u32 s33, 8
    s_cbranch_scc1 L_ag_many
    s_mov_b64 exec, s[22:23]
    s_cbranch_execz L_ag_c0
    v_mbcnt_lo_u32_b32 v29, exec_lo, 0
    v_mbcnt_hi_u32_b32 v29, exec_hi, v29
    v_lshl_add_u32 v29, v29, 2, s15
    ds_write_b32 v29, v20
L_ag_c0:
    s_mov_b64 exec, s[24:25]
    s_cbranch_execz L_ag_c1
    v_mbcnt_lo_u32_b32 v29, exec_lo, 0
    v_mbcnt_hi_u32_b32 v29, exec_hi, v29
    s_lshl2_add_u32 s16, s30, s15
    v_lshl_add_u32 v29, v29, 2, s16
    ds_write_b32 v29, v21
L_ag_c1:
    s_mov_b64 exec, s[26:27]
    s_cbranch_execz L_ag_c2
    v_mbcnt_lo_u32_b32 v29, exec_lo, 0
    v_mbcnt_hi_u32_b32 v29, exec_hi, v29
    s_lshl2_add_u32 s16, s31, s15
    v_lshl_add_u32 v29, v29, 2, s16
    ds_write_b32 v29, v22
L_ag_c2:
    s_mov_b64 exec, s[28:29]
    s_cbranch_execz L_ag_c3
    v_mbcnt_lo_u32_b32 v29, exec_lo, 0
    v_mbcnt_hi_u32_b32 v29, exec_hi, v29
    s_lshl2_add_u32 s16, s32, s15
    v_lshl_add_u32 v29, v29, 2, s16
    ds_write_b32 v29, v23
L_ag_c3:
    s_mov_b64 exec, -1
L_ag_cand:
    s_waitcnt lgkmcnt(0)
    s_barrier
    ds_read_b32 v20, v12 offset:64
    ds_read_b128 v[28:31], v16
    ds_read_b128 v[32:35], v16 offset:16
    v_mov_b32 v17, 0
    s_waitcnt lgkmcnt(0)
    v_cmp_gt_u32 s[22:23], v28, v20
    v_cmp_gt_u32 s[24:25], v29, v20
    v_cmp_gt_u32 s[26:27], v30, v20
    v_cmp_gt_u32 s[28:29], v31, v20
    v_addc_co_u32 v17, vcc, 0, v17, s[22:23]
    v_addc_co_u32 v17, vcc, 0, v17, s[24:25]
    v_addc_co_u32 v17, vcc, 0, v17, s[26:27]
    v_addc_co_u32 v17, vcc, 0, v17, s[28:29]
    v_cmp_gt_u32 s[22:23], v32, v20
    v_cmp_gt_u32 s[24:25], v33, v20
    v_cmp_gt_u32 s[26:27], v34, v20
    v_cmp_gt_u32 s[28:29], v35, v20
    v_addc_co_u32 v17, vcc, 0, v17, s[22:23]
    v_addc_co_u32 v17, vcc, 0, v17, s[24:25]
    v_addc_co_u32 v17, vcc, 0, v17, s[26:27]
    v_addc_co_u32 v17, vcc, 0, v17, s[28:29]
    ds_add_u32 v12, v17 offset:576
    s_cmp_lg_u32 s14, 0
    s_waitcnt lgkmcnt(0)
    s_barrier
    s_cbranch_scc1 L_ag_fin
    ds_read_b32 v2, v12 offset:576
    s_waitcnt lgkmcnt(0)
    v_cmp_gt_u32 vcc, 8, v2
    v_lshl_add_u32 v2, v2, 2, s19
    s_mov_b64 exec, vcc
    ds_write_b32 v2, v20
    s_mov_b64 exec, -1
    ds_read_b32 v18, v14
    s_mov_b32 s15, 0x254000
    s_waitcnt lgkmcnt(0)
    buffer_store_dwordx2 v[18:19], v15, s[4:7], s15 offen sc1
    buffer_store_dwordx2 v[18:19], v15, s[4:7], s15 offen offset:1024 sc1
L_ag_fin:
    s_endpgm
L_ag_many:
    s_mov_b32 s30, 0
    s_mov_b32 s31, 1
L_ag_mloop:
    v_subrev_u32 v29, s30, v20
    v_subrev_u32 v30, s30, v21
    v_subrev_u32 v31, s30, v22
    v_subrev_u32 v32, s30, v23
    v_max3_u32 v17, v29, v30, v31
    v_max_u32 v17, v17, v32
    s_nop 1
    v_max_u32_dpp v17, v17, v17 row_ror:8 row_mask:0xf bank_mask:0xf
    s_nop 1
    v_max_u32_dpp v17, v17, v17 row_ror:4 row_mask:0xf bank_mask:0xf
    s_nop 1
    v_max_u32_dpp v17, v17, v17 row_ror:2 row_mask:0xf bank_mask:0xf
    s_nop 1
    v_max_u32_dpp v17, v17, v17 row_ror:1 row_mask:0xf bank_mask:0xf
    s_nop 1
    v_max_u32_dpp v17, v17, v17 row_bcast:15 row_mask:0xa bank_mask:0xf
    s_nop 1
    v_max_u32_dpp v17, v17, v17 row_bcast:31 row_mask:0xc bank_mask:0xf
    s_nop 0
    v_readlane_b32 s15, v17, 63
    s_add_u32 s30, s30, s15
    s_mov_b32 exec_lo, s31
    s_mov_b32 exec_hi, 0
    v_mov_b32 v33, s30
    s_mov_b64 exec, -1
    s_lshl_b32 s31, s31, 1
    s_cmp_lt_u32 s31, 256
    s_cbranch_scc1 L_ag_mloop
    s_mov_b64 exec, 0xff
    ds_write_b32 v7, v33
    s_mov_b64 exec, -1
    s_branch L_ag_cand
L_pf:
    s_load_dwordx4 s[8:11], s[0:1], 56
    s_load_dwordx2 s[12:13], s[0:1], 72
    v_lshrrev_b32 v2, 6, v0
    v_and_b32 v1, 63, v0
    s_and_b32 s17, s2, 7
    s_sub_u32 s18, s2, 192
    s_lshr_b32 s18, s18, 3
    v_readfirstlane_b32 s14, v2
    s_cmp_gt_u32 s14, 11
    s_cbranch_scc1 L_exit
    s_mov_b32 s6, 1835008
    s_mov_b32 s7, 0x20000
    s_and_b32 s15, s14, 3
    s_lshl2_add_u32 s15, s18, s15
    s_cmp_gt_u32 s14, 7
    s_cbranch_scc1 L_pf_d
    v_lshrrev_b32 v2, 2, v1
    v_mul_u32_u24 v2, 3584, v2
    v_and_b32 v3, 3, v1
    v_lshl_add_u32 v4, v3, 7, v2
    s_mul_i32 s15, s15, 57344
    s_mul_i32 s17, s17, 448
    s_andn2_b32 s17, s17, 127
    s_add_u32 s15, s15, s17
    s_cmp_lt_u32 s14, 4
    s_waitcnt lgkmcnt(0)
    s_cselect_b32 s4, s8, s10
    s_cselect_b32 s5, s9, s11
    s_branch L_pf_j
L_pf_d:
    v_min_u32 v2, 55, v1
    v_lshlrev_b32 v4, 7, v2
    s_lshl_b32 s17, s17, 5
    s_add_u32 s15, s15, s17
    s_mul_i32 s15, s15, 7168
    s_waitcnt lgkmcnt(0)
    s_mov_b32 s4, s12
    s_mov_b32 s5, s13
L_pf_j:
    s_cmp_gt_u32 s14, 7
    s_cbranch_scc1 L_pf_l
    buffer_load_dword v2, v4, s[4:7], s15 offen
    s_waitcnt vmcnt(0)
    s_barrier
    s_endpgm
L_pf_l:
    s_barrier
    buffer_load_dword v2, v4, s[4:7], s15 offen
    s_endpgm

.p2align 8
.type T_fft,@object
T_fft:
.long 0x3f803f80,0x3f803f80,0x3f803f80,0x3f803f80,0x3f6d3f80,0x3ec43f35,0x3f6d3f80,0x3ec43f35
.long 0x3f353f80,0xbf350000,0x3f353f80,0xbf350000,0x3ec43f80,0xbf6dbf35,0x3ec43f80,0xbf6dbf35
.long 0x3f80,0xbf80,0x3f80,0xbf80,0xbec43f80,0x3f6dbf35,0xbec43f80,0x3f6dbf35
.long 0xbf353f80,0x3f350000,0xbf353f80,0x3f350000,0xbf6d3f80,0xbec43f35,0xbf6d3f80,0xbec43f35
.long 0xbf803f80,0xbf803f80,0xbf803f80,0xbf803f80,0xbf6d3f80,0xbec43f35,0xbf6d3f80,0xbec43f35
.long 0xbf353f80,0x3f350000,0xbf353f80,0x3f350000,0xbec43f80,0x3f6dbf35,0xbec43f80,0x3f6dbf35
.long 0x3f80,0xbf80,0x3f80,0xbf80,0x3ec43f80,0xbf6dbf35,0x3ec43f80,0xbf6dbf35
.long 0x3f353f80,0xbf350000,0x3f353f80,0xbf350000,0x3f6d3f80,0x3ec43f35,0x3f6d3f80,0x3ec43f35
.long 0x3f803f80,0x3f803f80,0x3f803f80,0x3f803f80,0xbec40000,0xbf6dbf35,0xbec40000,0xbf6dbf35
.long 0xbf35bf80,0x3f350000,0xbf35bf80,0x3f350000,0x3f6d0000,0xbec43f35,0x3f6d0000,0xbec43f35
.long 0x3f80,0xbf80,0x3f80,0xbf80,0xbf6d0000,0x3ec43f35,0xbf6d0000,0x3ec43f35
.long 0x3f35bf80,0xbf350000,0x3f35bf80,0xbf350000,0x3ec40000,0x3f6dbf35,0x3ec40000,0x3f6dbf35
.long 0xbf803f80,0xbf803f80,0xbf803f80,0xbf803f80,0x3ec40000,0x3f6dbf35,0x3ec40000,0x3f6dbf35
.long 0x3f35bf80,0xbf350000,0x3f35bf80,0xbf350000,0xbf6d0000,0x3ec43f35,0xbf6d0000,0x3ec43f35
.long 0x3f80,0xbf80,0x3f80,0xbf80,0x3f6d0000,0xbec43f35,0x3f6d0000,0xbec43f35
.long 0xbf35bf80,0x3f350000,0xbf35bf80,0x3f350000,0xbec40000,0xbf6dbf35,0xbec40000,0xbf6dbf35
.long 0x3f803f80,0x3f803f80,0x3f803f80,0x3f803f80,0xbf6dbf80,0xbec4bf35,0xbf6dbf80,0xbec4bf35
.long 0x3f353f80,0xbf350000,0x3f353f80,0xbf350000,0xbec4bf80,0x3f6d3f35,0xbec4bf80,0x3f6d3f35
.long 0x3f80,0xbf80,0x3f80,0xbf80,0x3ec4bf80,0xbf6d3f35,0x3ec4bf80,0xbf6d3f35
.long 0xbf353f80,0x3f350000,0xbf353f80,0x3f350000,0x3f6dbf80,0x3ec4bf35,0x3f6dbf80,0x3ec4bf35
.long 0xbf803f80,0xbf803f80,0xbf803f80,0xbf803f80,0x3f6dbf80,0x3ec4bf35,0x3f6dbf80,0x3ec4bf35
.long 0xbf353f80,0x3f350000,0xbf353f80,0x3f350000,0x3ec4bf80,0xbf6d3f35,0x3ec4bf80,0xbf6d3f35
.long 0x3f80,0xbf80,0x3f80,0xbf80,0xbec4bf80,0x3f6d3f35,0xbec4bf80,0x3f6d3f35
.long 0x3f353f80,0xbf350000,0x3f353f80,0xbf350000,0xbf6dbf80,0xbec4bf35,0xbf6dbf80,0xbec4bf35
.long 0x3f803f80,0x3f803f80,0x3f803f80,0x3f803f80,0x3ec40000,0x3f6d3f35,0x3ec40000,0x3f6d3f35
.long 0xbf35bf80,0x3f350000,0xbf35bf80,0x3f350000,0xbf6d0000,0x3ec4bf35,0xbf6d0000,0x3ec4bf35
.long 0x3f80,0xbf80,0x3f80,0xbf80,0x3f6d0000,0xbec4bf35,0x3f6d0000,0xbec4bf35
.long 0x3f35bf80,0xbf350000,0x3f35bf80,0xbf350000,0xbec40000,0xbf6d3f35,0xbec40000,0xbf6d3f35
.long 0xbf803f80,0xbf803f80,0xbf803f80,0xbf803f80,0xbec40000,0xbf6d3f35,0xbec40000,0xbf6d3f35
.long 0x3f35bf80,0xbf350000,0x3f35bf80,0xbf350000,0x3f6d0000,0xbec4bf35,0x3f6d0000,0xbec4bf35
.long 0x3f80,0xbf80,0x3f80,0xbf80,0xbf6d0000,0x3ec4bf35,0xbf6d0000,0x3ec4bf35
.long 0xbf35bf80,0x3f350000,0xbf35bf80,0x3f350000,0x3ec40000,0x3f6d3f35,0x3ec40000,0x3f6d3f35
.long 0x80008000,0x80008000,0x80008000,0x80008000,0xbec48000,0xbf6dbf35,0xbec48000,0xbf6dbf35
.long 0xbf358000,0xbf35bf80,0xbf358000,0xbf35bf80,0xbf6d8000,0x3ec4bf35,0xbf6d8000,0x3ec4bf35
.long 0xbf808000,0x3f808000,0xbf808000,0x3f808000,0xbf6d8000,0x3ec43f35,0xbf6d8000,0x3ec43f35
.long 0xbf358000,0xbf353f80,0xbf358000,0xbf353f80,0xbec48000,0xbf6d3f35,0xbec48000,0xbf6d3f35
.long 0x80008000,0x80008000,0x80008000,0x80008000,0x3ec48000,0x3f6dbf35,0x3ec48000,0x3f6dbf35
.long 0x3f358000,0x3f35bf80,0x3f358000,0x3f35bf80,0x3f6d8000,0xbec4bf35,0x3f6d8000,0xbec4bf35
.long 0x3f808000,0xbf808000,0x3f808000,0xbf808000,0x3f6d8000,0xbec43f35,0x3f6d8000,0xbec43f35
.long 0x3f358000,0x3f353f80,0x3f358000,0x3f353f80,0x3ec48000,0x3f6d3f35,0x3ec48000,0x3f6d3f35
.long 0x80008000,0x80008000,0x80008000,0x80008000,0xbf6dbf80,0xbec4bf35,0xbf6dbf80,0xbec4bf35
.long 0x3f358000,0x3f353f80,0x3f358000,0x3f353f80,0x3ec43f80,0xbf6dbf35,0x3ec43f80,0xbf6dbf35
.long 0xbf808000,0x3f808000,0xbf808000,0x3f808000,0x3ec4bf80,0xbf6d3f35,0x3ec4bf80,0xbf6d3f35
.long 0x3f358000,0x3f35bf80,0x3f358000,0x3f35bf80,0xbf6d3f80,0xbec43f35,0xbf6d3f80,0xbec43f35
.long 0x80008000,0x80008000,0x80008000,0x80008000,0x3f6dbf80,0x3ec4bf35,0x3f6dbf80,0x3ec4bf35
.long 0xbf358000,0xbf353f80,0xbf358000,0xbf353f80,0xbec43f80,0x3f6dbf35,0xbec43f80,0x3f6dbf35
.long 0x3f808000,0xbf808000,0x3f808000,0xbf808000,0xbec4bf80,0x3f6d3f35,0xbec4bf80,0x3f6d3f35
.long 0xbf358000,0xbf35bf80,0xbf358000,0xbf35bf80,0x3f6d3f80,0x3ec43f35,0x3f6d3f80,0x3ec43f35
.long 0x80008000,0x80008000,0x80008000,0x80008000,0x3ec48000,0x3f6d3f35,0x3ec48000,0x3f6d3f35
.long 0xbf358000,0xbf35bf80,0xbf358000,0xbf35bf80,0x3f6d8000,0xbec43f35,0x3f6d8000,0xbec43f35
.long 0xbf808000,0x3f808000,0xbf808000,0x3f808000,0x3f6d8000,0xbec4bf35,0x3f6d8000,0xbec4bf35
.long 0xbf358000,0xbf353f80,0xbf358000,0xbf353f80,0x3ec48000,0x3f6dbf35,0x3ec48000,0x3f6dbf35
.long 0x80008000,0x80008000,0x80008000,0x80008000,0xbec48000,0xbf6d3f35,0xbec48000,0xbf6d3f35
.long 0x3f358000,0x3f35bf80,0x3f358000,0x3f35bf80,0xbf6d8000,0x3ec43f35,0xbf6d8000,0x3ec43f35
.long 0x3f808000,0xbf808000,0x3f808000,0xbf808000,0xbf6d8000,0x3ec4bf35,0xbf6d8000,0x3ec4bf35
.long 0x3f358000,0x3f353f80,0x3f358000,0x3f353f80,0xbec48000,0xbf6dbf35,0xbec48000,0xbf6dbf35
.long 0x80008000,0x80008000,0x80008000,0x80008000,0x3f6d3f80,0x3ec43f35,0x3f6d3f80,0x3ec43f35
.long 0x3f358000,0x3f353f80,0x3f358000,0x3f353f80,0xbec4bf80,0x3f6d3f35,0xbec4bf80,0x3f6d3f35
.long 0xbf808000,0x3f808000,0xbf808000,0x3f808000,0xbec43f80,0x3f6dbf35,0xbec43f80,0x3f6dbf35
.long 0x3f358000,0x3f35bf80,0x3f358000,0x3f35bf80,0x3f6dbf80,0x3ec4bf35,0x3f6dbf80,0x3ec4bf35
.long 0x80008000,0x80008000,0x80008000,0x80008000,0xbf6d3f80,0xbec43f35,0xbf6d3f80,0xbec43f35
.long 0xbf358000,0xbf353f80,0xbf358000,0xbf353f80,0x3ec4bf80,0xbf6d3f35,0x3ec4bf80,0xbf6d3f35
.long 0x3f808000,0xbf808000,0x3f808000,0xbf808000,0x3ec43f80,0xbf6dbf35,0x3ec43f80,0xbf6dbf35
.long 0xbf358000,0xbf35bf80,0xbf358000,0xbf35bf80,0xbf6dbf80,0xbec4bf35,0xbf6dbf80,0xbec4bf35
.long 0x3f7b3f80,0x3f553f6d,0xbf7bbf80,0xbf55bf6d,0x3f553f80,0xbe483ec4,0xbf55bf80,0x3e48bec4
.long 0x3f0e3f80,0xbf7bbec4,0xbf0ebf80,0x3f7b3ec4,0x3e483f80,0xbf0ebf6d,0xbe48bf80,0x3f0e3f6d
.long 0xbe483f80,0x3f0ebf6d,0x3e48bf80,0xbf0e3f6d,0xbf0e3f80,0x3f7bbec4,0x3f0ebf80,0xbf7b3ec4
.long 0xbf553f80,0x3e483ec4,0x3f55bf80,0xbe48bec4,0xbf7b3f80,0xbf553f6d,0x3f7bbf80,0x3f55bf6d
.long 0xbf7b3f80,0xbf553f6d,0x3f7bbf80,0x3f55bf6d,0xbf553f80,0x3e483ec4,0x3f55bf80,0xbe48bec4
.long 0xbf0e3f80,0x3f7bbec4,0x3f0ebf80,0xbf7b3ec4,0xbe483f80,0x3f0ebf6d,0x3e48bf80,0xbf0e3f6d
.long 0x3e483f80,0xbf0ebf6d,0xbe48bf80,0x3f0e3f6d,0x3f0e3f80,0xbf7bbec4,0xbf0ebf80,0x3f7b3ec4
.long 0x3f553f80,0xbe483ec4,0xbf55bf80,0x3e48bec4,0x3f7b3f80,0x3f553f6d,0xbf7bbf80,0xbf55bf6d
.long 0x3f0e3f35,0x3e483ec4,0xbf0ebf35,0xbe48bec4,0xbf7bbf35,0xbf0ebf6d,0x3f7b3f35,0x3f0e3f6d
.long 0x3e48bf35,0x3f553f6d,0xbe483f35,0xbf55bf6d,0x3f553f35,0xbf7bbec4,0xbf55bf35,0x3f7b3ec4
.long 0xbf553f35,0x3f7bbec4,0x3f55bf35,0xbf7b3ec4,0xbe48bf35,0xbf553f6d,0x3e483f35,0x3f55bf6d
.long 0x3f7bbf35,0x3f0ebf6d,0xbf7b3f35,0xbf0e3f6d,0xbf0e3f35,0xbe483ec4,0x3f0ebf35,0x3e48bec4
.long 0xbf0e3f35,0xbe483ec4,0x3f0ebf35,0x3e48bec4,0x3f7bbf35,0x3f0ebf6d,0xbf7b3f35,0xbf0e3f6d
.long 0xbe48bf35,0xbf553f6d,0x3e483f35,0x3f55bf6d,0xbf553f35,0x3f7bbec4,0x3f55bf35,0xbf7b3ec4
.long 0x3f553f35,0xbf7bbec4,0xbf55bf35,0x3f7b3ec4,0x3e48bf35,0x3f553f6d,0xbe483f35,0xbf55bf6d
.long 0xbf7bbf35,0xbf0ebf6d,0x3f7b3f35,0x3f0e3f6d,0x3f0e3f35,0x3e483ec4,0xbf0ebf35,0xbe48bec4
.long 0xbe480000,0xbf0ebec4,0x3e480000,0x3f0e3ec4,0x3f0e0000,0x3f7b3f6d,0xbf0e0000,0xbf7bbf6d
.long 0xbf550000,0xbe48bf6d,0x3f550000,0x3e483f6d,0x3f7b0000,0xbf553ec4,0xbf7b0000,0x3f55bec4
.long 0xbf7b0000,0x3f553ec4,0x3f7b0000,0xbf55bec4,0x3f550000,0x3e48bf6d,0xbf550000,0xbe483f6d
.long 0xbf0e0000,0xbf7b3f6d,0x3f0e0000,0x3f7bbf6d,0x3e480000,0x3f0ebec4,0xbe480000,0xbf0e3ec4
.long 0x3e480000,0x3f0ebec4,0xbe480000,0xbf0e3ec4,0xbf0e0000,0xbf7b3f6d,0x3f0e0000,0x3f7bbf6d
.long 0x3f550000,0x3e48bf6d,0xbf550000,0xbe483f6d,0xbf7b0000,0x3f553ec4,0x3f7b0000,0xbf55bec4
.long 0x3f7b0000,0xbf553ec4,0xbf7b0000,0x3f55bec4,0xbf550000,0xbe48bf6d,0x3f550000,0x3e483f6d
.long 0x3f0e0000,0x3f7b3f6d,0xbf0e0000,0xbf7bbf6d,0xbe480000,0xbf0ebec4,0x3e480000,0x3f0e3ec4
.long 0xbf55bf35,0xbf7bbf6d,0x3f553f35,0x3f7b3f6d,0x3e483f35,0xbf55bec4,0xbe48bf35,0x3f553ec4
.long 0x3f7b3f35,0xbf0e3ec4,0xbf7bbf35,0x3f0ebec4,0x3f0ebf35,0xbe483f6d,0xbf0e3f35,0x3e48bf6d
.long 0xbf0ebf35,0x3e483f6d,0x3f0e3f35,0xbe48bf6d,0xbf7b3f35,0x3f0e3ec4,0x3f7bbf35,0xbf0ebec4
.long 0xbe483f35,0x3f55bec4,0x3e48bf35,0xbf553ec4,0x3f55bf35,0x3f7bbf6d,0xbf553f35,0xbf7b3f6d
.long 0x3f55bf35,0x3f7bbf6d,0xbf553f35,0xbf7b3f6d,0xbe483f35,0x3f55bec4,0x3e48bf35,0xbf553ec4
.long 0xbf7b3f35,0x3f0e3ec4,0x3f7bbf35,0xbf0ebec4,0xbf0ebf35,0x3e483f6d,0x3f0e3f35,0xbe48bf6d
.long 0x3f0ebf35,0xbe483f6d,0xbf0e3f35,0x3e48bf6d,0x3f7b3f35,0xbf0e3ec4,0xbf7bbf35,0x3f0ebec4
.long 0x3e483f35,0xbf55bec4,0xbe48bf35,0x3f553ec4,0xbf55bf35,0xbf7bbf6d,0x3f553f35,0x3f7b3f6d
.long 0xbe488000,0xbf0ebec4,0x3e488000,0x3f0e3ec4,0xbf0e8000,0xbf7bbf6d,0x3f0e8000,0x3f7b3f6d
.long 0xbf558000,0xbe48bf6d,0x3f558000,0x3e483f6d,0xbf7b8000,0x3f55bec4,0x3f7b8000,0xbf553ec4
.long 0xbf7b8000,0x3f553ec4,0x3f7b8000,0xbf55bec4,0xbf558000,0xbe483f6d,0x3f558000,0x3e48bf6d
.long 0xbf0e8000,0xbf7b3f6d,0x3f0e8000,0x3f7bbf6d,0xbe488000,0xbf0e3ec4,0x3e488000,0x3f0ebec4
.long 0x3e488000,0x3f0ebec4,0xbe488000,0xbf0e3ec4,0x3f0e8000,0x3f7bbf6d,0xbf0e8000,0xbf7b3f6d
.long 0x3f558000,0x3e48bf6d,0xbf558000,0xbe483f6d,0x3f7b8000,0xbf55bec4,0xbf7b8000,0x3f553ec4
.long 0x3f7b8000,0xbf553ec4,0xbf7b8000,0x3f55bec4,0x3f558000,0x3e483f6d,0xbf558000,0xbe48bf6d
.long 0x3f0e8000,0x3f7b3f6d,0xbf0e8000,0xbf7bbf6d,0x3e488000,0x3f0e3ec4,0xbe488000,0xbf0ebec4
.long 0xbf55bf35,0xbf7bbf6d,0x3f553f35,0x3f7b3f6d,0xbe48bf35,0x3f553ec4,0x3e483f35,0xbf55bec4
.long 0x3f7b3f35,0xbf0e3ec4,0xbf7bbf35,0x3f0ebec4,0xbf0e3f35,0x3e48bf6d,0x3f0ebf35,0xbe483f6d
.long 0xbf0ebf35,0x3e483f6d,0x3f0e3f35,0xbe48bf6d,0x3f7bbf35,0xbf0ebec4,0xbf7b3f35,0x3f0e3ec4
.long 0xbe483f35,0x3f55bec4,0x3e48bf35,0xbf553ec4,0xbf553f35,0xbf7b3f6d,0x3f55bf35,0x3f7bbf6d
.long 0x3f55bf35,0x3f7bbf6d,0xbf553f35,0xbf7b3f6d,0x3e48bf35,0xbf553ec4,0xbe483f35,0x3f55bec4
.long 0xbf7b3f35,0x3f0e3ec4,0x3f7bbf35,0xbf0ebec4,0x3f0e3f35,0xbe48bf6d,0xbf0ebf35,0x3e483f6d
.long 0x3f0ebf35,0xbe483f6d,0xbf0e3f35,0x3e48bf6d,0xbf7bbf35,0x3f0ebec4,0x3f7b3f35,0xbf0e3ec4
.long 0x3e483f35,0xbf55bec4,0xbe48bf35,0x3f553ec4,0x3f553f35,0x3f7b3f6d,0xbf55bf35,0xbf7bbf6d
.long 0xbf7bbf80,0xbf55bf6d,0x3f7b3f80,0x3f553f6d,0x3f553f80,0xbe483ec4,0xbf55bf80,0x3e48bec4
.long 0xbf0ebf80,0x3f7b3ec4,0x3f0e3f80,0xbf7bbec4,0x3e483f80,0xbf0ebf6d,0xbe48bf80,0x3f0e3f6d
.long 0x3e48bf80,0xbf0e3f6d,0xbe483f80,0x3f0ebf6d,0xbf0e3f80,0x3f7bbec4,0x3f0ebf80,0xbf7b3ec4
.long 0x3f55bf80,0xbe48bec4,0xbf553f80,0x3e483ec4,0xbf7b3f80,0xbf553f6d,0x3f7bbf80,0x3f55bf6d
.long 0x3f7bbf80,0x3f55bf6d,0xbf7b3f80,0xbf553f6d,0xbf553f80,0x3e483ec4,0x3f55bf80,0xbe48bec4
.long 0x3f0ebf80,0xbf7b3ec4,0xbf0e3f80,0x3f7bbec4,0xbe483f80,0x3f0ebf6d,0x3e48bf80,0xbf0e3f6d
.long 0xbe48bf80,0x3f0e3f6d,0x3e483f80,0xbf0ebf6d,0x3f0e3f80,0xbf7bbec4,0xbf0ebf80,0x3f7b3ec4
.long 0xbf55bf80,0x3e48bec4,0x3f553f80,0xbe483ec4,0x3f7b3f80,0x3f553f6d,0xbf7bbf80,0xbf55bf6d
.long 0xbf0ebf35,0xbe48bec4,0x3f0e3f35,0x3e483ec4,0xbf7bbf35,0xbf0ebf6d,0x3f7b3f35,0x3f0e3f6d
.long 0xbe483f35,0xbf55bf6d,0x3e48bf35,0x3f553f6d,0x3f553f35,0xbf7bbec4,0xbf55bf35,0x3f7b3ec4
.long 0x3f55bf35,0xbf7b3ec4,0xbf553f35,0x3f7bbec4,0xbe48bf35,0xbf553f6d,0x3e483f35,0x3f55bf6d
.long 0xbf7b3f35,0xbf0e3f6d,0x3f7bbf35,0x3f0ebf6d,0xbf0e3f35,0xbe483ec4,0x3f0ebf35,0x3e48bec4
.long 0x3f0ebf35,0x3e48bec4,0xbf0e3f35,0xbe483ec4,0x3f7bbf35,0x3f0ebf6d,0xbf7b3f35,0xbf0e3f6d
.long 0x3e483f35,0x3f55bf6d,0xbe48bf35,0xbf553f6d,0xbf553f35,0x3f7bbec4,0x3f55bf35,0xbf7b3ec4
.long 0xbf55bf35,0x3f7b3ec4,0x3f553f35,0xbf7bbec4,0x3e48bf35,0x3f553f6d,0xbe483f35,0xbf55bf6d
.long 0x3f7b3f35,0x3f0e3f6d,0xbf7bbf35,0xbf0ebf6d,0x3f0e3f35,0x3e483ec4,0xbf0ebf35,0xbe48bec4
.long 0x3c003c00,0x3c003c00,0x0,0x0,0x3bff3c00,0x3bfa3bfe,0x26480000,0x2cb52a48
.long 0x3bfe3c00,0x3bea3bf6,0x2a480000,0x30b22e46,0x3bfa3c00,0x3bce3bea,0x2cb50000,0x330330b2
.long 0x3bf63c00,0x3ba83bd9,0x2e460000,0x34a5323e,0x3bf13c00,0x3b773bc3,0x2fd60000,0x35c233c6
.long 0x3bea3c00,0x3b3b3ba8,0x30b20000,0x36d734a5,0x3be23c00,0x3af63b88,0x31790000,0x37e33564
.long 0x3bd93c00,0x3aa73b64,0x323e0000,0x3872361f,0x3bce3c00,0x3a4f3b3b,0x33030000,0x38ec36d7
.long 0x3bc33c00,0x39ed3b0e,0x33c60000,0x395f378b,0x3bb63c00,0x39843add,0x34440000,0x39cb381d
.long 0x3ba83c00,0x39133aa7,0x34a50000,0x3a2f3872,0x3b993c00,0x389b3a6d,0x35050000,0x3a8a38c4
.long 0x3b883c00,0x381d3a2f,0x35640000,0x3add3913,0x3b773c00,0x373239ed,0x35c20000,0x3b25395f
.long 0x3c003c00,0x3c003c00,0x0,0x0,0x3bf13bf6,0x3be23bea,0x2fd62e46,0x317930b2
.long 0x3bc33bd9,0x3b883ba8,0x33c6323e,0x356434a5,0x3b773ba8,0x3af63b3b,0x35c234a5,0x37e336d7
.long 0x3b0e3b64,0x3a2f3aa7,0x378b361f,0x39133872,0x3a8a3b0e,0x393a39ed,0x389b378b,0x3a0f395f
.long 0x39ed3aa7,0x381d3913,0x395f3872,0x3add3a2f,0x393a3a2f,0x35c2381d,0x3a0f3913,0x3b773add
.long 0x387239a8,0x323e361f,0x3aa739a8,0x3bd93b64,0x37323913,0x264833c6,0x3b253a2f,0x3bff3bc3
.long 0x35643872,0xb0b22e46,0x3b883aa7,0x3bea3bf6,0x3303378b,0xb505aa48,0x3bce3b0e,0x3b993bfe
.long 0x2e46361f,0xb78bb23e,0x3bf63b64,0x3b0e3bd9,0xa64834a5,0xb8ecb564,0x3bff3ba8,0x3a4f3b88
.long 0xb0b2323e,0xb9edb78b,0x3bea3bd9,0x395f3b0e,0xb4442e46,0xbac2b8c4,0x3bb63bf6,0x38483a6d
.long 0x3c003c00,0x3c003c00,0x0,0x0,0x3bce3bd9,0x3bb63bc3,0x3303323e,0x344433c6
.long 0x3b3b3b64,0x3add3b0e,0x36d7361f,0x381d378b,0x3a4f3aa7,0x398439ed,0x38ec3872,0x39cb395f
.long 0x391339a8,0x378b3872,0x3a2f39a8,0x3b0e3aa7,0x37323872,0x33033564,0x3b253aa7,0x3bce3b88
.long 0x33c6361f,0xaa482e46,0x3bc33b64,0x3bfe3bf6,0x2648323e,0xb505b0b2,0x3bff3bd9,0x3b993bea
.long 0xb23e0000,0xb872b61f,0x3bd93c00,0x3aa73b64,0xb67cb23e,0xba0fb8c4,0x3b503bd9,0x393a3a6d
.long 0xb8c4b61f,0xbb3bba2f,0x3a6d3b64,0x36d73913,0xba0fb872,0xbbe2bb3b,0x393a3aa7,0x317936d7
.long 0xbb0eb9a8,0xbbf6bbd9,0x378b39a8,0xae46323e,0xbbb6baa7,0xbb77bbfe,0x34443872,0xb5c2aa48
.long 0xbbfebb64,0xba6dbba8,0x2a48361f,0xb8c4b4a5,0xbbe2bbd9,0xb8ecbadd,0xb179323e,0xba4fb81d
.long 0x3c003c00,0x3c003c00,0x0,0x0,0x3b993ba8,0x3b773b88,0x350534a5,0x35c23564
.long 0x3a6d3aa7,0x39ed3a2f,0x38c43872,0x395f3913,0x389b3913,0x3732381d,0x3a8a3a2f,0x3b253add
.long 0x34a5361f,0x2e46323e,0x3ba83b64,0x3bf63bd9,0xa6482e46,0xb444b0b2,0x3bff3bf6,0x3bb63bea
.long 0xb564b23e,0xb8c4b78b,0x3b883bd9,0x3a6d3b0e,0xb8ecb78b,0xbac2b9ed,0x3a4f3b0e,0x3848395f
.long 0xbaa7b9a8,0xbbd9bb64,0x387239a8,0x323e361f,0xbbb6bb0e,0xbbe2bbfe,0x3444378b,0xb1792a48
.long 0xbbfebbd9,0xbaddbba8,0xaa48323e,0xb81db4a5,0xbb77bbf6,0xb8ecba6d,0xb5c2ae46,0xba4fb8c4
.long 0xba2fbb64,0xb4a5b872,0xb913b61f,0xbba8baa7,0xb848ba2f,0x2cb5b3c6,0xbac2b913,0xbbfabbc3
.long 0xb3c6b872,0x36d72e46,0xbbc3baa7,0xbb3bbbf6,0x2cb5b4a5,0x39cb36d7,0xbbfabba8,0xb984bb3b
.long 0x3c003c00,0x3bff3bff,0x22480000,0x28b62648,0x3bff3c00,0x3bf43bfa,0x28b60000,0x2f0e2cb5
.long 0x3bfc3c00,0x3bdd3bf1,0x2bd90000,0x31db2fd6,0x3bf83c00,0x3bbc3be2,0x2d7e0000,0x34143179
.long 0x3bf43c00,0x3b913bce,0x2f0e0000,0x35343303,0x3bed3c00,0x3b5a3bb6,0x304e0000,0x364e3444
.long 0x3be63c00,0x3b1a3b99,0x31150000,0x375e3505,0x3bdd3c00,0x3ad03b77,0x31db0000,0x383235c2
.long 0x3bd43c00,0x3a7c3b50,0x32a10000,0x38b0367c,0x3bc93c00,0x3a1f3b25,0x33650000,0x39273732
.long 0x3bbc3c00,0x39ba3af6,0x34140000,0x399637e3,0x3baf3c00,0x394d3ac2,0x34750000,0x39fe3848
.long 0x3ba03c00,0x38d83a8a,0x34d50000,0x3a5e389b,0x3b913c00,0x385d3a4f,0x35340000,0x3ab538ec
.long 0x3b803c00,0x37b73a0f,0x35930000,0x3b02393a,0x3b6e3c00,0x36aa39cb,0x35f10000,0x3b463984
.long 0x3bfc3bfe,0x3bf83bfa,0x2bd92a48,0x2d7e2cb5,0x3bdd3bea,0x3bbc3bce,0x31db30b2,0x34143303
.long 0x3ba03bc3,0x3b463b77,0x34d533c6,0x36aa35c2,0x3b463b88,0x3a993af6,0x36aa3564,0x388737e3
.long 0x3ad03b3b,0x39ba3a4f,0x383236d7,0x399638ec,0x3a3f3add,0x38b03984,0x3900381d,0x3a7c39cb
.long 0x39963a6d,0x3705389b,0x39ba38c4,0x3b303a8a,0x38d839ed,0x34753732,0x3a5e395f,0x3baf3b25
.long 0x3807395f,0x2f0e3505,0x3ae939ed,0x3bf43b99,0x364e38c4,0xabd93179,0x3b5a3a6d,0x3bfc3be2
.long 0x3475381d,0xb3652648,0x3baf3add,0x3bc93bff,0x311536d7,0xb64eafd6,0x3be63b3b,0x3b5a3bf1
.long 0x28b63564,0xb85db444,0x3bff3b88,0x3ab53bb6,0xad7e33c6,0xb972b67c,0x3bf83bc3,0x39dc3b50
.long 0xb2a130b2,0xba5eb848,0x3bd43bea,0x38d83ac2,0xb5342a48,0xbb1ab93a,0x3b913bfe,0x375e3a0f
.long 0x3bf43bf6,0x3bed3bf1,0x2f0e2e46,0x304e2fd6,0x3b913ba8,0x3b5a3b77,0x353434a5,0x364e35c2
.long 0x3ad03b0e,0x3a3f3a8a,0x3832378b,0x3900389b,0x39ba3a2f,0x38b0393a,0x39963913,0x3a7c3a0f
.long 0x385d3913,0x35933732,0x3ab53a2f,0x3b803b25,0x3593378b,0x2d7e3303,0x3b803b0e,0x3bf83bce
.long 0x304e34a5,0xb1dba648,0x3bed3ba8,0x3bdd3bff,0xad7e2e46,0xb705b444,0x3bf83bf6,0x3b303bb6
.long 0xb4d5ae46,0xb94db7e3,0x3ba03bf6,0x39fe3af6,0xb807b4a5,0xbab5b984,0x3ae93ba8,0x385d39cb
.long 0xb972b78b,0xbba0bac2,0x39dc3b0e,0x34d53848,0xba99b913,0xbbffbb99,0x38873a2f,0x28b63505
.long 0xbb6eba2f,0xbbc9bbfa,0x35f13913,0xb3652cb5,0xbbe6bb0e,0xbb02bbe2,0x3115378b,0xb7b7b179
.long 0xbbfcbba8,0xb9babb50,0xabd934a5,0xb996b67c,0xbbafbbf6,0xb807ba4f,0xb4752e46,0xbae9b8ec
.long 0x3be63bea,0x3bdd3be2,0x311530b2,0x31db3179,0x3b1a3b3b,0x3ad03af6,0x375e36d7,0x383237e3
.long 0x399639ed,0x38d8393a,0x39ba395f,0x3a5e3a0f,0x3705381d,0x347535c2,0x3b303add,0x3baf3b77
.long 0x304e33c6,0xad7e2648,0x3bed3bc3,0x3bf83bff,0xb1dbaa48,0xb705b505,0x3bdd3bfe,0x3b303b99
.long 0xb7b7b564,0xb9dcb8ec,0x3b023b88,0x39723a4f,0xb9dcb8c4,0xbb6ebac2,0x39723a6d,0x35f13848
.long 0xbb46ba6d,0xbc00bbce,0x36aa38c4,0x22483303,0xbbf4bb88,0xbb80bbf1,0x2f0e3564,0xb593afd6
.long 0xbbd4bbfe,0xb9febb25,0xb2a12a48,0xb94db732,0xbae9bbc3,0xb75eb984,0xb807b3c6,0xbb1ab9cb
.long 0xb94dbadd,0xaf0eb67c,0xb9feb81d,0xbbf4bb50,0xb64eb95f,0x3414acb5,0xbb5ab9ed,0xbbbcbbfa
.long 0xad7eb6d7,0x38b03444,0xbbf8bb3b,0xba7cbbb6,0x3365b0b2,0x3ab5389b,0xbbc9bbea,0xb85dba8a
.long 0x3c003c00,0x3c003c00,0x0,0x0,0x3b643c00,0x361f39a8,0x361f0000,0x3b6439a8
.long 0x39a83c00,0xb9a80000,0x39a80000,0x39a83c00,0x361f3c00,0xbb64b9a8,0x3b640000,0xb61f39a8
.long 0x3c00,0xbc00,0x3c000000,0xbc000000,0xb61f3c00,0x3b64b9a8,0x3b640000,0xb61fb9a8
.long 0xb9a83c00,0x39a80000,0x39a80000,0x39a8bc00,0xbb643c00,0xb61f39a8,0x361f0000,0x3b64b9a8
.long 0x0,0x0,0x3c003c00,0x3c003c00,0xb61f0000,0xbb64b9a8,0x3b643c00,0x361f39a8
.long 0xb9a80000,0xb9a8bc00,0x39a83c00,0xb9a80000,0xbb640000,0x361fb9a8,0x361f3c00,0xbb64b9a8
.long 0xbc000000,0x3c000000,0x3c00,0xbc00,0xbb640000,0x361f39a8,0xb61f3c00,0x3b64b9a8
.long 0xb9a80000,0xb9a83c00,0xb9a83c00,0x39a80000,0xb61f0000,0xbb6439a8,0xbb643c00,0xb61f39a8
.long 0x3c003c00,0x3c003c00,0x0,0x0,0xb61f0000,0xbb64b9a8,0x3b643c00,0x361f39a8
.long 0xb9a8bc00,0x39a80000,0xb9a80000,0xb9a8bc00,0x3b640000,0xb61f39a8,0xb61fbc00,0x3b6439a8
.long 0x3c00,0xbc00,0x3c000000,0xbc000000,0xbb640000,0x361f39a8,0xb61f3c00,0x3b64b9a8
.long 0x39a8bc00,0xb9a80000,0xb9a80000,0xb9a83c00,0x361f0000,0x3b64b9a8,0x3b64bc00,0x361fb9a8
.long 0x0,0x0,0x3c003c00,0x3c003c00,0xbb64bc00,0xb61fb9a8,0xb61f0000,0xbb64b9a8
.long 0x39a80000,0x39a83c00,0xb9a8bc00,0x39a80000,0x361f3c00,0xbb64b9a8,0x3b640000,0xb61f39a8
.long 0xbc000000,0x3c000000,0x3c00,0xbc00,0x361fbc00,0xbb6439a8,0xbb640000,0x361f39a8
.long 0x39a80000,0x39a8bc00,0x39a8bc00,0xb9a80000,0xbb643c00,0xb61f39a8,0x361f0000,0x3b64b9a8
.long 0x3c003c00,0x3c003c00,0x0,0x0,0xbb64bc00,0xb61fb9a8,0xb61f0000,0xbb64b9a8
.long 0x39a83c00,0xb9a80000,0x39a80000,0x39a83c00,0xb61fbc00,0x3b6439a8,0xbb640000,0x361fb9a8
.long 0x3c00,0xbc00,0x3c000000,0xbc000000,0x361fbc00,0xbb6439a8,0xbb640000,0x361f39a8
.long 0xb9a83c00,0x39a80000,0x39a80000,0x39a8bc00,0x3b64bc00,0x361fb9a8,0xb61f0000,0xbb6439a8
.long 0x0,0x0,0x3c003c00,0x3c003c00,0x361f0000,0x3b6439a8,0xbb64bc00,0xb61fb9a8
.long 0xb9a80000,0xb9a8bc00,0x39a83c00,0xb9a80000,0x3b640000,0xb61f39a8,0xb61fbc00,0x3b6439a8
.long 0xbc000000,0x3c000000,0x3c00,0xbc00,0x3b640000,0xb61fb9a8,0x361fbc00,0xbb6439a8
.long 0xb9a80000,0xb9a83c00,0xb9a83c00,0x39a80000,0x361f0000,0x3b64b9a8,0x3b64bc00,0x361fb9a8
.long 0x3c003c00,0x3c003c00,0x0,0x0,0x361f0000,0x3b6439a8,0xbb64bc00,0xb61fb9a8
.long 0xb9a8bc00,0x39a80000,0xb9a80000,0xb9a8bc00,0xbb640000,0x361fb9a8,0x361f3c00,0xbb64b9a8
.long 0x3c00,0xbc00,0x3c000000,0xbc000000,0x3b640000,0xb61fb9a8,0x361fbc00,0xbb6439a8
.long 0x39a8bc00,0xb9a80000,0xb9a80000,0xb9a83c00,0xb61f0000,0xbb6439a8,0xbb643c00,0xb61f39a8
.long 0x0,0x0,0x3c003c00,0x3c003c00,0x3b643c00,0x361f39a8,0x361f0000,0x3b6439a8
.long 0x39a80000,0x39a83c00,0xb9a8bc00,0x39a80000,0xb61fbc00,0x3b6439a8,0xbb640000,0x361fb9a8
.long 0xbc000000,0x3c000000,0x3c00,0xbc00,0xb61f3c00,0x3b64b9a8,0x3b640000,0xb61fb9a8
.long 0x39a80000,0x39a8bc00,0x39a8bc00,0xb9a80000,0x3b64bc00,0x361fb9a8,0xb61f0000,0xbb6439a8
.long 0x3c00,0x3c00,0x3c00,0x3c00,0x3c000000,0x3c000000,0x3c000000,0x3c000000
.long 0x3c00,0x361f3b64,0xbc00,0xb61fbb64,0x3c000000,0x3b64b61f,0xbc000000,0xbb64361f
.long 0x3c00,0x39a839a8,0x3c00,0x39a839a8,0x3c000000,0x39a8b9a8,0x3c000000,0x39a8b9a8
.long 0x3c00,0x3b64361f,0xbc00,0xbb64b61f,0x3c000000,0x361fbb64,0xbc000000,0xb61f3b64
.long 0x3c00,0x3c000000,0x3c00,0x3c000000,0x3c000000,0xbc00,0x3c000000,0xbc00
.long 0x3c00,0x3b64b61f,0xbc00,0xbb64361f,0x3c000000,0xb61fbb64,0xbc000000,0x361f3b64
.long 0x3c00,0x39a8b9a8,0x3c00,0x39a8b9a8,0x3c000000,0xb9a8b9a8,0x3c000000,0xb9a8b9a8
.long 0x3c00,0x361fbb64,0xbc00,0xb61f3b64,0x3c000000,0xbb64b61f,0xbc000000,0x3b64361f
.long 0x3c00,0x3c00,0x3c00,0x3c00,0x3c000000,0x3c000000,0x3c000000,0x3c000000
.long 0x39a839a8,0x3b64361f,0xb9a8b9a8,0xbb64b61f,0x39a8b9a8,0x361fbb64,0xb9a839a8,0xb61f3b64
.long 0x3c000000,0x39a8b9a8,0x3c000000,0x39a8b9a8,0xbc00,0xb9a8b9a8,0xbc00,0xb9a8b9a8
.long 0x39a8b9a8,0xb61fbb64,0xb9a839a8,0x361f3b64,0xb9a8b9a8,0xbb64361f,0x39a839a8,0x3b64b61f
.long 0xbc00,0xbc000000,0xbc00,0xbc000000,0xbc000000,0x3c00,0xbc000000,0x3c00
.long 0xb9a8b9a8,0xb61f3b64,0x39a839a8,0x361fbb64,0xb9a839a8,0x3b64361f,0x39a8b9a8,0xbb64b61f
.long 0xbc000000,0x39a839a8,0xbc000000,0x39a839a8,0x3c00,0x39a8b9a8,0x3c00,0x39a8b9a8
.long 0xb9a839a8,0x3b64b61f,0x39a8b9a8,0xbb64361f,0x39a839a8,0xb61fbb64,0xb9a8b9a8,0x361f3b64
.long 0x3c00,0x3c00,0x3c00,0x3c00,0x3c000000,0x3c000000,0x3c000000,0x3c000000
.long 0x3c000000,0x3b64b61f,0xbc000000,0xbb64361f,0xbc00,0xb61fbb64,0x3c00,0x361f3b64
.long 0xbc00,0xb9a8b9a8,0xbc00,0xb9a8b9a8,0xbc000000,0xb9a839a8,0xbc000000,0xb9a839a8
.long 0xbc000000,0xb61f3b64,0x3c000000,0x361fbb64,0x3c00,0x3b64361f,0xbc00,0xbb64b61f
.long 0x3c00,0x3c000000,0x3c00,0x3c000000,0x3c000000,0xbc00,0x3c000000,0xbc00
.long 0x3c000000,0xb61fbb64,0xbc000000,0x361f3b64,0xbc00,0xbb64361f,0x3c00,0x3b64b61f
.long 0xbc00,0xb9a839a8,0xbc00,0xb9a839a8,0xbc000000,0x39a839a8,0xbc000000,0x39a839a8
.long 0xbc000000,0x3b64361f,0x3c000000,0xbb64b61f,0x3c00,0x361fbb64,0xbc00,0xb61f3b64
.long 0x3c00,0x3c00,0x3c00,0x3c00,0x3c000000,0x3c000000,0x3c000000,0x3c000000
.long 0x39a8b9a8,0x361fbb64,0xb9a839a8,0xb61f3b64,0xb9a8b9a8,0xbb64b61f,0x39a839a8,0x3b64361f
.long 0xbc000000,0xb9a839a8,0xbc000000,0xb9a839a8,0x3c00,0x39a839a8,0x3c00,0x39a839a8
.long 0x39a839a8,0x3b64b61f,0xb9a8b9a8,0xbb64361f,0x39a8b9a8,0xb61fbb64,0xb9a839a8,0x361f3b64
.long 0xbc00,0xbc000000,0xbc00,0xbc000000,0xbc000000,0x3c00,0xbc000000,0x3c00
.long 0xb9a839a8,0x3b64361f,0x39a8b9a8,0xbb64b61f,0x39a839a8,0x361fbb64,0xb9a8b9a8,0xb61f3b64
.long 0x3c000000,0xb9a8b9a8,0x3c000000,0xb9a8b9a8,0xbc00,0xb9a839a8,0xbc00,0xb9a839a8
.long 0xb9a8b9a8,0x361f3b64,0x39a839a8,0xb61fbb64,0xb9a839a8,0x3b64b61f,0x39a8b9a8,0xbb64361f
.long 0x3c00,0xbc00,0x3c00,0xbc00,0x3c000000,0xbc000000,0x3c000000,0xbc000000
.long 0x3c00,0xb61fbb64,0xbc00,0x361f3b64,0x3c000000,0xbb64361f,0xbc000000,0x3b64b61f
.long 0x3c00,0xb9a8b9a8,0x3c00,0xb9a8b9a8,0x3c000000,0xb9a839a8,0x3c000000,0xb9a839a8
.long 0x3c00,0xbb64b61f,0xbc00,0x3b64361f,0x3c000000,0xb61f3b64,0xbc000000,0x361fbb64
.long 0x3c00,0xbc000000,0x3c00,0xbc000000,0x3c000000,0x3c00,0x3c000000,0x3c00
.long 0x3c00,0xbb64361f,0xbc00,0x3b64b61f,0x3c000000,0x361f3b64,0xbc000000,0xb61fbb64
.long 0x3c00,0xb9a839a8,0x3c00,0xb9a839a8,0x3c000000,0x39a839a8,0x3c000000,0x39a839a8
.long 0x3c00,0xb61f3b64,0xbc00,0x361fbb64,0x3c000000,0x3b64361f,0xbc000000,0xbb64b61f
.long 0x3c00,0xbc00,0x3c00,0xbc00,0x3c000000,0xbc000000,0x3c000000,0xbc000000
.long 0x39a839a8,0xbb64b61f,0xb9a8b9a8,0x3b64361f,0x39a8b9a8,0xb61f3b64,0xb9a839a8,0x361fbb64
.long 0x3c000000,0xb9a839a8,0x3c000000,0xb9a839a8,0xbc00,0x39a839a8,0xbc00,0x39a839a8
.long 0x39a8b9a8,0x361f3b64,0xb9a839a8,0xb61fbb64,0xb9a8b9a8,0x3b64b61f,0x39a839a8,0xbb64361f
.long 0xbc00,0x3c000000,0xbc00,0x3c000000,0xbc000000,0xbc00,0xbc000000,0xbc00
.long 0xb9a8b9a8,0x361fbb64,0x39a839a8,0xb61f3b64,0xb9a839a8,0xbb64b61f,0x39a8b9a8,0x3b64361f
.long 0xbc000000,0xb9a8b9a8,0xbc000000,0xb9a8b9a8,0x3c00,0xb9a839a8,0x3c00,0xb9a839a8
.long 0xb9a839a8,0xbb64361f,0x39a8b9a8,0x3b64b61f,0x39a839a8,0x361f3b64,0xb9a8b9a8,0xb61fbb64
.long 0x3c00,0xbc00,0x3c00,0xbc00,0x3c000000,0xbc000000,0x3c000000,0xbc000000
.long 0x3c000000,0xbb64361f,0xbc000000,0x3b64b61f,0xbc00,0x361f3b64,0x3c00,0xb61fbb64
.long 0xbc00,0x39a839a8,0xbc00,0x39a839a8,0xbc000000,0x39a8b9a8,0xbc000000,0x39a8b9a8
.long 0xbc000000,0x361fbb64,0x3c000000,0xb61f3b64,0x3c00,0xbb64b61f,0xbc00,0x3b64361f
.long 0x3c00,0xbc000000,0x3c00,0xbc000000,0x3c000000,0x3c00,0x3c000000,0x3c00
.long 0x3c000000,0x361f3b64,0xbc000000,0xb61fbb64,0xbc00,0x3b64b61f,0x3c00,0xbb64361f
.long 0xbc00,0x39a8b9a8,0xbc00,0x39a8b9a8,0xbc000000,0xb9a8b9a8,0xbc000000,0xb9a8b9a8
.long 0xbc000000,0xbb64b61f,0x3c000000,0x3b64361f,0x3c00,0xb61f3b64,0xbc00,0x361fbb64
.long 0x3c00,0xbc00,0x3c00,0xbc00,0x3c000000,0xbc000000,0x3c000000,0xbc000000
.long 0x39a8b9a8,0xb61f3b64,0xb9a839a8,0x361fbb64,0xb9a8b9a8,0x3b64361f,0x39a839a8,0xbb64b61f
.long 0xbc000000,0x39a8b9a8,0xbc000000,0x39a8b9a8,0x3c00,0xb9a8b9a8,0x3c00,0xb9a8b9a8
.long 0x39a839a8,0xbb64361f,0xb9a8b9a8,0x3b64b61f,0x39a8b9a8,0x361f3b64,0xb9a839a8,0xb61fbb64
.long 0xbc00,0x3c000000,0xbc00,0x3c000000,0xbc000000,0xbc00,0xbc000000,0xbc00
.long 0xb9a839a8,0xbb64b61f,0x39a8b9a8,0x3b64361f,0x39a839a8,0xb61f3b64,0xb9a8b9a8,0x361fbb64
.long 0x3c000000,0x39a839a8,0x3c000000,0x39a839a8,0xbc00,0x39a8b9a8,0xbc00,0x39a8b9a8
.long 0xb9a8b9a8,0xb61fbb64,0x39a839a8,0x361f3b64,0xb9a839a8,0xbb64361f,0x39a8b9a8,0x3b64b61f
.long 0x44004400,0x44004400,0x0,0x0,0x41a84400,0xc1a80000,0x41a80000,0x41a84400
.long 0x4400,0xc400,0x44000000,0xc4000000,0xc1a84400,0x41a80000,0x41a80000,0x41a8c400
.long 0xc4004400,0xc4004400,0x0,0x0,0xc1a84400,0x41a80000,0xc1a80000,0xc1a84400
.long 0x4400,0xc400,0xc4000000,0x44000000,0x41a84400,0xc1a80000,0xc1a80000,0xc1a8c400
.long 0x0,0x0,0x0,0x0,0x0,0x80000000,0x0,0x0
.long 0x0,0x8000,0x0,0x80000000,0x80000000,0x0,0x0,0x8000
.long 0x80000000,0x80000000,0x0,0x0,0x80000000,0x0,0x80000000,0x80000000
.long 0x0,0x8000,0x80000000,0x0,0x0,0x80000000,0x80000000,0x80008000
.long 0x44004400,0x44004400,0x0,0x0,0xc1a8c400,0x41a80000,0xc1a80000,0xc1a8c400
.long 0x4400,0xc400,0x44000000,0xc4000000,0x41a8c400,0xc1a80000,0xc1a80000,0xc1a84400
.long 0xc4004400,0xc4004400,0x0,0x0,0x41a8c400,0xc1a80000,0x41a80000,0x41a8c400
.long 0x4400,0xc400,0xc4000000,0x44000000,0xc1a8c400,0x41a80000,0x41a80000,0x41a84400
.long 0x0,0x0,0x0,0x0,0x80008000,0x0,0x80000000,0x80008000
.long 0x0,0x8000,0x0,0x80000000,0x8000,0x80000000,0x80000000,0x80000000
.long 0x80000000,0x80000000,0x0,0x0,0x8000,0x80000000,0x0,0x8000
.long 0x0,0x8000,0x80000000,0x0,0x80008000,0x0,0x0,0x0
.long 0x0,0x0,0x0,0x0,0x0,0x80000000,0x0,0x0
.long 0x0,0x8000,0x0,0x80000000,0x80000000,0x0,0x0,0x8000
.long 0x80000000,0x80000000,0x0,0x0,0x80000000,0x0,0x80000000,0x80000000
.long 0x0,0x8000,0x80000000,0x0,0x0,0x80000000,0x80000000,0x80008000
.long 0x44004400,0x44004400,0x0,0x0,0x41a84400,0xc1a80000,0x41a80000,0x41a84400
.long 0x4400,0xc400,0x44000000,0xc4000000,0xc1a84400,0x41a80000,0x41a80000,0x41a8c400
.long 0xc4004400,0xc4004400,0x0,0x0,0xc1a84400,0x41a80000,0xc1a80000,0xc1a84400
.long 0x4400,0xc400,0xc4000000,0x44000000,0x41a84400,0xc1a80000,0xc1a80000,0xc1a8c400
.long 0x0,0x0,0x0,0x0,0x80008000,0x0,0x80000000,0x80008000
.long 0x0,0x8000,0x0,0x80000000,0x8000,0x80000000,0x80000000,0x80000000
.long 0x80000000,0x80000000,0x0,0x0,0x8000,0x80000000,0x0,0x8000
.long 0x0,0x8000,0x80000000,0x0,0x80008000,0x0,0x0,0x0
.long 0x44004400,0x44004400,0x0,0x0,0xc1a8c400,0x41a80000,0xc1a80000,0xc1a8c400
.long 0x4400,0xc400,0x44000000,0xc4000000,0x41a8c400,0xc1a80000,0xc1a80000,0xc1a84400
.long 0xc4004400,0xc4004400,0x0,0x0,0x41a8c400,0xc1a80000,0x41a80000,0x41a8c400
.long 0x4400,0xc400,0xc4000000,0x44000000,0xc1a8c400,0x41a80000,0x41a80000,0x41a84400
.long 0x3400,0x3400,0x3400,0x3400,0x3400,0x2e1f3364,0x31a831a8,0x33642e1f
.long 0x3400,0x31a831a8,0x34000000,0x31a8b1a8,0x3400,0x33642e1f,0x31a8b1a8,0xae1fb364
.long 0x3400,0x34000000,0xb400,0xb4000000,0x3400,0x3364ae1f,0xb1a8b1a8,0xae1f3364
.long 0x3400,0x31a8b1a8,0xb4000000,0x31a831a8,0x3400,0x2e1fb364,0xb1a831a8,0x3364ae1f
.long 0x3400,0xb400,0x3400,0xb400,0x3400,0xae1fb364,0x31a831a8,0xb364ae1f
.long 0x3400,0xb1a8b1a8,0x34000000,0xb1a831a8,0x3400,0xb364ae1f,0x31a8b1a8,0x2e1f3364
.long 0x3400,0xb4000000,0xb400,0x34000000,0x3400,0xb3642e1f,0xb1a8b1a8,0x2e1fb364
.long 0x3400,0xb1a831a8,0xb4000000,0xb1a8b1a8,0x3400,0xae1f3364,0xb1a831a8,0xb3642e1f
.long 0x3400,0x3400,0x3400,0x3400,0x34000000,0x3364ae1f,0x31a8b1a8,0x2e1fb364
.long 0xb400,0xb1a8b1a8,0xb4000000,0xb1a831a8,0xb4000000,0xae1f3364,0x31a831a8,0x3364ae1f
.long 0x3400,0x34000000,0xb400,0xb4000000,0x34000000,0xae1fb364,0xb1a831a8,0x33642e1f
.long 0xb400,0xb1a831a8,0x34000000,0xb1a8b1a8,0xb4000000,0x33642e1f,0xb1a8b1a8,0x2e1f3364
.long 0x3400,0xb400,0x3400,0xb400,0x34000000,0xb3642e1f,0x31a8b1a8,0xae1f3364
.long 0xb400,0x31a831a8,0xb4000000,0x31a8b1a8,0xb4000000,0x2e1fb364,0x31a831a8,0xb3642e1f
.long 0x3400,0xb4000000,0xb400,0x34000000,0x34000000,0x2e1f3364,0xb1a831a8,0xb364ae1f
.long 0xb400,0x31a8b1a8,0x34000000,0x31a831a8,0xb4000000,0xb364ae1f,0xb1a8b1a8,0xae1fb364
.long 0x3400,0x3400,0x3400,0x3400,0xb400,0xae1fb364,0xb1a8b1a8,0xb364ae1f
.long 0x3400,0x31a831a8,0x34000000,0x31a8b1a8,0xb400,0xb364ae1f,0xb1a831a8,0x2e1f3364
.long 0x3400,0x34000000,0xb400,0xb4000000,0xb400,0xb3642e1f,0x31a831a8,0x2e1fb364
.long 0x3400,0x31a8b1a8,0xb4000000,0x31a831a8,0xb400,0xae1f3364,0x31a8b1a8,0xb3642e1f
.long 0x3400,0xb400,0x3400,0xb400,0xb400,0x2e1f3364,0xb1a8b1a8,0x33642e1f
.long 0x3400,0xb1a8b1a8,0x34000000,0xb1a831a8,0xb400,0x33642e1f,0xb1a831a8,0xae1fb364
.long 0x3400,0xb4000000,0xb400,0x34000000,0xb400,0x3364ae1f,0x31a831a8,0xae1f3364
.long 0x3400,0xb1a831a8,0xb4000000,0xb1a8b1a8,0xb400,0x2e1fb364,0x31a8b1a8,0x3364ae1f
.long 0x3400,0x3400,0x3400,0x3400,0xb4000000,0xb3642e1f,0xb1a831a8,0xae1f3364
.long 0xb400,0xb1a8b1a8,0xb4000000,0xb1a831a8,0x34000000,0x2e1fb364,0xb1a8b1a8,0xb3642e1f
.long 0x3400,0x34000000,0xb400,0xb4000000,0xb4000000,0x2e1f3364,0x31a8b1a8,0xb364ae1f
.long 0xb400,0xb1a831a8,0x34000000,0xb1a8b1a8,0x34000000,0xb364ae1f,0x31a831a8,0xae1fb364
.long 0x3400,0xb400,0x3400,0xb400,0xb4000000,0x3364ae1f,0xb1a831a8,0x2e1fb364
.long 0xb400,0x31a831a8,0xb4000000,0x31a8b1a8,0x34000000,0xae1f3364,0xb1a8b1a8,0x3364ae1f
.long 0x3400,0xb4000000,0xb400,0x34000000,0xb4000000,0xae1fb364,0x31a8b1a8,0x33642e1f
.long 0xb400,0x31a8b1a8,0x34000000,0x31a831a8,0x34000000,0x33642e1f,0x31a831a8,0x2e1f3364
.long 0x34008000,0x34008000,0x34008000,0x34008000,0x34008000,0x3364ae1f,0x31a8b1a8,0x2e1fb364
.long 0x34008000,0x31a8b1a8,0xb400,0xb1a8b1a8,0x34008000,0x2e1fb364,0xb1a8b1a8,0xb3642e1f
.long 0x34008000,0xb400,0xb4008000,0x3400,0x34008000,0xae1fb364,0xb1a831a8,0x33642e1f
.long 0x34008000,0xb1a8b1a8,0x3400,0x31a8b1a8,0x34008000,0xb364ae1f,0x31a831a8,0xae1fb364
.long 0x34008000,0xb4008000,0x34008000,0xb4008000,0x34008000,0xb3642e1f,0x31a8b1a8,0xae1f3364
.long 0x34008000,0xb1a831a8,0xb400,0x31a831a8,0x34008000,0xae1f3364,0xb1a8b1a8,0x3364ae1f
.long 0x34008000,0x3400,0xb4008000,0xb400,0x34008000,0x2e1f3364,0xb1a831a8,0xb364ae1f
.long 0x34008000,0x31a831a8,0x3400,0xb1a831a8,0x34008000,0x33642e1f,0x31a831a8,0x2e1f3364
.long 0x34008000,0x34008000,0x34008000,0x34008000,0xb400,0xae1fb364,0xb1a8b1a8,0xb364ae1f
.long 0xb4008000,0xb1a831a8,0x3400,0x31a831a8,0x3400,0x33642e1f,0x31a8b1a8,0xae1fb364
.long 0x34008000,0xb400,0xb4008000,0x3400,0xb400,0xb3642e1f,0x31a831a8,0x2e1fb364
.long 0xb4008000,0x31a831a8,0xb400,0xb1a831a8,0x3400,0x2e1fb364,0xb1a831a8,0x3364ae1f
.long 0x34008000,0xb4008000,0x34008000,0xb4008000,0xb400,0x2e1f3364,0xb1a8b1a8,0x33642e1f
.long 0xb4008000,0x31a8b1a8,0x3400,0xb1a8b1a8,0x3400,0xb364ae1f,0x31a8b1a8,0x2e1f3364
.long 0x34008000,0x3400,0xb4008000,0xb400,0xb400,0x3364ae1f,0x31a831a8,0xae1f3364
.long 0xb4008000,0xb1a8b1a8,0xb400,0x31a8b1a8,0x3400,0xae1f3364,0xb1a831a8,0xb3642e1f
.long 0x34008000,0x34008000,0x34008000,0x34008000,0xb4008000,0xb3642e1f,0xb1a831a8,0xae1f3364
.long 0x34008000,0x31a8b1a8,0xb400,0xb1a8b1a8,0xb4008000,0xae1f3364,0x31a831a8,0x3364ae1f
.long 0x34008000,0xb400,0xb4008000,0x3400,0xb4008000,0x2e1f3364,0x31a8b1a8,0xb364ae1f
.long 0x34008000,0xb1a8b1a8,0x3400,0x31a8b1a8,0xb4008000,0x33642e1f,0xb1a8b1a8,0x2e1f3364
.long 0x34008000,0xb4008000,0x34008000,0xb4008000,0xb4008000,0x3364ae1f,0xb1a831a8,0x2e1fb364
.long 0x34008000,0xb1a831a8,0xb400,0x31a831a8,0xb4008000,0x2e1fb364,0x31a831a8,0xb3642e1f
.long 0x34008000,0x3400,0xb4008000,0xb400,0xb4008000,0xae1fb364,0x31a8b1a8,0x33642e1f
.long 0x34008000,0x31a831a8,0x3400,0xb1a831a8,0xb4008000,0xb364ae1f,0xb1a8b1a8,0xae1fb364
.long 0x34008000,0x34008000,0x34008000,0x34008000,0x3400,0x2e1f3364,0x31a831a8,0x33642e1f
.long 0xb4008000,0xb1a831a8,0x3400,0x31a831a8,0xb400,0xb364ae1f,0xb1a831a8,0x2e1f3364
.long 0x34008000,0xb400,0xb4008000,0x3400,0x3400,0x3364ae1f,0xb1a8b1a8,0xae1f3364
.long 0xb4008000,0x31a831a8,0xb400,0xb1a831a8,0xb400,0xae1f3364,0x31a8b1a8,0xb3642e1f
.long 0x34008000,0xb4008000,0x34008000,0xb4008000,0x3400,0xae1fb364,0x31a831a8,0xb364ae1f
.long 0xb4008000,0x31a8b1a8,0x3400,0xb1a8b1a8,0xb400,0x33642e1f,0xb1a831a8,0xae1fb364
.long 0x34008000,0x3400,0xb4008000,0xb400,0x3400,0xb3642e1f,0xb1a8b1a8,0x2e1fb364
.long 0xb4008000,0xb1a8b1a8,0xb400,0x31a8b1a8,0xb400,0x2e1fb364,0x31a8b1a8,0x3364ae1f
.long 0x3c013c01,0x3c013c01,0x0,0x0,0x3c003c01,0x3bec3bf8,0x2a4a0000,0x30b32e48
.long 0x3bf83c01,0x3baa3bdb,0x2e480000,0x34a63240,0x3bec3c01,0x3b3d3baa,0x30b30000,0x36d934a6
.long 0x3bdb3c01,0x3aa93b66,0x32400000,0x38733621,0x3bc53c01,0x39ef3b10,0x33c90000,0x3961378d
.long 0x3baa3c01,0x39153aa9,0x34a60000,0x3a313873,0x3b8a3c01,0x381e3a31,0x35650000,0x3ade3915
.long 0x3b663c01,0x362139aa,0x36210000,0x3b6639aa,0x3b3d3c01,0x33c93915,0x36d90000,0x3bc53a31
.long 0x3b103c01,0x2e483873,0x378d0000,0x3bf83aa9,0x3ade3c01,0xaa4a378d,0x381e0000,0x3c003b10
.long 0x3aa93c01,0xb2403621,0x38730000,0x3bdb3b66,0x3a6f3c01,0xb56534a6,0x38c50000,0x3b8a3baa
.long 0x3a313c01,0xb78d3240,0x39150000,0x3b103bdb,0x39ef3c01,0xb8c52e48,0x39610000,0x3a6f3bf8
.long 0x3c013c01,0x3c013c01,0x0,0x0,0x3bc53bdb,0x3b8a3baa,0x33c93240,0x356534a6
.long 0x3b103b66,0x3a313aa9,0x378d3621,0x39153873,0x39ef3aa9,0x381e3915,0x39613873,0x3ade3a31
.long 0x387339aa,0x32403621,0x3aa939aa,0x3bdb3b66,0x35653873,0xb0b32e48,0x3b8a3aa9,0x3bec3bf8
.long 0x2e483621,0xb78db240,0x3bf83b66,0x3b103bdb,0xb0b33240,0xb9efb78d,0x3bec3bdb,0x39613b10
.long 0xb6210000,0xbb66b9aa,0x3b663c01,0x362139aa,0xb8c5b240,0xbc00bb10,0x3a6f3bdb,0x2a4a378d
.long 0xba31b621,0xbbaabbdb,0x39153b66,0xb4a63240,0xbb3db873,0xba6fbbf8,0x36d93aa9,0xb8c5ae48
.long 0xbbdbb9aa,0xb873bb66,0x324039aa,0xbaa9b621,0xbc00baa9,0xb3c9ba31,0xaa4a3873,0xbbc5b915
.long 0xbbaabb66,0x2e48b873,0xb4a63621,0xbbf8baa9,0xbadebbdb,0x36d9b4a6,0xb81e3240,0xbb3dbbaa
.long 0x3c013c01,0x3c013c01,0x0,0x0,0x3c003c01,0x3bec3bf8,0x2a4a0000,0x30b32e48
.long 0x3bf83c01,0x3baa3bdb,0x2e480000,0x34a63240,0x3bec3c01,0x3b3d3baa,0x30b30000,0x36d934a6
.long 0x3bdb3c01,0x3aa93b66,0x32400000,0x38733621,0x3bc53c01,0x39ef3b10,0x33c90000,0x3961378d
.long 0x3baa3c01,0x39153aa9,0x34a60000,0x3a313873,0x3b8a3c01,0x381e3a31,0x35650000,0x3ade3915
.long 0x3b663c01,0x362139aa,0x36210000,0x3b6639aa,0x3b3d3c01,0x33c93915,0x36d90000,0x3bc53a31
.long 0x3b103c01,0x2e483873,0x378d0000,0x3bf83aa9,0x3ade3c01,0xaa4a378d,0x381e0000,0x3c003b10
.long 0x3aa93c01,0xb2403621,0x38730000,0x3bdb3b66,0x3a6f3c01,0xb56534a6,0x38c50000,0x3b8a3baa
.long 0x3a313c01,0xb78d3240,0x39150000,0x3b103bdb,0x39ef3c01,0xb8c52e48,0x39610000,0x3a6f3bf8
.long 0x3c013c01,0x3c013c01,0x0,0x0,0x3bc53bdb,0x3b8a3baa,0x33c93240,0x356534a6
.long 0x3b103b66,0x3a313aa9,0x378d3621,0x39153873,0x39ef3aa9,0x381e3915,0x39613873,0x3ade3a31
.long 0x387339aa,0x32403621,0x3aa939aa,0x3bdb3b66,0x35653873,0xb0b32e48,0x3b8a3aa9,0x3bec3bf8
.long 0x2e483621,0xb78db240,0x3bf83b66,0x3b103bdb,0xb0b33240,0xb9efb78d,0x3bec3bdb,0x39613b10
.long 0xb6210000,0xbb66b9aa,0x3b663c01,0x362139aa,0xb8c5b240,0xbc00bb10,0x3a6f3bdb,0x2a4a378d
.long 0xba31b621,0xbbaabbdb,0x39153b66,0xb4a63240,0xbb3db873,0xba6fbbf8,0x36d93aa9,0xb8c5ae48
.long 0xbbdbb9aa,0xb873bb66,0x324039aa,0xbaa9b621,0xbc00baa9,0xb3c9ba31,0xaa4a3873,0xbbc5b915
.long 0xbbaabb66,0x2e48b873,0xb4a63621,0xbbf8baa9,0xbadebbdb,0x36d9b4a6,0xb81e3240,0xbb3dbbaa
.long 0x3400,0x1e4833ff,0x224833fe,0x24b533fa,0x3400,0x2e7c3350,0x31ed315f,0x33992d05
.long 0x3400,0x31cb3184,0x33fea248,0x313ab20f,0x3400,0x33772dc2,0x315fb1ed,0xaf32b325
.long 0x3400,0x33ff9e48,0xa248b3fe,0xb3fa24b5,0x3400,0x3350ae7c,0xb1edb15f,0xad053399
.long 0x3400,0x3184b1cb,0xb3fe2248,0x320f313a,0x3400,0x2dc2b377,0xb15f31ed,0x3325af32
.long 0x3400,0x9e48b3ff,0x224833fe,0xa4b5b3fa,0x3400,0xae7cb350,0x31ed315f,0xb399ad05
.long 0x3400,0xb1cbb184,0x33fea248,0xb13a320f,0x3400,0xb377adc2,0x315fb1ed,0x2f323325
.long 0x3400,0xb3ff1e48,0xa248b3fe,0x33faa4b5,0x3400,0xb3502e7c,0xb1edb15f,0x2d05b399
.long 0x3400,0xb18431cb,0xb3fe2248,0xb20fb13a,0x3400,0xadc23377,0xb15f31ed,0xb3252f32
.long 0x264633f6,0x27d633f1,0x28b233ea,0x297933e2,0x33f6a646,0x32f6afe3,0x30c4b26d,0x2b03b3ce
.long 0xa646b3f6,0xb24fb0ec,0xb3ea28b2,0xb09b328a,0xb3f62646,0xac4433b6,0x326d30c4,0x32c2b048
.long 0x264633f6,0x33f1a7d6,0xa8b2b3ea,0xb3e22979,0x33f6a646,0xafe3b2f6,0xb0c4326d,0x33ce2b03
.long 0xa646b3f6,0xb0ec324f,0x33eaa8b2,0xb28ab09b,0xb3f62646,0x33b62c44,0xb26db0c4,0x304832c2
.long 0x264633f6,0xa7d6b3f1,0x28b233ea,0xa979b3e2,0x33f6a646,0xb2f62fe3,0x30c4b26d,0xab0333ce
.long 0xa646b3f6,0x324f30ec,0xb3ea28b2,0x309bb28a,0xb3f62646,0x2c44b3b6,0x326d30c4,0xb2c23048
.long 0x264633f6,0xb3f127d6,0xa8b2b3ea,0x33e2a979,0x33f6a646,0x2fe332f6,0xb0c4326d,0xb3ceab03
.long 0xa646b3f6,0x30ecb24f,0x33eaa8b2,0x328a309b,0xb3f62646,0xb3b6ac44,0xb26db0c4,0xb048b2c2
.long 0x2a3e33d9,0x2b0333ce,0x2bc633c3,0x2c4433b6,0xaa3eb3d9,0xb09bb28a,0xb2ddb01d,0xb3f1a7d6
.long 0x2a3e33d9,0x32c23048,0x33c3abc6,0x2fe3b2f6,0xaa3eb3d9,0xb3e2a979,0xb01d32dd,0x30ec324f
.long 0x2a3e33d9,0x33ceab03,0xabc6b3c3,0xb3b62c44,0xaa3eb3d9,0xb28a309b,0x32dd301d,0x27d6b3f1
.long 0x2a3e33d9,0x3048b2c2,0xb3c32bc6,0x32f62fe3,0xaa3eb3d9,0xa97933e2,0x301db2dd,0xb24f30ec
.long 0x2a3e33d9,0xab03b3ce,0x2bc633c3,0xac44b3b6,0xaa3eb3d9,0x309b328a,0xb2ddb01d,0x33f127d6
.long 0x2a3e33d9,0xb2c2b048,0x33c3abc6,0xafe332f6,0xaa3eb3d9,0x33e22979,0xb01d32dd,0xb0ecb24f
.long 0x2a3e33d9,0xb3ce2b03,0xabc6b3c3,0x33b6ac44,0xaa3eb3d9,0x328ab09b,0x32dd301d,0xa7d633f1
.long 0x2a3e33d9,0xb04832c2,0xb3c32bc6,0xb2f6afe3,0xaa3eb3d9,0x2979b3e2,0x301db2dd,0x324fb0ec
.long 0x2ca533a8,0x2d053399,0x2d643388,0x2dc23377,0xb3a82ca5,0xb20f313a,0xaed7333b,0x9e4833ff
.long 0xaca5b3a8,0xb325af32,0xb3882d64,0xae7c3350,0x33a8aca5,0x24b5b3fa,0xb33baed7,0xb1cb3184
.long 0x2ca533a8,0x3399ad05,0xad64b388,0xb3772dc2,0xb3a82ca5,0x313a320f,0x2ed7b33b,0xb3ff9e48
.long 0xaca5b3a8,0xaf323325,0x3388ad64,0xb350ae7c,0x33a8aca5,0xb3faa4b5,0x333b2ed7,0xb184b1cb
.long 0x2ca533a8,0xad05b399,0x2d643388,0xadc2b377,0xb3a82ca5,0x320fb13a,0xaed7333b,0x1e48b3ff
.long 0xaca5b3a8,0x33252f32,0xb3882d64,0x2e7cb350,0x33a8aca5,0xa4b533fa,0xb33baed7,0x31cbb184
.long 0x2ca533a8,0xb3992d05,0xad64b388,0x3377adc2,0xb3a82ca5,0xb13ab20f,0x2ed7b33b,0x33ff1e48
.long 0xaca5b3a8,0x2f32b325,0x3388ad64,0x33502e7c,0x33a8aca5,0x33fa24b5,0x333b2ed7,0x318431cb
.long 0x34008000,0x33ff9e48,0x33fea248,0x33faa4b5,0x34008000,0x3350ae7c,0x315fb1ed,0x2d05b399
.long 0x34008000,0x3184b1cb,0xa248b3fe,0xb20fb13a,0x34008000,0x2dc2b377,0xb1edb15f,0xb3252f32
.long 0x34008000,0x9e48b3ff,0xb3fe2248,0x24b533fa,0x34008000,0xae7cb350,0xb15f31ed,0x33992d05
.long 0x34008000,0xb1cbb184,0x224833fe,0x313ab20f,0x34008000,0xb377adc2,0x31ed315f,0xaf32b325
.long 0x34008000,0xb3ff1e48,0x33fea248,0xb3fa24b5,0x34008000,0xb3502e7c,0x315fb1ed,0xad053399
.long 0x34008000,0xb18431cb,0xa248b3fe,0x320f313a,0x34008000,0xadc23377,0xb1edb15f,0x3325af32
.long 0x34008000,0x1e4833ff,0xb3fe2248,0xa4b5b3fa,0x34008000,0x2e7c3350,0xb15f31ed,0xb399ad05
.long 0x34008000,0x31cb3184,0x224833fe,0xb13a320f,0x34008000,0x33772dc2,0x31ed315f,0x2f323325
.long 0x33f6a646,0x33f1a7d6,0x33eaa8b2,0x33e2a979,0xa646b3f6,0xafe3b2f6,0xb26db0c4,0xb3ceab03
.long 0xb3f62646,0xb0ec324f,0x28b233ea,0x328a309b,0x264633f6,0x33b62c44,0x30c4b26d,0xb048b2c2
.long 0x33f6a646,0xa7d6b3f1,0xb3ea28b2,0x297933e2,0xa646b3f6,0xb2f62fe3,0x326d30c4,0x2b03b3ce
.long 0xb3f62646,0x324f30ec,0xa8b2b3ea,0xb09b328a,0x264633f6,0x2c44b3b6,0xb0c4326d,0x32c2b048
.long 0x33f6a646,0xb3f127d6,0x33eaa8b2,0xb3e22979,0xa646b3f6,0x2fe332f6,0xb26db0c4,0x33ce2b03
.long 0xb3f62646,0x30ecb24f,0x28b233ea,0xb28ab09b,0x264633f6,0xb3b6ac44,0x30c4b26d,0x304832c2
.long 0x33f6a646,0x27d633f1,0xb3ea28b2,0xa979b3e2,0xa646b3f6,0x32f6afe3,0x326d30c4,0xab0333ce
.long 0xb3f62646,0xb24fb0ec,0xa8b2b3ea,0x309bb28a,0x264633f6,0xac4433b6,0xb0c4326d,0xb2c23048
.long 0x33d9aa3e,0x33ceab03,0x33c3abc6,0x33b6ac44,0xb3d92a3e,0xb28a309b,0xb01d32dd,0xa7d633f1
.long 0x33d9aa3e,0x3048b2c2,0xabc6b3c3,0xb2f6afe3,0xb3d92a3e,0xa97933e2,0x32dd301d,0x324fb0ec
.long 0x33d9aa3e,0xab03b3ce,0xb3c32bc6,0x2c4433b6,0xb3d92a3e,0x309b328a,0x301db2dd,0xb3f1a7d6
.long 0x33d9aa3e,0xb2c2b048,0x2bc633c3,0x2fe3b2f6,0xb3d92a3e,0x33e22979,0xb2ddb01d,0x30ec324f
.long 0x33d9aa3e,0xb3ce2b03,0x33c3abc6,0xb3b62c44,0xb3d92a3e,0x328ab09b,0xb01d32dd,0x27d6b3f1
.long 0x33d9aa3e,0xb04832c2,0xabc6b3c3,0x32f62fe3,0xb3d92a3e,0x2979b3e2,0x32dd301d,0xb24f30ec
.long 0x33d9aa3e,0x2b0333ce,0xb3c32bc6,0xac44b3b6,0xb3d92a3e,0xb09bb28a,0x301db2dd,0x33f127d6
.long 0x33d9aa3e,0x32c23048,0x2bc633c3,0xafe332f6,0xb3d92a3e,0xb3e2a979,0xb2ddb01d,0xb0ecb24f
.long 0x33a8aca5,0x3399ad05,0x3388ad64,0x3377adc2,0x2ca533a8,0x313a320f,0x333b2ed7,0x33ff1e48
.long 0xb3a82ca5,0xaf323325,0x2d643388,0x33502e7c,0xaca5b3a8,0xb3faa4b5,0xaed7333b,0x318431cb
.long 0x33a8aca5,0xad05b399,0xb3882d64,0x2dc23377,0x2ca533a8,0x320fb13a,0xb33baed7,0x9e4833ff
.long 0xb3a82ca5,0x33252f32,0xad64b388,0xae7c3350,0xaca5b3a8,0xa4b533fa,0x2ed7b33b,0xb1cb3184
.long 0x33a8aca5,0xb3992d05,0x3388ad64,0xb3772dc2,0x2ca533a8,0xb13ab20f,0x333b2ed7,0xb3ff9e48
.long 0xb3a82ca5,0x2f32b325,0x2d643388,0xb350ae7c,0xaca5b3a8,0x33fa24b5,0xaed7333b,0xb184b1cb
.long 0x33a8aca5,0x2d053399,0xb3882d64,0xadc2b377,0x2ca533a8,0xb20f313a,0xb33baed7,0x1e48b3ff
.long 0xb3a82ca5,0xb325af32,0xad64b388,0x2e7cb350,0xaca5b3a8,0x24b5b3fa,0x2ed7b33b,0x31cbb184
.long 0x3c013c01,0x3c013c01,0x1a4a0000,0x20b81e4a,0x3bff3c01,0x3be93bf7,0x2aae0000,0x30fe2eac
.long 0x3bf83c01,0x3ba43bd8,0x2e7a0000,0x34ca3271,0x3beb3c01,0x3b353ba6,0x30cc0000,0x36fb34be
.long 0x3bda3c01,0x3a9e3b61,0x32590000,0x38833638,0x3bc33c01,0x39e23b0a,0x33e10000,0x396f37a3
.long 0x3ba83c01,0x39063aa2,0x34b20000,0x3a3d387d,0x3b883c01,0x380e3a29,0x35710000,0x3ae8391e
.long 0x3b643c01,0x35fe39a1,0x362d0000,0x3b6d39b3,0x3b3b3c01,0x337f390b,0x36e40000,0x3bc93a39
.long 0x3b0d3c01,0x2db13869,0x37980000,0x3bfa3ab0,0x3adb3c01,0xab773777,0x38230000,0x3bff3b16
.long 0x3aa53c01,0xb28a360a,0x38780000,0x3bd73b6b,0x3a6b3c01,0xb589348e,0x38ca0000,0x3b843bad
.long 0x3a2d3c01,0xb7ae320e,0x39190000,0x3b073bdd,0x39eb3c01,0xb8d42de3,0x39650000,0x3a633bf9
.long 0x3c013c01,0x3c013c01,0x23dd224a,0x258124b8,0x3bbd3bd6,0x3b7b3b9f,0x342132a2,0x35b834ee
.long 0x3b013b5c,0x3a153a93,0x37c4364f,0x39363892,0x39da3a9b,0x37f038f7,0x39783888,0x3af53a48
.long 0x38593998,0x319335db,0x3aba39bb,0x3be33b74,0x352a385e,0xb1612d1b,0x3b953ab6,0x3be53bfc
.long 0x2d4d35f3,0xb7dab2d4,0x3bfb3b70,0x3afb3bd3,0xb13031dd,0xba0cb7cf,0x3be73be0,0x39403afe
.long 0xb65ba24a,0xbb77b9c4,0x3b5a3c01,0x35cf398f,0xb8deb2a2,0xbc01bb22,0x3a5c3bd6,0x2713374a
.long 0xba45b64f,0xbb9dbbe2,0x38fc3b5c,0xb4fa31ac,0xbb4bb888,0xba54bbf4,0x36a03a9b,0xb8e8af74
.long 0xbbe1b9bb,0xb84ebb57,0x31c43998,0xbac1b667,0xbbfebab6,0xb31dba19,0xac20385e,0xbbcfb932
.long 0xbba1bb70,0x2fa6b853,0xb4e235f3,0xbbf4babd,0xbacebbe0,0x3728b45e,0xb83931dd,0xbb2abbb5
.long 0x3c013c01,0x3c013c01,0x1a4a0000,0x20b81e4a,0x3bff3c01,0x3be93bf7,0x2aae0000,0x30fe2eac
.long 0x3bf83c01,0x3ba43bd8,0x2e7a0000,0x34ca3271,0x3beb3c01,0x3b353ba6,0x30cc0000,0x36fb34be
.long 0x3bda3c01,0x3a9e3b61,0x32590000,0x38833638,0x3bc33c01,0x39e23b0a,0x33e10000,0x396f37a3
.long 0x3ba83c01,0x39063aa2,0x34b20000,0x3a3d387d,0x3b883c01,0x380e3a29,0x35710000,0x3ae8391e
.long 0x3b643c01,0x35fe39a1,0x362d0000,0x3b6d39b3,0x3b3b3c01,0x337f390b,0x36e40000,0x3bc93a39
.long 0x3b0d3c01,0x2db13869,0x37980000,0x3bfa3ab0,0x3adb3c01,0xab773777,0x38230000,0x3bff3b16
.long 0x3aa53c01,0xb28a360a,0x38780000,0x3bd73b6b,0x3a6b3c01,0xb589348e,0x38ca0000,0x3b843bad
.long 0x3a2d3c01,0xb7ae320e,0x39190000,0x3b073bdd,0x39eb3c01,0xb8d42de3,0x39650000,0x3a633bf9
.long 0x3c013c01,0x3c013c01,0x23dd224a,0x258124b8,0x3bbd3bd6,0x3b7b3b9f,0x342132a2,0x35b834ee
.long 0x3b013b5c,0x3a153a93,0x37c4364f,0x39363892,0x39da3a9b,0x37f038f7,0x39783888,0x3af53a48
.long 0x38593998,0x319335db,0x3aba39bb,0x3be33b74,0x352a385e,0xb1612d1b,0x3b953ab6,0x3be53bfc
.long 0x2d4d35f3,0xb7dab2d4,0x3bfb3b70,0x3afb3bd3,0xb13031dd,0xba0cb7cf,0x3be73be0,0x39403afe
.long 0xb65ba24a,0xbb77b9c4,0x3b5a3c01,0x35cf398f,0xb8deb2a2,0xbc01bb22,0x3a5c3bd6,0x2713374a
.long 0xba45b64f,0xbb9dbbe2,0x38fc3b5c,0xb4fa31ac,0xbb4bb888,0xba54bbf4,0x36a03a9b,0xb8e8af74
.long 0xbbe1b9bb,0xb84ebb57,0x31c43998,0xbac1b667,0xbbfebab6,0xb31dba19,0xac20385e,0xbbcfb932
.long 0xbba1bb70,0x2fa6b853,0xb4e235f3,0xbbf4babd,0xbacebbe0,0x3728b45e,0xb83931dd,0xbb2abbb5
.long 0x3400,0x224833fe,0x264633f6,0x28b233ea,0x3400,0x2ed7333b,0x322f3113,0x33c32bc6
.long 0x3400,0x31ed315f,0x33f6a646,0x30c4b26d,0x3400,0x33882d64,0x3113b22f,0xb01db2dd
.long 0x3400,0x33fea248,0xa646b3f6,0xb3ea28b2,0x3400,0x333baed7,0xb22fb113,0xabc633c3
.long 0x3400,0x315fb1ed,0xb3f62646,0x326d30c4,0x3400,0x2d64b388,0xb113322f,0x32ddb01d
.long 0x3400,0xa248b3fe,0x264633f6,0xa8b2b3ea,0x3400,0xaed7b33b,0x322f3113,0xb3c3abc6
.long 0x3400,0xb1edb15f,0x33f6a646,0xb0c4326d,0x3400,0xb388ad64,0x3113b22f,0x301d32dd
.long 0x3400,0xb3fe2248,0xa646b3f6,0x33eaa8b2,0x3400,0xb33b2ed7,0xb22fb113,0x2bc6b3c3
.long 0x3400,0xb15f31ed,0xb3f62646,0xb26db0c4,0x3400,0xad643388,0xb113322f,0xb2dd301d
.long 0x2a3e33d9,0x2bc633c3,0x2ca533a8,0x2d643388,0x33d9aa3e,0x326db0c4,0x2f8bb30e,0x2248b3fe
.long 0xaa3eb3d9,0xb2ddb01d,0xb3a82ca5,0xaed7333b,0xb3d92a3e,0xa8b233ea,0x330e2f8b,0x31edb15f
.long 0x2a3e33d9,0x33c3abc6,0xaca5b3a8,0xb3882d64,0x33d9aa3e,0xb0c4b26d,0xaf8b330e,0x33fe2248
.long 0xaa3eb3d9,0xb01d32dd,0x33a8aca5,0xb33baed7,0xb3d92a3e,0x33ea28b2,0xb30eaf8b,0x315f31ed
.long 0x2a3e33d9,0xabc6b3c3,0x2ca533a8,0xad64b388,0x33d9aa3e,0xb26d30c4,0x2f8bb30e,0xa24833fe
.long 0xaa3eb3d9,0x32dd301d,0xb3a82ca5,0x2ed7b33b,0xb3d92a3e,0x28b2b3ea,0x330e2f8b,0xb1ed315f
.long 0x2a3e33d9,0xb3c32bc6,0xaca5b3a8,0x3388ad64,0x33d9aa3e,0x30c4326d,0xaf8b330e,0xb3fea248
.long 0xaa3eb3d9,0x301db2dd,0x33a8aca5,0x333b2ed7,0xb3d92a3e,0xb3eaa8b2,0xb30eaf8b,0xb15fb1ed
.long 0x2e1f3364,0x2ed7333b,0x2f8b330e,0x301d32dd,0xae1fb364,0xb1edb15f,0xb3a8aca5,0xb3ea28b2
.long 0x2e1f3364,0x33882d64,0x330eaf8b,0x2bc6b3c3,0xae1fb364,0xb3fe2248,0xaca533a8,0x326d30c4
.long 0x2e1f3364,0x333baed7,0xaf8bb30e,0xb2dd301d,0xae1fb364,0xb15f31ed,0x33a82ca5,0xa8b2b3ea
.long 0x2e1f3364,0x2d64b388,0xb30e2f8b,0x33c32bc6,0xae1fb364,0x224833fe,0x2ca5b3a8,0xb0c4326d
.long 0x2e1f3364,0xaed7b33b,0x2f8b330e,0xb01db2dd,0xae1fb364,0x31ed315f,0xb3a8aca5,0x33eaa8b2
.long 0x2e1f3364,0xb388ad64,0x330eaf8b,0xabc633c3,0xae1fb364,0x33fea248,0xaca533a8,0xb26db0c4
.long 0x2e1f3364,0xb33b2ed7,0xaf8bb30e,0x32ddb01d,0xae1fb364,0x315fb1ed,0x33a82ca5,0x28b233ea
.long 0x2e1f3364,0xad643388,0xb30e2f8b,0xb3c3abc6,0xae1fb364,0xa248b3fe,0x2ca5b3a8,0x30c4b26d
.long 0x307232a7,0x30c4326d,0x3113322f,0x315f31ed,0xb2a73072,0xb01d32dd,0xa64633f6,0x2d643388
.long 0xb072b2a7,0xb3eaa8b2,0xb22f3113,0xa24833fe,0x32a7b072,0xabc6b3c3,0xb3f6a646,0xaed7333b
.long 0x307232a7,0x326db0c4,0xb113b22f,0xb1ed315f,0xb2a73072,0x32dd301d,0x2646b3f6,0xb3882d64
.long 0xb072b2a7,0xa8b233ea,0x322fb113,0xb3fea248,0x32a7b072,0xb3c32bc6,0x33f62646,0xb33baed7
.long 0x307232a7,0xb0c4b26d,0x3113322f,0xb15fb1ed,0xb2a73072,0x301db2dd,0xa64633f6,0xad64b388
.long 0xb072b2a7,0x33ea28b2,0xb22f3113,0x2248b3fe,0x32a7b072,0x2bc633c3,0xb3f6a646,0x2ed7b33b
.long 0x307232a7,0xb26d30c4,0xb113b22f,0x31edb15f,0xb2a73072,0xb2ddb01d,0x2646b3f6,0x3388ad64
.long 0xb072b2a7,0x28b2b3ea,0x322fb113,0x33fe2248,0x32a7b072,0x33c3abc6,0x33f62646,0x333b2ed7
.long 0x34008000,0x33fea248,0x33f6a646,0x33eaa8b2,0x34008000,0x333baed7,0x3113b22f,0x2bc6b3c3
.long 0x34008000,0x315fb1ed,0xa646b3f6,0xb26db0c4,0x34008000,0x2d64b388,0xb22fb113,0xb2dd301d
.long 0x34008000,0xa248b3fe,0xb3f62646,0x28b233ea,0x34008000,0xaed7b33b,0xb113322f,0x33c32bc6
.long 0x34008000,0xb1edb15f,0x264633f6,0x30c4b26d,0x34008000,0xb388ad64,0x322f3113,0xb01db2dd
.long 0x34008000,0xb3fe2248,0x33f6a646,0xb3ea28b2,0x34008000,0xb33b2ed7,0x3113b22f,0xabc633c3
.long 0x34008000,0xb15f31ed,0xa646b3f6,0x326d30c4,0x34008000,0xad643388,0xb22fb113,0x32ddb01d
.long 0x34008000,0x224833fe,0xb3f62646,0xa8b2b3ea,0x34008000,0x2ed7333b,0xb113322f,0xb3c3abc6
.long 0x34008000,0x31ed315f,0x264633f6,0xb0c4326d,0x34008000,0x33882d64,0x322f3113,0x301d32dd
.long 0x33d9aa3e,0x33c3abc6,0x33a8aca5,0x3388ad64,0xaa3eb3d9,0xb0c4b26d,0xb30eaf8b,0xb3fea248
.long 0xb3d92a3e,0xb01d32dd,0x2ca533a8,0x333b2ed7,0x2a3e33d9,0x33ea28b2,0x2f8bb30e,0xb15fb1ed
.long 0x33d9aa3e,0xabc6b3c3,0xb3a82ca5,0x2d643388,0xaa3eb3d9,0xb26d30c4,0x330e2f8b,0x2248b3fe
.long 0xb3d92a3e,0x32dd301d,0xaca5b3a8,0xaed7333b,0x2a3e33d9,0x28b2b3ea,0xaf8b330e,0x31edb15f
.long 0x33d9aa3e,0xb3c32bc6,0x33a8aca5,0xb3882d64,0xaa3eb3d9,0x30c4326d,0xb30eaf8b,0x33fe2248
.long 0xb3d92a3e,0x301db2dd,0x2ca533a8,0xb33baed7,0x2a3e33d9,0xb3eaa8b2,0x2f8bb30e,0x315f31ed
.long 0x33d9aa3e,0x2bc633c3,0xb3a82ca5,0xad64b388,0xaa3eb3d9,0x326db0c4,0x330e2f8b,0xa24833fe
.long 0xb3d92a3e,0xb2ddb01d,0xaca5b3a8,0x2ed7b33b,0x2a3e33d9,0xa8b233ea,0xaf8b330e,0xb1ed315f
.long 0x3364ae1f,0x333baed7,0x330eaf8b,0x32ddb01d,0xb3642e1f,0xb15f31ed,0xaca533a8,0x28b233ea
.long 0x3364ae1f,0x2d64b388,0xaf8bb30e,0xb3c3abc6,0xb3642e1f,0x224833fe,0x33a82ca5,0x30c4b26d
.long 0x3364ae1f,0xaed7b33b,0xb30e2f8b,0x301d32dd,0xb3642e1f,0x31ed315f,0x2ca5b3a8,0xb3ea28b2
.long 0x3364ae1f,0xb388ad64,0x2f8b330e,0x2bc6b3c3,0xb3642e1f,0x33fea248,0xb3a8aca5,0x326d30c4
.long 0x3364ae1f,0xb33b2ed7,0x330eaf8b,0xb2dd301d,0xb3642e1f,0x315fb1ed,0xaca533a8,0xa8b2b3ea
.long 0x3364ae1f,0xad643388,0xaf8bb30e,0x33c32bc6,0xb3642e1f,0xa248b3fe,0x33a82ca5,0xb0c4326d
.long 0x3364ae1f,0x2ed7333b,0xb30e2f8b,0xb01db2dd,0xb3642e1f,0xb1edb15f,0x2ca5b3a8,0x33eaa8b2
.long 0x3364ae1f,0x33882d64,0x2f8b330e,0xabc633c3,0xb3642e1f,0xb3fe2248,0xb3a8aca5,0xb26db0c4
.long 0x32a7b072,0x326db0c4,0x322fb113,0x31edb15f,0x307232a7,0x32dd301d,0x33f62646,0x3388ad64
.long 0xb2a73072,0xa8b233ea,0x3113322f,0x33fe2248,0xb072b2a7,0xb3c32bc6,0xa64633f6,0x333b2ed7
.long 0x32a7b072,0xb0c4b26d,0xb22f3113,0x315f31ed,0x307232a7,0x301db2dd,0xb3f6a646,0x2d643388
.long 0xb2a73072,0x33ea28b2,0xb113b22f,0xa24833fe,0xb072b2a7,0x2bc633c3,0x2646b3f6,0xaed7333b
.long 0x32a7b072,0xb26d30c4,0x322fb113,0xb1ed315f,0x307232a7,0xb2ddb01d,0x33f62646,0xb3882d64
.long 0xb2a73072,0x28b2b3ea,0x3113322f,0xb3fea248,0xb072b2a7,0x33c3abc6,0xa64633f6,0xb33baed7
.long 0x32a7b072,0x30c4326d,0xb22f3113,0xb15fb1ed,0x307232a7,0xb01d32dd,0xb3f6a646,0xad64b388
.long 0xb2a73072,0xb3eaa8b2,0xb113b22f,0x2248b3fe,0xb072b2a7,0xabc6b3c3,0x2646b3f6,0x2ed7b33b
.long 0x3c013c01,0x3c013c01,0x1e4a0000,0x24b8224a,0x3bff3c01,0x3be63bf6,0x2b130000,0x31482f10
.long 0x3bf73c01,0x3b9f3bd6,0x2eac0000,0x34ee32a2,0x3bea3c01,0x3b2d3ba2,0x30e50000,0x371d34d6
.long 0x3bd83c01,0x3a933b5c,0x32710000,0x3892364f,0x3bc23c01,0x39d53b04,0x33f90000,0x397d37b9
.long 0x3ba63c01,0x38f73a9b,0x34be0000,0x3a483888,0x3b863c01,0x37fb3a21,0x357d0000,0x3af23928
.long 0x3b613c01,0x35db3998,0x36380000,0x3b7439bb,0x3b383c01,0x33363901,0x36f00000,0x3bce3a41
.long 0x3b0a3c01,0x2d1b385e,0x37a30000,0x3bfc3ab6,0x3ad83c01,0xac523760,0x38290000,0x3bfd3b1c
.long 0x3aa23c01,0xb2d435f3,0x387d0000,0x3bd33b70,0x3a673c01,0xb5ac3476,0x38cf0000,0x3b7d3bb1
.long 0x3a293c01,0xb7cf31dd,0x391e0000,0x3afe3be0,0x39e73c01,0xb8e32d7f,0x396a0000,0x3a583bfb
.long 0x3c013c01,0x3c003c00,0x27dc264a,0x298028b7,0x3bb53bd0,0x3b6b3b93,0x345e3305,0x360a3536
.long 0x3af23b52,0x39f73a7e,0x37fb367e,0x395738b1,0x39c43a8c,0x37a338d9,0x398f389d,0x3b0a3a60
.long 0x383e3986,0x30e53595,0x3acb39cd,0x3bea3b82,0x34ee3849,0xb20e2bdb,0x3b9f3ac4,0x3bdd3bfe
.long 0x2c5235c4,0xb813b367,0x3bfd3b79,0x3ae53bcb,0xb1ac317a,0xba29b808,0x3be23be4,0x391e3aeb
.long 0xb695a64a,0xbb86b9de,0x3b4d3c01,0x357d3973,0xb8f7b305,0xbc01bb32,0x3a483bd0,0x1e4a3706
.long 0xba58b67e,0xbb8fbbe8,0x38e33b52,0xb54e3117,0xbb57b89d,0xba39bbf0,0x36673a8c,0xb90bb050
.long 0xbbe6b9cd,0xb829bb48,0x31483986,0xbad8b6ab,0xbbfcbac4,0xb271ba00,0xad1b3849,0xbbd8b94e
.long 0xbb97bb79,0x3081b833,0xb51e35c4,0xbbeebad1,0xbabdbbe4,0x3777b415,0xb853317a,0xbb16bbbe
.long 0x3c013c01,0x3c013c01,0x1e4a0000,0x24b8224a,0x3bff3c01,0x3be63bf6,0x2b130000,0x31482f10
.long 0x3bf73c01,0x3b9f3bd6,0x2eac0000,0x34ee32a2,0x3bea3c01,0x3b2d3ba2,0x30e50000,0x371d34d6
.long 0x3bd83c01,0x3a933b5c,0x32710000,0x3892364f,0x3bc23c01,0x39d53b04,0x33f90000,0x397d37b9
.long 0x3ba63c01,0x38f73a9b,0x34be0000,0x3a483888,0x3b863c01,0x37fb3a21,0x357d0000,0x3af23928
.long 0x3b613c01,0x35db3998,0x36380000,0x3b7439bb,0x3b383c01,0x33363901,0x36f00000,0x3bce3a41
.long 0x3b0a3c01,0x2d1b385e,0x37a30000,0x3bfc3ab6,0x3ad83c01,0xac523760,0x38290000,0x3bfd3b1c
.long 0x3aa23c01,0xb2d435f3,0x387d0000,0x3bd33b70,0x3a673c01,0xb5ac3476,0x38cf0000,0x3b7d3bb1
.long 0x3a293c01,0xb7cf31dd,0x391e0000,0x3afe3be0,0x39e73c01,0xb8e32d7f,0x396a0000,0x3a583bfb
.long 0x3c013c01,0x3c003c00,0x27dc264a,0x298028b7,0x3bb53bd0,0x3b6b3b93,0x345e3305,0x360a3536
.long 0x3af23b52,0x39f73a7e,0x37fb367e,0x395738b1,0x39c43a8c,0x37a338d9,0x398f389d,0x3b0a3a60
.long 0x383e3986,0x30e53595,0x3acb39cd,0x3bea3b82,0x34ee3849,0xb20e2bdb,0x3b9f3ac4,0x3bdd3bfe
.long 0x2c5235c4,0xb813b367,0x3bfd3b79,0x3ae53bcb,0xb1ac317a,0xba29b808,0x3be23be4,0x391e3aeb
.long 0xb695a64a,0xbb86b9de,0x3b4d3c01,0x357d3973,0xb8f7b305,0xbc01bb32,0x3a483bd0,0x1e4a3706
.long 0xba58b67e,0xbb8fbbe8,0x38e33b52,0xb54e3117,0xbb57b89d,0xba39bbf0,0x36673a8c,0xb90bb050
.long 0xbbe6b9cd,0xb829bb48,0x31483986,0xbad8b6ab,0xbbfcbac4,0xb271ba00,0xad1b3849,0xbbd8b94e
.long 0xbb97bb79,0x3081b833,0xb51e35c4,0xbbeebad1,0xbabdbbe4,0x3777b415,0xb853317a,0xbb16bbbe
.long 0x3400,0x24b533fa,0x28b233ea,0x2b0333ce,0x3400,0x2f323325,0x326d30c4,0x33e22979
.long 0x3400,0x320f313a,0x33eaa8b2,0x3048b2c2,0x3400,0x33992d05,0x30c4b26d,0xb09bb28a
.long 0x3400,0x33faa4b5,0xa8b2b3ea,0xb3ce2b03,0x3400,0x3325af32,0xb26db0c4,0xa97933e2
.long 0x3400,0x313ab20f,0xb3ea28b2,0x32c23048,0x3400,0x2d05b399,0xb0c4326d,0x328ab09b
.long 0x3400,0xa4b5b3fa,0x28b233ea,0xab03b3ce,0x3400,0xaf32b325,0x326d30c4,0xb3e2a979
.long 0x3400,0xb20fb13a,0x33eaa8b2,0xb04832c2,0x3400,0xb399ad05,0x30c4b26d,0x309b328a
.long 0x3400,0xb3fa24b5,0xa8b2b3ea,0x33ceab03,0x3400,0xb3252f32,0xb26db0c4,0x2979b3e2
.long 0x3400,0xb13a320f,0xb3ea28b2,0xb2c2b048,0x3400,0xad053399,0xb0c4326d,0xb28a309b
.long 0x2ca533a8,0x2dc23377,0x2ed7333b,0x2fe332f6,0x33a8aca5,0x31cbb184,0x2d64b388,0xa7d6b3f1
.long 0xaca5b3a8,0xb350ae7c,0xb33b2ed7,0xac4433b6,0xb3a82ca5,0x9e4833ff,0x33882d64,0x30ecb24f
.long 0x2ca533a8,0x3377adc2,0xaed7b33b,0xb2f62fe3,0x33a8aca5,0xb184b1cb,0xad643388,0x33f1a7d6
.long 0xaca5b3a8,0xae7c3350,0x333baed7,0xb3b6ac44,0xb3a82ca5,0x33ff1e48,0xb388ad64,0x324f30ec
.long 0x2ca533a8,0xadc2b377,0x2ed7333b,0xafe3b2f6,0x33a8aca5,0xb1cb3184,0x2d64b388,0x27d633f1
.long 0xaca5b3a8,0x33502e7c,0xb33b2ed7,0x2c44b3b6,0xb3a82ca5,0x1e48b3ff,0x33882d64,0xb0ec324f
.long 0x2ca533a8,0xb3772dc2,0xaed7b33b,0x32f6afe3,0x33a8aca5,0x318431cb,0xad643388,0xb3f127d6
.long 0xaca5b3a8,0x2e7cb350,0x333baed7,0x33b62c44,0xb3a82ca5,0xb3ff9e48,0xb388ad64,0xb24fb0ec
.long 0x307232a7,0x30ec324f,0x315f31ed,0x31cb3184,0xb072b2a7,0xb2f6afe3,0xb3fea248,0xb3502e7c
.long 0x307232a7,0x33f127d6,0x31edb15f,0x9e48b3ff,0xb072b2a7,0xb3b62c44,0xa24833fe,0x33772dc2
.long 0x307232a7,0x324fb0ec,0xb15fb1ed,0xb18431cb,0xb072b2a7,0xafe332f6,0x33fe2248,0xae7cb350
.long 0x307232a7,0x27d6b3f1,0xb1ed315f,0x33ff9e48,0xb072b2a7,0x2c4433b6,0x2248b3fe,0xadc23377
.long 0x307232a7,0xb0ecb24f,0x315f31ed,0xb1cbb184,0xb072b2a7,0x32f62fe3,0xb3fea248,0x3350ae7c
.long 0x307232a7,0xb3f1a7d6,0x31edb15f,0x1e4833ff,0xb072b2a7,0x33b6ac44,0xa24833fe,0xb377adc2
.long 0x307232a7,0xb24f30ec,0xb15fb1ed,0x3184b1cb,0xb072b2a7,0x2fe3b2f6,0x33fe2248,0x2e7c3350
.long 0x307232a7,0xa7d633f1,0xb1ed315f,0xb3ff1e48,0xb072b2a7,0xac44b3b6,0x2248b3fe,0x2dc2b377
.long 0x322f3113,0x328a309b,0x32dd301d,0x33252f32,0xb113322f,0xab0333ce,0x2bc633c3,0x313a320f
.long 0xb22fb113,0xb3e22979,0xb01d32dd,0x2d053399,0x3113b22f,0xb048b2c2,0xb3c32bc6,0xa4b533fa
.long 0x322f3113,0x309bb28a,0xb2ddb01d,0xaf323325,0xb113322f,0x33ce2b03,0xabc6b3c3,0xb20f313a
.long 0xb22fb113,0x297933e2,0x301db2dd,0xb3992d05,0x3113b22f,0xb2c23048,0x33c3abc6,0xb3faa4b5
.long 0x322f3113,0xb28ab09b,0x32dd301d,0xb325af32,0xb113322f,0x2b03b3ce,0x2bc633c3,0xb13ab20f
.long 0xb22fb113,0x33e2a979,0xb01d32dd,0xad05b399,0x3113b22f,0x304832c2,0xb3c32bc6,0x24b5b3fa
.long 0x322f3113,0xb09b328a,0xb2ddb01d,0x2f32b325,0xb113322f,0xb3ceab03,0xabc6b3c3,0x320fb13a
.long 0xb22fb113,0xa979b3e2,0x301db2dd,0x3399ad05,0x3113b22f,0x32c2b048,0x33c3abc6,0x33fa24b5
.long 0x34008000,0x33faa4b5,0x33eaa8b2,0x33ceab03,0x34008000,0x3325af32,0x30c4b26d,0x2979b3e2
.long 0x34008000,0x313ab20f,0xa8b2b3ea,0xb2c2b048,0x34008000,0x2d05b399,0xb26db0c4,0xb28a309b
.long 0x34008000,0xa4b5b3fa,0xb3ea28b2,0x2b0333ce,0x34008000,0xaf32b325,0xb0c4326d,0x33e22979
.long 0x34008000,0xb20fb13a,0x28b233ea,0x3048b2c2,0x34008000,0xb399ad05,0x326d30c4,0xb09bb28a
.long 0x34008000,0xb3fa24b5,0x33eaa8b2,0xb3ce2b03,0x34008000,0xb3252f32,0x30c4b26d,0xa97933e2
.long 0x34008000,0xb13a320f,0xa8b2b3ea,0x32c23048,0x34008000,0xad053399,0xb26db0c4,0x328ab09b
.long 0x34008000,0x24b533fa,0xb3ea28b2,0xab03b3ce,0x34008000,0x2f323325,0xb0c4326d,0xb3e2a979
.long 0x34008000,0x320f313a,0x28b233ea,0xb04832c2,0x34008000,0x33992d05,0x326d30c4,0x309b328a
.long 0x33a8aca5,0x3377adc2,0x333baed7,0x32f6afe3,0xaca5b3a8,0xb184b1cb,0xb388ad64,0xb3f127d6
.long 0xb3a82ca5,0xae7c3350,0x2ed7333b,0x33b62c44,0x2ca533a8,0x33ff1e48,0x2d64b388,0xb24fb0ec
.long 0x33a8aca5,0xadc2b377,0xb33b2ed7,0x2fe332f6,0xaca5b3a8,0xb1cb3184,0x33882d64,0xa7d6b3f1
.long 0xb3a82ca5,0x33502e7c,0xaed7b33b,0xac4433b6,0x2ca533a8,0x1e48b3ff,0xad643388,0x30ecb24f
.long 0x33a8aca5,0xb3772dc2,0x333baed7,0xb2f62fe3,0xaca5b3a8,0x318431cb,0xb388ad64,0x33f1a7d6
.long 0xb3a82ca5,0x2e7cb350,0x2ed7333b,0xb3b6ac44,0x2ca533a8,0xb3ff9e48,0x2d64b388,0x324f30ec
.long 0x33a8aca5,0x2dc23377,0xb33b2ed7,0xafe3b2f6,0xaca5b3a8,0x31cbb184,0x33882d64,0x27d633f1
.long 0xb3a82ca5,0xb350ae7c,0xaed7b33b,0x2c44b3b6,0x2ca533a8,0x9e4833ff,0xad643388,0xb0ec324f
.long 0x32a7b072,0x324fb0ec,0x31edb15f,0x3184b1cb,0xb2a73072,0xafe332f6,0xa24833fe,0x2e7c3350
.long 0x32a7b072,0x27d6b3f1,0xb15fb1ed,0xb3ff1e48,0xb2a73072,0x2c4433b6,0x33fe2248,0x2dc2b377
.long 0x32a7b072,0xb0ecb24f,0xb1ed315f,0x31cb3184,0xb2a73072,0x32f62fe3,0x2248b3fe,0xb3502e7c
.long 0x32a7b072,0xb3f1a7d6,0x315f31ed,0x9e48b3ff,0xb2a73072,0x33b6ac44,0xb3fea248,0x33772dc2
.long 0x32a7b072,0xb24f30ec,0x31edb15f,0xb18431cb,0xb2a73072,0x2fe3b2f6,0xa24833fe,0xae7cb350
.long 0x32a7b072,0xa7d633f1,0xb15fb1ed,0x33ff9e48,0xb2a73072,0xac44b3b6,0x33fe2248,0xadc23377
.long 0x32a7b072,0x30ec324f,0xb1ed315f,0xb1cbb184,0xb2a73072,0xb2f6afe3,0x2248b3fe,0x3350ae7c
.long 0x32a7b072,0x33f127d6,0x315f31ed,0x1e4833ff,0xb2a73072,0xb3b62c44,0xb3fea248,0xb377adc2
.long 0x3113b22f,0x309bb28a,0x301db2dd,0x2f32b325,0x322f3113,0x33ce2b03,0x33c3abc6,0x320fb13a
.long 0xb113322f,0x297933e2,0x32dd301d,0x3399ad05,0xb22fb113,0xb2c23048,0x2bc633c3,0x33fa24b5
.long 0x3113b22f,0xb28ab09b,0xb01d32dd,0x33252f32,0x322f3113,0x2b03b3ce,0xb3c32bc6,0x313a320f
.long 0xb113322f,0x33e2a979,0xb2ddb01d,0x2d053399,0xb22fb113,0x304832c2,0xabc6b3c3,0xa4b533fa
.long 0x3113b22f,0xb09b328a,0x301db2dd,0xaf323325,0x322f3113,0xb3ceab03,0x33c3abc6,0xb20f313a
.long 0xb113322f,0xa979b3e2,0x32dd301d,0xb3992d05,0xb22fb113,0x32c2b048,0x2bc633c3,0xb3faa4b5
.long 0x3113b22f,0x328a309b,0xb01d32dd,0xb325af32,0x322f3113,0xab0333ce,0xb3c32bc6,0xb13ab20f
.long 0xb113322f,0xb3e22979,0xb2ddb01d,0xad05b399,0xb22fb113,0xb048b2c2,0xabc6b3c3,0x24b5b3fa
.long 0x3c013c01,0x3c013c01,0x20b80000,0x271324b8,0x3bff3c01,0x3be33bf4,0x2b770000,0x31932f74
.long 0x3bf63c01,0x3b993bd3,0x2ede0000,0x351232d4,0x3be93c01,0x3b243b9f,0x30fe0000,0x373f34ee
.long 0x3bd73c01,0x3a893b57,0x328a0000,0x38a23667,0x3bc03c01,0x39c83afe,0x34090000,0x398a37cf
.long 0x3ba43c01,0x38e83a93,0x34ca0000,0x3a543892,0x3b843c01,0x37da3a19,0x35890000,0x3afb3932
.long 0x3b5f3c01,0x35b8398f,0x36440000,0x3b7b39c4,0x3b353c01,0x32ec38f7,0x36fb0000,0x3bd23a48
.long 0x3b073c01,0x2c843853,0x37ae0000,0x3bfd3abd,0x3ad53c01,0xace9374a,0x382e0000,0x3bfc3b22
.long 0x3a9e3c01,0xb31d35db,0x38830000,0x3bcf3b74,0x3a633c01,0xb5cf345e,0x38d40000,0x3b773bb5
.long 0x3a253c01,0xb7f031ac,0x39230000,0x3af53be2,0x39e23c01,0xb8f22d1b,0x396f0000,0x3a4c3bfc
.long 0x3c003c00,0x3bfe3bff,0x29e528b7,0x2c202b13,0x3bac3bcb,0x3b5a3b86,0x349a3367,0x365b357d
.long 0x3ae23b48,0x39da3a67,0x381936ab,0x397838cf,0x39ae3a7e,0x375538bb,0x39a538b1,0x3b1f3a76
.long 0x38233973,0x3037354e,0x3adb39de,0x3bf03b8f,0x34b23833,0xb2bb2980,0x3ba83ad1,0x3bd43c00
.long 0x2aae3595,0xb839b3f9,0x3bff3b82,0x3ace3bc2,0xb2273117,0xba45b829,0x3bdc3be8,0x38fc3ad8
.long 0xb6cea8b7,0xbb95b9f7,0x3b403c00,0x352a3957,0xb910b367,0xbc01bb43,0x3a353bcb,0xa3dd36c2
.long 0xba6bb6ab,0xbb7fbbee,0x38ca3b48,0xb5a03081,0xbb64b8b1,0xba1dbbea,0x362d3a7e,0xb92db0e5
.long 0xbbebb9de,0xb803bb38,0x30cc3973,0xbaeeb6f0,0xbbf9bad1,0xb1c4b9e7,0xae163833,0xbbe1b96a
.long 0xbb8cbb82,0x3130b813,0xb55a3595,0xbbe7bae5,0xbaacbbe8,0x37c4b398,0xb86e3117,0xbb01bbc8
.long 0x3c013c01,0x3c013c01,0x20b80000,0x271324b8,0x3bff3c01,0x3be33bf4,0x2b770000,0x31932f74
.long 0x3bf63c01,0x3b993bd3,0x2ede0000,0x351232d4,0x3be93c01,0x3b243b9f,0x30fe0000,0x373f34ee
.long 0x3bd73c01,0x3a893b57,0x328a0000,0x38a23667,0x3bc03c01,0x39c83afe,0x34090000,0x398a37cf
.long 0x3ba43c01,0x38e83a93,0x34ca0000,0x3a543892,0x3b843c01,0x37da3a19,0x35890000,0x3afb3932
.long 0x3b5f3c01,0x35b8398f,0x36440000,0x3b7b39c4,0x3b353c01,0x32ec38f7,0x36fb0000,0x3bd23a48
.long 0x3b073c01,0x2c843853,0x37ae0000,0x3bfd3abd,0x3ad53c01,0xace9374a,0x382e0000,0x3bfc3b22
.long 0x3a9e3c01,0xb31d35db,0x38830000,0x3bcf3b74,0x3a633c01,0xb5cf345e,0x38d40000,0x3b773bb5
.long 0x3a253c01,0xb7f031ac,0x39230000,0x3af53be2,0x39e23c01,0xb8f22d1b,0x396f0000,0x3a4c3bfc
.long 0x3c003c00,0x3bfe3bff,0x29e528b7,0x2c202b13,0x3bac3bcb,0x3b5a3b86,0x349a3367,0x365b357d
.long 0x3ae23b48,0x39da3a67,0x381936ab,0x397838cf,0x39ae3a7e,0x375538bb,0x39a538b1,0x3b1f3a76
.long 0x38233973,0x3037354e,0x3adb39de,0x3bf03b8f,0x34b23833,0xb2bb2980,0x3ba83ad1,0x3bd43c00
.long 0x2aae3595,0xb839b3f9,0x3bff3b82,0x3ace3bc2,0xb2273117,0xba45b829,0x3bdc3be8,0x38fc3ad8
.long 0xb6cea8b7,0xbb95b9f7,0x3b403c00,0x352a3957,0xb910b367,0xbc01bb43,0x3a353bcb,0xa3dd36c2
.long 0xba6bb6ab,0xbb7fbbee,0x38ca3b48,0xb5a03081,0xbb64b8b1,0xba1dbbea,0x362d3a7e,0xb92db0e5
.long 0xbbebb9de,0xb803bb38,0x30cc3973,0xbaeeb6f0,0xbbf9bad1,0xb1c4b9e7,0xae163833,0xbbe1b96a
.long 0xbb8cbb82,0x3130b813,0xb55a3595,0xbbe7bae5,0xbaacbbe8,0x37c4b398,0xb86e3117,0xbb01bbc8
.long 0x3400,0x264633f6,0x2a3e33d9,0x2ca533a8,0x3400,0x2f8b330e,0x32a73072,0x33f62646
.long 0x3400,0x322f3113,0x33d9aa3e,0x2f8bb30e,0x3400,0x33a82ca5,0x3072b2a7,0xb113b22f
.long 0x3400,0x33f6a646,0xaa3eb3d9,0xb3a82ca5,0x3400,0x330eaf8b,0xb2a7b072,0xa64633f6
.long 0x3400,0x3113b22f,0xb3d92a3e,0x330e2f8b,0x3400,0x2ca5b3a8,0xb07232a7,0x322fb113
.long 0x3400,0xa646b3f6,0x2a3e33d9,0xaca5b3a8,0x3400,0xaf8bb30e,0x32a73072,0xb3f6a646
.long 0x3400,0xb22fb113,0x33d9aa3e,0xaf8b330e,0x3400,0xb3a8aca5,0x3072b2a7,0x3113322f
.long 0x3400,0xb3f62646,0xaa3eb3d9,0x33a8aca5,0x3400,0xb30e2f8b,0xb2a7b072,0x2646b3f6
.long 0x3400,0xb113322f,0xb3d92a3e,0xb30eaf8b,0x3400,0xaca533a8,0xb07232a7,0xb22f3113
.long 0x2e1f3364,0x2f8b330e,0x307232a7,0x3113322f,0x3364ae1f,0x3113b22f,0x2a3eb3d9,0xaca5b3a8
.long 0xae1fb364,0xb3a8aca5,0xb2a73072,0xa64633f6,0xb3642e1f,0x264633f6,0x33d92a3e,0x2f8bb30e
.long 0x2e1f3364,0x330eaf8b,0xb072b2a7,0xb22f3113,0x3364ae1f,0xb22fb113,0xaa3e33d9,0x33a8aca5
.long 0xae1fb364,0xaca533a8,0x32a7b072,0xb3f6a646,0xb3642e1f,0x33f6a646,0xb3d9aa3e,0x330e2f8b
.long 0x2e1f3364,0xaf8bb30e,0x307232a7,0xb113b22f,0x3364ae1f,0xb113322f,0x2a3eb3d9,0x2ca533a8
.long 0xae1fb364,0x33a82ca5,0xb2a73072,0x2646b3f6,0xb3642e1f,0xa646b3f6,0x33d92a3e,0xaf8b330e
.long 0x2e1f3364,0xb30e2f8b,0xb072b2a7,0x322fb113,0x3364ae1f,0x322f3113,0xaa3e33d9,0xb3a82ca5
.long 0xae1fb364,0x2ca5b3a8,0x32a7b072,0x33f62646,0xb3642e1f,0xb3f62646,0xb3d9aa3e,0xb30eaf8b
.long 0x31a831a8,0x322f3113,0x32a73072,0x330e2f8b,0xb1a8b1a8,0xb3a8aca5,0xb3d92a3e,0xb22f3113
.long 0x31a831a8,0x33f6a646,0x3072b2a7,0xaca5b3a8,0xb1a8b1a8,0xb30e2f8b,0x2a3e33d9,0x33f62646
.long 0x31a831a8,0x3113b22f,0xb2a7b072,0xaf8b330e,0xb1a8b1a8,0xaca533a8,0x33d9aa3e,0xb113b22f
.long 0x31a831a8,0xa646b3f6,0xb07232a7,0x33a8aca5,0xb1a8b1a8,0x2f8b330e,0xaa3eb3d9,0xa64633f6
.long 0x31a831a8,0xb22fb113,0x32a73072,0xb30eaf8b,0xb1a8b1a8,0x33a82ca5,0xb3d92a3e,0x322fb113
.long 0x31a831a8,0xb3f62646,0x3072b2a7,0x2ca533a8,0xb1a8b1a8,0x330eaf8b,0x2a3e33d9,0xb3f6a646
.long 0x31a831a8,0xb113322f,0xb2a7b072,0x2f8bb30e,0xb1a8b1a8,0x2ca5b3a8,0x33d9aa3e,0x3113322f
.long 0x31a831a8,0x264633f6,0xb07232a7,0xb3a82ca5,0xb1a8b1a8,0xaf8bb30e,0xaa3eb3d9,0x2646b3f6
.long 0x33642e1f,0x33a82ca5,0x33d92a3e,0x33f62646,0xae1f3364,0x264633f6,0x307232a7,0x330e2f8b
.long 0xb364ae1f,0xb30e2f8b,0xaa3e33d9,0x3113322f,0x2e1fb364,0xb22fb113,0xb2a73072,0x2ca533a8
.long 0x33642e1f,0x2ca5b3a8,0xb3d9aa3e,0xa64633f6,0xae1f3364,0x33f6a646,0xb072b2a7,0xaf8b330e
.long 0xb364ae1f,0x2f8b330e,0x2a3eb3d9,0xb22f3113,0x2e1fb364,0xb113322f,0x32a7b072,0xb3a82ca5
.long 0x33642e1f,0xb3a8aca5,0x33d92a3e,0xb3f6a646,0xae1f3364,0xa646b3f6,0x307232a7,0xb30eaf8b
.long 0xb364ae1f,0x330eaf8b,0xaa3e33d9,0xb113b22f,0x2e1fb364,0x322f3113,0xb2a73072,0xaca5b3a8
.long 0x33642e1f,0xaca533a8,0xb3d9aa3e,0x2646b3f6,0xae1f3364,0xb3f62646,0xb072b2a7,0x2f8bb30e
.long 0xb364ae1f,0xaf8bb30e,0x2a3eb3d9,0x322fb113,0x2e1fb364,0x3113b22f,0x32a7b072,0x33a8aca5
.long 0x34008000,0x33f6a646,0x33d9aa3e,0x33a8aca5,0x34008000,0x330eaf8b,0x3072b2a7,0x2646b3f6
.long 0x34008000,0x3113b22f,0xaa3eb3d9,0xb30eaf8b,0x34008000,0x2ca5b3a8,0xb2a7b072,0xb22f3113
.long 0x34008000,0xa646b3f6,0xb3d92a3e,0x2ca533a8,0x34008000,0xaf8bb30e,0xb07232a7,0x33f62646
.long 0x34008000,0xb22fb113,0x2a3e33d9,0x2f8bb30e,0x34008000,0xb3a8aca5,0x32a73072,0xb113b22f
.long 0x34008000,0xb3f62646,0x33d9aa3e,0xb3a82ca5,0x34008000,0xb30e2f8b,0x3072b2a7,0xa64633f6
.long 0x34008000,0xb113322f,0xaa3eb3d9,0x330e2f8b,0x34008000,0xaca533a8,0xb2a7b072,0x322fb113
.long 0x34008000,0x264633f6,0xb3d92a3e,0xaca5b3a8,0x34008000,0x2f8b330e,0xb07232a7,0xb3f6a646
.long 0x34008000,0x322f3113,0x2a3e33d9,0xaf8b330e,0x34008000,0x33a82ca5,0x32a73072,0x3113322f
.long 0x3364ae1f,0x330eaf8b,0x32a7b072,0x322fb113,0xae1fb364,0xb22fb113,0xb3d9aa3e,0xb3a82ca5
.long 0xb3642e1f,0xaca533a8,0x307232a7,0x33f62646,0x2e1f3364,0x33f6a646,0x2a3eb3d9,0xb30eaf8b
.long 0x3364ae1f,0xaf8bb30e,0xb2a73072,0x3113322f,0xae1fb364,0xb113322f,0x33d92a3e,0xaca5b3a8
.long 0xb3642e1f,0x33a82ca5,0xb072b2a7,0xa64633f6,0x2e1f3364,0xa646b3f6,0xaa3e33d9,0x2f8bb30e
.long 0x3364ae1f,0xb30e2f8b,0x32a7b072,0xb22f3113,0xae1fb364,0x322f3113,0xb3d9aa3e,0x33a8aca5
.long 0xb3642e1f,0x2ca5b3a8,0x307232a7,0xb3f6a646,0x2e1f3364,0xb3f62646,0x2a3eb3d9,0x330e2f8b
.long 0x3364ae1f,0x2f8b330e,0xb2a73072,0xb113b22f,0xae1fb364,0x3113b22f,0x33d92a3e,0x2ca533a8
.long 0xb3642e1f,0xb3a8aca5,0xb072b2a7,0x2646b3f6,0x2e1f3364,0x264633f6,0xaa3e33d9,0xaf8b330e
.long 0x31a8b1a8,0x3113b22f,0x3072b2a7,0x2f8bb30e,0xb1a831a8,0xaca533a8,0x2a3e33d9,0x3113322f
.long 0x31a8b1a8,0xa646b3f6,0xb2a7b072,0xb3a82ca5,0xb1a831a8,0x2f8b330e,0x33d9aa3e,0x2646b3f6
.long 0x31a8b1a8,0xb22fb113,0xb07232a7,0x330e2f8b,0xb1a831a8,0x33a82ca5,0xaa3eb3d9,0xb22f3113
.long 0x31a8b1a8,0xb3f62646,0x32a73072,0xaca5b3a8,0xb1a831a8,0x330eaf8b,0xb3d92a3e,0x33f62646
.long 0x31a8b1a8,0xb113322f,0x3072b2a7,0xaf8b330e,0xb1a831a8,0x2ca5b3a8,0x2a3e33d9,0xb113b22f
.long 0x31a8b1a8,0x264633f6,0xb2a7b072,0x33a8aca5,0xb1a831a8,0xaf8bb30e,0x33d9aa3e,0xa64633f6
.long 0x31a8b1a8,0x322f3113,0xb07232a7,0xb30eaf8b,0xb1a831a8,0xb3a8aca5,0xaa3eb3d9,0x322fb113
.long 0x31a8b1a8,0x33f6a646,0x32a73072,0x2ca533a8,0xb1a831a8,0xb30e2f8b,0xb3d92a3e,0xb3f6a646
.long 0x2e1fb364,0x2ca5b3a8,0x2a3eb3d9,0x2646b3f6,0x33642e1f,0x33f6a646,0x32a7b072,0x2f8bb30e
.long 0xae1f3364,0x2f8b330e,0x33d92a3e,0x322fb113,0xb364ae1f,0xb113322f,0x307232a7,0x33a8aca5
.long 0x2e1fb364,0xb3a8aca5,0xaa3e33d9,0x33f62646,0x33642e1f,0xa646b3f6,0xb2a73072,0x330e2f8b
.long 0xae1f3364,0x330eaf8b,0xb3d9aa3e,0x3113322f,0xb364ae1f,0x322f3113,0xb072b2a7,0x2ca533a8
.long 0x2e1fb364,0xaca533a8,0x2a3eb3d9,0xa64633f6,0x33642e1f,0xb3f62646,0x32a7b072,0xaf8b330e
.long 0xae1f3364,0xaf8bb30e,0x33d92a3e,0xb22f3113,0xb364ae1f,0x3113b22f,0x307232a7,0xb3a82ca5
.long 0x2e1fb364,0x33a82ca5,0xaa3e33d9,0xb3f6a646,0x33642e1f,0x264633f6,0xb2a73072,0xb30eaf8b
.long 0xae1f3364,0xb30e2f8b,0xb3d9aa3e,0xb113b22f,0xb364ae1f,0xb22fb113,0xb072b2a7,0xaca5b3a8
.long 0x3c013c01,0x3c003c01,0x224a0000,0x28b7264a,0x3bfe3c01,0x3be03bf3,0x2bdb0000,0x31dd2fd8
.long 0x3bf63c01,0x3b933bd0,0x2f100000,0x35363305,0x3be83c01,0x3b1c3b9b,0x31170000,0x37603506
.long 0x3bd63c01,0x3a7e3b52,0x32a20000,0x38b1367e,0x3bbe3c01,0x39bb3af8,0x34150000,0x399837e5
.long 0x3ba23c01,0x38d93a8c,0x34d60000,0x3a60389d,0x3b823c01,0x37b93a10,0x35950000,0x3b04393b
.long 0x3b5c3c01,0x35953986,0x364f0000,0x3b8239cd,0x3b323c01,0x32a238ed,0x37060000,0x3bd63a50
.long 0x3b043c01,0x2bdb3849,0x37b90000,0x3bfe3ac4,0x3ad13c01,0xad7f3734,0x38330000,0x3bfb3b27
.long 0x3a9b3c01,0xb36735c4,0x38880000,0x3bcb3b79,0x3a603c01,0xb5f33446,0x38d90000,0x3b703bb8
.long 0x3a213c01,0xb808317a,0x39280000,0x3aeb3be4,0x39de3c01,0xb9012cb7,0x39730000,0x3a413bfd
.long 0x3bfe3c00,0x3bfb3bfd,0x2bdb2a4a,0x2d7f2cb7,0x3ba23bc5,0x3b483b79,0x34d633c9,0x36ab35c4
.long 0x3ad13b3d,0x39bb3a50,0x383336d9,0x399838ed,0x39983a6f,0x3706389d,0x39bb38c5,0x3b323a8c
.long 0x38083961,0x2f103506,0x3aeb39ef,0x3bf63b9b,0x3476381e,0xb367264a,0x3bb13ade,0x3bcb3c01
.long 0x28b73565,0xb85eb446,0x3c003b8a,0x3ab63bb8,0xb2a230b3,0xba60b849,0x3bd63bec,0x38d93ac4
.long 0xb706aa4a,0xbba2ba10,0x3b323c00,0x34d6393b,0xb928b3c9,0xbc00bb52,0x3a213bc5,0xa8b7367e
.long 0xba7eb6d9,0xbb70bbf3,0x38b13b3d,0xb5f32fd8,0xbb70b8c5,0xba00bbe4,0x35f33a6f,0xb94eb17a
.long 0xbbf0b9ef,0xb7b9bb27,0x30503961,0xbb04b734,0xbbf6bade,0xb117b9cd,0xaf10381e,0xbbe8b986
.long 0xbb82bb8a,0x31ddb7e5,0xb5953565,0xbbe0baf8,0xba9bbbec,0x3808b305,0xb88830b3,0xbaebbbd0
.long 0x3c013c01,0x3c003c01,0x224a0000,0x28b7264a,0x3bfe3c01,0x3be03bf3,0x2bdb0000,0x31dd2fd8
.long 0x3bf63c01,0x3b933bd0,0x2f100000,0x35363305,0x3be83c01,0x3b1c3b9b,0x31170000,0x37603506
.long 0x3bd63c01,0x3a7e3b52,0x32a20000,0x38b1367e,0x3bbe3c01,0x39bb3af8,0x34150000,0x399837e5
.long 0x3ba23c01,0x38d93a8c,0x34d60000,0x3a60389d,0x3b823c01,0x37b93a10,0x35950000,0x3b04393b
.long 0x3b5c3c01,0x35953986,0x364f0000,0x3b8239cd,0x3b323c01,0x32a238ed,0x37060000,0x3bd63a50
.long 0x3b043c01,0x2bdb3849,0x37b90000,0x3bfe3ac4,0x3ad13c01,0xad7f3734,0x38330000,0x3bfb3b27
.long 0x3a9b3c01,0xb36735c4,0x38880000,0x3bcb3b79,0x3a603c01,0xb5f33446,0x38d90000,0x3b703bb8
.long 0x3a213c01,0xb808317a,0x39280000,0x3aeb3be4,0x39de3c01,0xb9012cb7,0x39730000,0x3a413bfd
.long 0x3bfe3c00,0x3bfb3bfd,0x2bdb2a4a,0x2d7f2cb7,0x3ba23bc5,0x3b483b79,0x34d633c9,0x36ab35c4
.long 0x3ad13b3d,0x39bb3a50,0x383336d9,0x399838ed,0x39983a6f,0x3706389d,0x39bb38c5,0x3b323a8c
.long 0x38083961,0x2f103506,0x3aeb39ef,0x3bf63b9b,0x3476381e,0xb367264a,0x3bb13ade,0x3bcb3c01
.long 0x28b73565,0xb85eb446,0x3c003b8a,0x3ab63bb8,0xb2a230b3,0xba60b849,0x3bd63bec,0x38d93ac4
.long 0xb706aa4a,0xbba2ba10,0x3b323c00,0x34d6393b,0xb928b3c9,0xbc00bb52,0x3a213bc5,0xa8b7367e
.long 0xba7eb6d9,0xbb70bbf3,0x38b13b3d,0xb5f32fd8,0xbb70b8c5,0xba00bbe4,0x35f33a6f,0xb94eb17a
.long 0xbbf0b9ef,0xb7b9bb27,0x30503961,0xbb04b734,0xbbf6bade,0xb117b9cd,0xaf10381e,0xbbe8b986
.long 0xbb82bb8a,0x31ddb7e5,0xb5953565,0xbbe0baf8,0xba9bbbec,0x3808b305,0xb88830b3,0xbaebbbd0
.long 0x3400,0x27d633f1,0x2bc633c3,0x2dc23377,0x3400,0x2fe332f6,0x32dd301d,0x33ff1e48
.long 0x3400,0x324f30ec,0x33c3abc6,0x2e7cb350,0x3400,0x33b62c44,0x301db2dd,0xb184b1cb
.long 0x3400,0x33f1a7d6,0xabc6b3c3,0xb3772dc2,0x3400,0x32f6afe3,0xb2ddb01d,0x9e4833ff
.long 0x3400,0x30ecb24f,0xb3c32bc6,0x33502e7c,0x3400,0x2c44b3b6,0xb01d32dd,0x31cbb184
.long 0x3400,0xa7d6b3f1,0x2bc633c3,0xadc2b377,0x3400,0xafe3b2f6,0x32dd301d,0xb3ff9e48
.long 0x3400,0xb24fb0ec,0x33c3abc6,0xae7c3350,0x3400,0xb3b6ac44,0x301db2dd,0x318431cb
.long 0x3400,0xb3f127d6,0xabc6b3c3,0x3377adc2,0x3400,0xb2f62fe3,0xb2ddb01d,0x1e48b3ff
.long 0x3400,0xb0ec324f,0xb3c32bc6,0xb350ae7c,0x3400,0xac4433b6,0xb01d32dd,0xb1cb3184
.long 0x2f8b330e,0x309b328a,0x315f31ed,0x320f313a,0x330eaf8b,0x3048b2c2,0x2248b3fe,0xaf32b325
.long 0xaf8bb30e,0xb3e2a979,0xb1ed315f,0x24b533fa,0xb30e2f8b,0x2b0333ce,0x33fe2248,0x2d05b399
.long 0x2f8b330e,0x328ab09b,0xb15fb1ed,0xb13a320f,0x330eaf8b,0xb2c2b048,0xa24833fe,0x3325af32
.long 0xaf8bb30e,0xa97933e2,0x31edb15f,0xb3fa24b5,0xb30e2f8b,0x33ceab03,0xb3fea248,0x33992d05
.long 0x2f8b330e,0xb09bb28a,0x315f31ed,0xb20fb13a,0x330eaf8b,0xb04832c2,0x2248b3fe,0x2f323325
.long 0xaf8bb30e,0x33e22979,0xb1ed315f,0xa4b5b3fa,0xb30e2f8b,0xab03b3ce,0x33fe2248,0xad053399
.long 0x2f8b330e,0xb28a309b,0xb15fb1ed,0x313ab20f,0x330eaf8b,0x32c23048,0xa24833fe,0xb3252f32
.long 0xaf8bb30e,0x2979b3e2,0x31edb15f,0x33faa4b5,0xb30e2f8b,0xb3ce2b03,0xb3fea248,0xb399ad05
.long 0x32a73072,0x33252f32,0x33882d64,0x33ce2b03,0xb2a7b072,0xb3faa4b5,0xb33b2ed7,0xb09b328a
.long 0x32a73072,0x3399ad05,0x2d64b388,0xb048b2c2,0xb2a7b072,0xb20f313a,0x2ed7333b,0x33e2a979
.long 0x32a73072,0x2f32b325,0xb388ad64,0xab0333ce,0xb2a7b072,0xa4b533fa,0x333baed7,0xb28ab09b
.long 0x32a73072,0xad05b399,0xad643388,0x32c2b048,0xb2a7b072,0x313a320f,0xaed7b33b,0x297933e2
.long 0x32a73072,0xb325af32,0x33882d64,0xb3ceab03,0xb2a7b072,0x33fa24b5,0xb33b2ed7,0x309bb28a
.long 0x32a73072,0xb3992d05,0x2d64b388,0x304832c2,0xb2a7b072,0x320fb13a,0x2ed7333b,0xb3e22979
.long 0x32a73072,0xaf323325,0xb388ad64,0x2b03b3ce,0xb2a7b072,0x24b5b3fa,0x333baed7,0x328a309b
.long 0x32a73072,0x2d053399,0xad643388,0xb2c23048,0xb2a7b072,0xb13ab20f,0xaed7b33b,0xa979b3e2
.long 0x33f62646,0x33ff9e48,0x33eaa8b2,0x33b6ac44,0xa64633f6,0x2e7c3350,0x326d30c4,0x33f127d6
.long 0xb3f6a646,0xb18431cb,0x28b233ea,0x32f62fe3,0x2646b3f6,0xb377adc2,0xb0c4326d,0x30ec324f
.long 0x33f62646,0x9e48b3ff,0xb3ea28b2,0x2c4433b6,0xa64633f6,0x3350ae7c,0xb26db0c4,0xa7d633f1
.long 0xb3f6a646,0x31cb3184,0xa8b2b3ea,0xafe332f6,0x2646b3f6,0xadc23377,0x30c4b26d,0xb24f30ec
.long 0x33f62646,0xb3ff1e48,0x33eaa8b2,0xb3b62c44,0xa64633f6,0xae7cb350,0x326d30c4,0xb3f1a7d6
.long 0xb3f6a646,0x3184b1cb,0x28b233ea,0xb2f6afe3,0x2646b3f6,0x33772dc2,0xb0c4326d,0xb0ecb24f
.long 0x33f62646,0x1e4833ff,0xb3ea28b2,0xac44b3b6,0xa64633f6,0xb3502e7c,0xb26db0c4,0x27d6b3f1
.long 0xb3f6a646,0xb1cbb184,0xa8b2b3ea,0x2fe3b2f6,0x2646b3f6,0x2dc2b377,0x30c4b26d,0x324fb0ec
.long 0x34008000,0x33f1a7d6,0x33c3abc6,0x3377adc2,0x34008000,0x32f6afe3,0x301db2dd,0x1e48b3ff
.long 0x34008000,0x30ecb24f,0xabc6b3c3,0xb350ae7c,0x34008000,0x2c44b3b6,0xb2ddb01d,0xb1cb3184
.long 0x34008000,0xa7d6b3f1,0xb3c32bc6,0x2dc23377,0x34008000,0xafe3b2f6,0xb01d32dd,0x33ff1e48
.long 0x34008000,0xb24fb0ec,0x2bc633c3,0x2e7cb350,0x34008000,0xb3b6ac44,0x32dd301d,0xb184b1cb
.long 0x34008000,0xb3f127d6,0x33c3abc6,0xb3772dc2,0x34008000,0xb2f62fe3,0x301db2dd,0x9e4833ff
.long 0x34008000,0xb0ec324f,0xabc6b3c3,0x33502e7c,0x34008000,0xac4433b6,0xb2ddb01d,0x31cbb184
.long 0x34008000,0x27d633f1,0xb3c32bc6,0xadc2b377,0x34008000,0x2fe332f6,0xb01d32dd,0xb3ff9e48
.long 0x34008000,0x324f30ec,0x2bc633c3,0xae7c3350,0x34008000,0x33b62c44,0x32dd301d,0x318431cb
.long 0x330eaf8b,0x328ab09b,0x31edb15f,0x313ab20f,0xaf8bb30e,0xb2c2b048,0xb3fea248,0xb3252f32
.long 0xb30e2f8b,0xa97933e2,0x315f31ed,0x33faa4b5,0x2f8b330e,0x33ceab03,0x2248b3fe,0xb399ad05
.long 0x330eaf8b,0xb09bb28a,0xb1ed315f,0x320f313a,0xaf8bb30e,0xb04832c2,0x33fe2248,0xaf32b325
.long 0xb30e2f8b,0x33e22979,0xb15fb1ed,0x24b533fa,0x2f8b330e,0xab03b3ce,0xa24833fe,0x2d05b399
.long 0x330eaf8b,0xb28a309b,0x31edb15f,0xb13a320f,0xaf8bb30e,0x32c23048,0xb3fea248,0x3325af32
.long 0xb30e2f8b,0x2979b3e2,0x315f31ed,0xb3fa24b5,0x2f8b330e,0xb3ce2b03,0x2248b3fe,0x33992d05
.long 0x330eaf8b,0x309b328a,0xb1ed315f,0xb20fb13a,0xaf8bb30e,0x3048b2c2,0x33fe2248,0x2f323325
.long 0xb30e2f8b,0xb3e2a979,0xb15fb1ed,0xa4b5b3fa,0x2f8b330e,0x2b0333ce,0xa24833fe,0xad053399
.long 0x3072b2a7,0x2f32b325,0x2d64b388,0x2b03b3ce,0xb07232a7,0xa4b533fa,0x2ed7333b,0x328a309b
.long 0x3072b2a7,0xad05b399,0xb388ad64,0xb2c23048,0xb07232a7,0x313a320f,0x333baed7,0xa979b3e2
.long 0x3072b2a7,0xb325af32,0xad643388,0x33ce2b03,0xb07232a7,0x33fa24b5,0xaed7b33b,0xb09b328a
.long 0x3072b2a7,0xb3992d05,0x33882d64,0xb048b2c2,0xb07232a7,0x320fb13a,0xb33b2ed7,0x33e2a979
.long 0x3072b2a7,0xaf323325,0x2d64b388,0xab0333ce,0xb07232a7,0x24b5b3fa,0x2ed7333b,0xb28ab09b
.long 0x3072b2a7,0x2d053399,0xb388ad64,0x32c2b048,0xb07232a7,0xb13ab20f,0x333baed7,0x297933e2
.long 0x3072b2a7,0x33252f32,0xad643388,0xb3ceab03,0xb07232a7,0xb3faa4b5,0xaed7b33b,0x309bb28a
.long 0x3072b2a7,0x3399ad05,0x33882d64,0x304832c2,0xb07232a7,0xb20f313a,0xb33b2ed7,0xb3e22979
.long 0x2646b3f6,0x9e48b3ff,0xa8b2b3ea,0xac44b3b6,0x33f62646,0x3350ae7c,0x30c4b26d,0x27d6b3f1
.long 0xa64633f6,0x31cb3184,0x33eaa8b2,0x2fe3b2f6,0xb3f6a646,0xadc23377,0x326d30c4,0x324fb0ec
.long 0x2646b3f6,0xb3ff1e48,0x28b233ea,0x33b6ac44,0x33f62646,0xae7cb350,0xb0c4326d,0x33f127d6
.long 0xa64633f6,0x3184b1cb,0xb3ea28b2,0x32f62fe3,0xb3f6a646,0x33772dc2,0xb26db0c4,0x30ec324f
.long 0x2646b3f6,0x1e4833ff,0xa8b2b3ea,0x2c4433b6,0x33f62646,0xb3502e7c,0x30c4b26d,0xa7d633f1
.long 0xa64633f6,0xb1cbb184,0x33eaa8b2,0xafe332f6,0xb3f6a646,0x2dc2b377,0x326d30c4,0xb24f30ec
.long 0x2646b3f6,0x33ff9e48,0x28b233ea,0xb3b62c44,0x33f62646,0x2e7c3350,0xb0c4326d,0xb3f1a7d6
.long 0xa64633f6,0xb18431cb,0xb3ea28b2,0xb2f6afe3,0xb3f6a646,0xb377adc2,0xb26db0c4,0xb0ecb24f
.long 0x3c013c01,0x3c003c01,0x23dd0000,0x29e527dc,0x3bfe3c01,0x3bdc3bf1,0x2c200000,0x3227301e
.long 0x3bf53c01,0x3b8c3bce,0x2f420000,0x355a3336,0x3be73c01,0x3b133b97,0x31300000,0x3782351e
.long 0x3bd43c01,0x3a723b4d,0x32bb0000,0x38c03695,0x3bbd3c01,0x39ae3af2,0x34210000,0x39a537fb
.long 0x3ba13c01,0x38ca3a85,0x34e20000,0x3a6b38a7,0x3b7f3c01,0x37983a08,0x35a00000,0x3b0d3945
.long 0x3b5a3c01,0x3571397d,0x365b0000,0x3b8839d5,0x3b303c01,0x325938e3,0x37120000,0x3bda3a58
.long 0x3b013c01,0x2aae383e,0x37c40000,0x3bff3acb,0x3ace3c01,0xae16371d,0x38390000,0x3bf93b2d
.long 0x3a973c01,0xb3b035ac,0x388d0000,0x3bc63b7d,0x3a5c3c01,0xb615342d,0x38de0000,0x3b693bbb
.long 0x3a1d3c01,0xb8193148,0x392d0000,0x3ae23be6,0x39da3c01,0xb9102c52,0x39780000,0x3a353bfd
.long 0x3bfc3bfe,0x3bf63bf9,0x2ce92bdb,0x2ede2de3,0x3b993bbe,0x3b353b6b,0x35123415,0x36fb360a
.long 0x3ac13b32,0x399c3a39,0x384e3706,0x39b7390b,0x39813a60,0x36b7387d,0x39d138d9,0x3b453aa2
.long 0x37da394e,0x2db134be,0x3afb3a00,0x3bfa3ba6,0x34393808,0xb4091e4a,0x3bba3aeb,0x3bc03c01
.long 0x25813536,0xb883b48e,0x3c013b93,0x3a9e3bad,0xb31d3050,0xba7ab869,0x3bcf3bf0,0x38b63ab0
.long 0xb73fabdb,0xbbafba29,0x3b243bfe,0x3482391e,0xb940b415,0xbbffbb61,0x3a0c3bbe,0xab773638
.long 0xba90b706,0xbb5fbbf7,0x38973b32,0xb6442eac,0xbb7bb8d9,0xb9e2bbdd,0x35b83a60,0xb96fb20e
.long 0xbbf4ba00,0xb76cbb16,0x2fa6394e,0xbb19b777,0xbbf2baeb,0xb069b9b3,0xb0053808,0xbbefb9a1
.long 0xbb77bb93,0x328ab7a3,0xb5cf3536,0xbbd7bb0a,0xba89bbf0,0x382eb271,0xb8a23050,0xbad5bbd8
.long 0x3c013c01,0x3c003c01,0x23dd0000,0x29e527dc,0x3bfe3c01,0x3bdc3bf1,0x2c200000,0x3227301e
.long 0x3bf53c01,0x3b8c3bce,0x2f420000,0x355a3336,0x3be73c01,0x3b133b97,0x31300000,0x3782351e
.long 0x3bd43c01,0x3a723b4d,0x32bb0000,0x38c03695,0x3bbd3c01,0x39ae3af2,0x34210000,0x39a537fb
.long 0x3ba13c01,0x38ca3a85,0x34e20000,0x3a6b38a7,0x3b7f3c01,0x37983a08,0x35a00000,0x3b0d3945
.long 0x3b5a3c01,0x3571397d,0x365b0000,0x3b8839d5,0x3b303c01,0x325938e3,0x37120000,0x3bda3a58
.long 0x3b013c01,0x2aae383e,0x37c40000,0x3bff3acb,0x3ace3c01,0xae16371d,0x38390000,0x3bf93b2d
.long 0x3a973c01,0xb3b035ac,0x388d0000,0x3bc63b7d,0x3a5c3c01,0xb615342d,0x38de0000,0x3b693bbb
.long 0x3a1d3c01,0xb8193148,0x392d0000,0x3ae23be6,0x39da3c01,0xb9102c52,0x39780000,0x3a353bfd
.long 0x3bfc3bfe,0x3bf63bf9,0x2ce92bdb,0x2ede2de3,0x3b993bbe,0x3b353b6b,0x35123415,0x36fb360a
.long 0x3ac13b32,0x399c3a39,0x384e3706,0x39b7390b,0x39813a60,0x36b7387d,0x39d138d9,0x3b453aa2
.long 0x37da394e,0x2db134be,0x3afb3a00,0x3bfa3ba6,0x34393808,0xb4091e4a,0x3bba3aeb,0x3bc03c01
.long 0x25813536,0xb883b48e,0x3c013b93,0x3a9e3bad,0xb31d3050,0xba7ab869,0x3bcf3bf0,0x38b63ab0
.long 0xb73fabdb,0xbbafba29,0x3b243bfe,0x3482391e,0xb940b415,0xbbffbb61,0x3a0c3bbe,0xab773638
.long 0xba90b706,0xbb5fbbf7,0x38973b32,0xb6442eac,0xbb7bb8d9,0xb9e2bbdd,0x35b83a60,0xb96fb20e
.long 0xbbf4ba00,0xb76cbb16,0x2fa6394e,0xbb19b777,0xbbf2baeb,0xb069b9b3,0xb0053808,0xbbefb9a1
.long 0xbb77bb93,0x328ab7a3,0xb5cf3536,0xbbd7bb0a,0xba89bbf0,0x382eb271,0xb8a23050,0xbad5bbd8
.long 0x3400,0x28b233ea,0x2ca533a8,0x2ed7333b,0x3400,0x301d32dd,0x330e2f8b,0x33fea248
.long 0x3400,0x326d30c4,0x33a8aca5,0x2d64b388,0x3400,0x33c32bc6,0x2f8bb30e,0xb1edb15f
.long 0x3400,0x33eaa8b2,0xaca5b3a8,0xb33b2ed7,0x3400,0x32ddb01d,0xb30eaf8b,0x224833fe
.long 0x3400,0x30c4b26d,0xb3a82ca5,0x33882d64,0x3400,0x2bc6b3c3,0xaf8b330e,0x315fb1ed
.long 0x3400,0xa8b2b3ea,0x2ca533a8,0xaed7b33b,0x3400,0xb01db2dd,0x330e2f8b,0xb3fe2248
.long 0x3400,0xb26db0c4,0x33a8aca5,0xad643388,0x3400,0xb3c3abc6,0x2f8bb30e,0x31ed315f
.long 0x3400,0xb3ea28b2,0xaca5b3a8,0x333baed7,0x3400,0xb2dd301d,0xb30eaf8b,0xa248b3fe
.long 0x3400,0xb0c4326d,0xb3a82ca5,0xb388ad64,0x3400,0xabc633c3,0xaf8b330e,0xb15f31ed
.long 0x307232a7,0x315f31ed,0x322f3113,0x32dd301d,0x32a7b072,0x2ed7b33b,0xa646b3f6,0xb0c4b26d
.long 0xb072b2a7,0xb3fea248,0xb113322f,0x2bc633c3,0xb2a73072,0x2d643388,0x33f6a646,0x28b2b3ea
.long 0x307232a7,0x31edb15f,0xb22fb113,0xb01d32dd,0x32a7b072,0xb33baed7,0x264633f6,0x326db0c4
.long 0xb072b2a7,0xa24833fe,0x3113b22f,0xb3c32bc6,0xb2a73072,0x3388ad64,0xb3f62646,0x33ea28b2
.long 0x307232a7,0xb15fb1ed,0x322f3113,0xb2ddb01d,0x32a7b072,0xaed7333b,0xa646b3f6,0x30c4326d
.long 0xb072b2a7,0x33fe2248,0xb113322f,0xabc6b3c3,0xb2a73072,0xad64b388,0x33f6a646,0xa8b233ea
.long 0x307232a7,0xb1ed315f,0xb22fb113,0x301db2dd,0x32a7b072,0x333b2ed7,0x264633f6,0xb26d30c4
.long 0xb072b2a7,0x2248b3fe,0x3113b22f,0x33c3abc6,0xb2a73072,0xb3882d64,0xb3f62646,0xb3eaa8b2
.long 0x33642e1f,0x33c32bc6,0x33f62646,0x33fea248,0xb364ae1f,0xb3ea28b2,0xb22f3113,0xad643388
.long 0x33642e1f,0x32ddb01d,0x2646b3f6,0xb1edb15f,0xb364ae1f,0xb0c4326d,0x3113322f,0x333baed7
.long 0x33642e1f,0x2bc6b3c3,0xb3f6a646,0x224833fe,0xb364ae1f,0x28b233ea,0x322fb113,0xb388ad64
.long 0x33642e1f,0xb01db2dd,0xa64633f6,0x315fb1ed,0xb364ae1f,0x326d30c4,0xb113b22f,0x2ed7333b
.long 0x33642e1f,0xb3c3abc6,0x33f62646,0xb3fe2248,0xb364ae1f,0x33eaa8b2,0xb22f3113,0x2d64b388
.long 0x33642e1f,0xb2dd301d,0x2646b3f6,0x31ed315f,0xb364ae1f,0x30c4b26d,0x3113322f,0xb33b2ed7
.long 0x33642e1f,0xabc633c3,0xb3f6a646,0xa248b3fe,0xb364ae1f,0xa8b2b3ea,0x322fb113,0x33882d64
.long 0x33642e1f,0x301d32dd,0xa64633f6,0xb15f31ed,0xb364ae1f,0xb26db0c4,0xb113b22f,0xaed7b33b
.long 0x33d9aa3e,0x3388ad64,0x330eaf8b,0x326db0c4,0x2a3e33d9,0x315f31ed,0x33a82ca5,0x33c3abc6
.long 0xb3d92a3e,0xaed7333b,0x2f8b330e,0x33ea28b2,0xaa3eb3d9,0xb3fea248,0xaca533a8,0x32dd301d
.long 0x33d9aa3e,0xad64b388,0xb30e2f8b,0x30c4326d,0x2a3e33d9,0x31edb15f,0xb3a8aca5,0x2bc633c3
.long 0xb3d92a3e,0x333b2ed7,0xaf8bb30e,0xa8b233ea,0xaa3eb3d9,0xa24833fe,0x2ca5b3a8,0xb01d32dd
.long 0x33d9aa3e,0xb3882d64,0x330eaf8b,0xb26d30c4,0x2a3e33d9,0xb15fb1ed,0x33a82ca5,0xb3c32bc6
.long 0xb3d92a3e,0x2ed7b33b,0x2f8b330e,0xb3eaa8b2,0xaa3eb3d9,0x33fe2248,0xaca533a8,0xb2ddb01d
.long 0x33d9aa3e,0x2d643388,0xb30e2f8b,0xb0c4b26d,0x2a3e33d9,0xb1ed315f,0xb3a8aca5,0xabc6b3c3
.long 0xb3d92a3e,0xb33baed7,0xaf8bb30e,0x28b2b3ea,0xaa3eb3d9,0x2248b3fe,0x2ca5b3a8,0x301db2dd
.long 0x34008000,0x33eaa8b2,0x33a8aca5,0x333baed7,0x34008000,0x32ddb01d,0x2f8bb30e,0xa248b3fe
.long 0x34008000,0x30c4b26d,0xaca5b3a8,0xb388ad64,0x34008000,0x2bc6b3c3,0xb30eaf8b,0xb15f31ed
.long 0x34008000,0xa8b2b3ea,0xb3a82ca5,0x2ed7333b,0x34008000,0xb01db2dd,0xaf8b330e,0x33fea248
.long 0x34008000,0xb26db0c4,0x2ca533a8,0x2d64b388,0x34008000,0xb3c3abc6,0x330e2f8b,0xb1edb15f
.long 0x34008000,0xb3ea28b2,0x33a8aca5,0xb33b2ed7,0x34008000,0xb2dd301d,0x2f8bb30e,0x224833fe
.long 0x34008000,0xb0c4326d,0xaca5b3a8,0x33882d64,0x34008000,0xabc633c3,0xb30eaf8b,0x315fb1ed
.long 0x34008000,0x28b233ea,0xb3a82ca5,0xaed7b33b,0x34008000,0x301d32dd,0xaf8b330e,0xb3fe2248
.long 0x34008000,0x326d30c4,0x2ca533a8,0xad643388,0x34008000,0x33c32bc6,0x330e2f8b,0x31ed315f
.long 0x32a7b072,0x31edb15f,0x3113b22f,0x301db2dd,0xb072b2a7,0xb33baed7,0xb3f62646,0xb26d30c4
.long 0xb2a73072,0xa24833fe,0x322f3113,0x33c3abc6,0x307232a7,0x3388ad64,0xa646b3f6,0xb3eaa8b2
.long 0x32a7b072,0xb15fb1ed,0xb113322f,0x32dd301d,0xb072b2a7,0xaed7333b,0x33f6a646,0xb0c4b26d
.long 0xb2a73072,0x33fe2248,0xb22fb113,0x2bc633c3,0x307232a7,0xad64b388,0x264633f6,0x28b2b3ea
.long 0x32a7b072,0xb1ed315f,0x3113b22f,0xb01d32dd,0xb072b2a7,0x333b2ed7,0xb3f62646,0x326db0c4
.long 0xb2a73072,0x2248b3fe,0x322f3113,0xb3c32bc6,0x307232a7,0xb3882d64,0xa646b3f6,0x33ea28b2
.long 0x32a7b072,0x315f31ed,0xb113322f,0xb2ddb01d,0xb072b2a7,0x2ed7b33b,0x33f6a646,0x30c4326d
.long 0xb2a73072,0xb3fea248,0xb22fb113,0xabc6b3c3,0x307232a7,0x2d643388,0x264633f6,0xa8b233ea
.long 0x2e1fb364,0x2bc6b3c3,0x2646b3f6,0xa248b3fe,0xae1f3364,0x28b233ea,0x3113322f,0x33882d64
.long 0x2e1fb364,0xb01db2dd,0xb3f6a646,0xb15f31ed,0xae1f3364,0x326d30c4,0x322fb113,0xaed7b33b
.long 0x2e1fb364,0xb3c3abc6,0xa64633f6,0x33fea248,0xae1f3364,0x33eaa8b2,0xb113b22f,0xad643388
.long 0x2e1fb364,0xb2dd301d,0x33f62646,0xb1edb15f,0xae1f3364,0x30c4b26d,0xb22f3113,0x333baed7
.long 0x2e1fb364,0xabc633c3,0x2646b3f6,0x224833fe,0xae1f3364,0xa8b2b3ea,0x3113322f,0xb388ad64
.long 0x2e1fb364,0x301d32dd,0xb3f6a646,0x315fb1ed,0xae1f3364,0xb26db0c4,0x322fb113,0x2ed7333b
.long 0x2e1fb364,0x33c32bc6,0xa64633f6,0xb3fe2248,0xae1f3364,0xb3ea28b2,0xb113b22f,0x2d64b388
.long 0x2e1fb364,0x32ddb01d,0x33f62646,0x31ed315f,0xae1f3364,0xb0c4326d,0xb22f3113,0xb33b2ed7
.long 0xaa3eb3d9,0xad64b388,0xaf8bb30e,0xb0c4b26d,0x33d9aa3e,0x31edb15f,0x2ca5b3a8,0xabc6b3c3
.long 0x2a3e33d9,0x333b2ed7,0x330eaf8b,0x28b2b3ea,0xb3d92a3e,0xa24833fe,0x33a82ca5,0x301db2dd
.long 0xaa3eb3d9,0xb3882d64,0x2f8b330e,0x326db0c4,0x33d9aa3e,0xb15fb1ed,0xaca533a8,0x33c3abc6
.long 0x2a3e33d9,0x2ed7b33b,0xb30e2f8b,0x33ea28b2,0xb3d92a3e,0x33fe2248,0xb3a8aca5,0x32dd301d
.long 0xaa3eb3d9,0x2d643388,0xaf8bb30e,0x30c4326d,0x33d9aa3e,0xb1ed315f,0x2ca5b3a8,0x2bc633c3
.long 0x2a3e33d9,0xb33baed7,0x330eaf8b,0xa8b233ea,0xb3d92a3e,0x2248b3fe,0x33a82ca5,0xb01d32dd
.long 0xaa3eb3d9,0x3388ad64,0x2f8b330e,0xb26d30c4,0x33d9aa3e,0x315f31ed,0xaca533a8,0xb3c32bc6
.long 0x2a3e33d9,0xaed7333b,0xb30e2f8b,0xb3eaa8b2,0xb3d92a3e,0xb3fea248,0xb3a8aca5,0xb2ddb01d
.long 0x3c013c01,0x3bff3c00,0x24b80000,0x2b1328b7,0x3bfd3c01,0x3bd83bf0,0x2c520000,0x32713050
.long 0x3bf43c01,0x3b863bcb,0x2f740000,0x357d3367,0x3be63c01,0x3b0a3b93,0x31480000,0x37a33536
.long 0x3bd33c01,0x3a673b48,0x32d40000,0x38cf36ab,0x3bbb3c01,0x39a13aeb,0x342d0000,0x39b33808
.long 0x3b9f3c01,0x38bb3a7e,0x34ee0000,0x3a7638b1,0x3b7d3c01,0x37773a00,0x35ac0000,0x3b16394e
.long 0x3b573c01,0x354e3973,0x36670000,0x3b8f39de,0x3b2d3c01,0x320e38d9,0x371d0000,0x3bdd3a60
.long 0x3afe3c01,0x29803833,0x37cf0000,0x3c003ad1,0x3acb3c01,0xaeac3706,0x383e0000,0x3bf73b32
.long 0x3a933c01,0xb3f93595,0x38920000,0x3bc23b82,0x3a583c01,0xb6383415,0x38e30000,0x3b613bbe
.long 0x3a193c01,0xb8293117,0x39320000,0x3ad83be8,0x39d53c01,0xb91e2bdb,0x397d0000,0x3a293bfe
.long 0x3bf93bfd,0x3bf13bf6,0x2de32cb7,0x301e2f10,0x3b8f3bb8,0x3b223b5c,0x354e3446,0x374a364f
.long 0x3ab03b27,0x397d3a21,0x38693734,0x39d53928,0x396a3a50,0x3667385e,0x39e738ed,0x3b573ab6
.long 0x37a3393b,0x2c523476,0x3b0a3a10,0x3bfd3bb1,0x33f937e5,0xb45ea24a,0x3bc23af8,0x3bb53c01
.long 0x1e4a3506,0xb8a7b4d6,0x3c013b9b,0x3a853ba2,0xb3982fd8,0xba93b888,0x3bc83bf3,0x38923a9b
.long 0xb777acb7,0xbbbbba41,0x3b163bfd,0x342d3901,0xb957b446,0xbbfcbb70,0x39f73bb8,0xad1b35f3
.long 0xbaa2b734,0xbb4dbbfb,0x387d3b27,0xb6952d7f,0xbb86b8ed,0xb9c4bbd6,0x357d3a50,0xb98fb2a2
.long 0xbbf7ba10,0xb71dbb04,0x2eac393b,0xbb2db7b9,0xbbeebaf8,0xaf74b998,0xb08137e5,0xbbf4b9bb
.long 0xbb6bbb9b,0x3336b760,0xb60a3506,0xbbcebb1c,0xba76bbf3,0x3853b1dd,0xb8bb2fd8,0xbabdbbe0
.long 0x3c013c01,0x3bff3c00,0x24b80000,0x2b1328b7,0x3bfd3c01,0x3bd83bf0,0x2c520000,0x32713050
.long 0x3bf43c01,0x3b863bcb,0x2f740000,0x357d3367,0x3be63c01,0x3b0a3b93,0x31480000,0x37a33536
.long 0x3bd33c01,0x3a673b48,0x32d40000,0x38cf36ab,0x3bbb3c01,0x39a13aeb,0x342d0000,0x39b33808
.long 0x3b9f3c01,0x38bb3a7e,0x34ee0000,0x3a7638b1,0x3b7d3c01,0x37773a00,0x35ac0000,0x3b16394e
.long 0x3b573c01,0x354e3973,0x36670000,0x3b8f39de,0x3b2d3c01,0x320e38d9,0x371d0000,0x3bdd3a60
.long 0x3afe3c01,0x29803833,0x37cf0000,0x3c003ad1,0x3acb3c01,0xaeac3706,0x383e0000,0x3bf73b32
.long 0x3a933c01,0xb3f93595,0x38920000,0x3bc23b82,0x3a583c01,0xb6383415,0x38e30000,0x3b613bbe
.long 0x3a193c01,0xb8293117,0x39320000,0x3ad83be8,0x39d53c01,0xb91e2bdb,0x397d0000,0x3a293bfe
.long 0x3bf93bfd,0x3bf13bf6,0x2de32cb7,0x301e2f10,0x3b8f3bb8,0x3b223b5c,0x354e3446,0x374a364f
.long 0x3ab03b27,0x397d3a21,0x38693734,0x39d53928,0x396a3a50,0x3667385e,0x39e738ed,0x3b573ab6
.long 0x37a3393b,0x2c523476,0x3b0a3a10,0x3bfd3bb1,0x33f937e5,0xb45ea24a,0x3bc23af8,0x3bb53c01
.long 0x1e4a3506,0xb8a7b4d6,0x3c013b9b,0x3a853ba2,0xb3982fd8,0xba93b888,0x3bc83bf3,0x38923a9b
.long 0xb777acb7,0xbbbbba41,0x3b163bfd,0x342d3901,0xb957b446,0xbbfcbb70,0x39f73bb8,0xad1b35f3
.long 0xbaa2b734,0xbb4dbbfb,0x387d3b27,0xb6952d7f,0xbb86b8ed,0xb9c4bbd6,0x357d3a50,0xb98fb2a2
.long 0xbbf7ba10,0xb71dbb04,0x2eac393b,0xbb2db7b9,0xbbeebaf8,0xaf74b998,0xb08137e5,0xbbf4b9bb
.long 0xbb6bbb9b,0x3336b760,0xb60a3506,0xbbcebb1c,0xba76bbf3,0x3853b1dd,0xb8bb2fd8,0xbabdbbe0
.long 0x3400,0x297933e2,0x2d643388,0x2fe332f6,0x3400,0x304832c2,0x333b2ed7,0x33f1a7d6
.long 0x3400,0x328a309b,0x3388ad64,0x2c44b3b6,0x3400,0x33ce2b03,0x2ed7b33b,0xb24fb0ec
.long 0x3400,0x33e2a979,0xad64b388,0xb2f62fe3,0x3400,0x32c2b048,0xb33baed7,0x27d633f1
.long 0x3400,0x309bb28a,0xb3882d64,0x33b62c44,0x3400,0x2b03b3ce,0xaed7333b,0x30ecb24f
.long 0x3400,0xa979b3e2,0x2d643388,0xafe3b2f6,0x3400,0xb048b2c2,0x333b2ed7,0xb3f127d6
.long 0x3400,0xb28ab09b,0x3388ad64,0xac4433b6,0x3400,0xb3ceab03,0x2ed7b33b,0x324f30ec
.long 0x3400,0xb3e22979,0xad64b388,0x32f6afe3,0x3400,0xb2c23048,0xb33baed7,0xa7d6b3f1
.long 0x3400,0xb09b328a,0xb3882d64,0xb3b6ac44,0x3400,0xab0333ce,0xaed7333b,0xb0ec324f
.long 0x3113322f,0x320f313a,0x32dd301d,0x33772dc2,0x322fb113,0x2d05b399,0xabc6b3c3,0xb1cbb184
.long 0xb113b22f,0xb3fa24b5,0xb01d32dd,0x2e7c3350,0xb22f3113,0x2f323325,0x33c3abc6,0x9e48b3ff
.long 0x3113322f,0x313ab20f,0xb2ddb01d,0xadc23377,0x322fb113,0xb399ad05,0x2bc633c3,0x3184b1cb
.long 0xb113b22f,0x24b533fa,0x301db2dd,0xb3502e7c,0xb22f3113,0x3325af32,0xb3c32bc6,0x33ff9e48
.long 0x3113322f,0xb20fb13a,0x32dd301d,0xb377adc2,0x322fb113,0xad053399,0xabc6b3c3,0x31cb3184
.long 0xb113b22f,0x33faa4b5,0xb01d32dd,0xae7cb350,0xb22f3113,0xaf32b325,0x33c3abc6,0x1e4833ff
.long 0x3113322f,0xb13a320f,0xb2ddb01d,0x2dc2b377,0x322fb113,0x33992d05,0x2bc633c3,0xb18431cb
.long 0xb113b22f,0xa4b5b3fa,0x301db2dd,0x3350ae7c,0xb22f3113,0xb3252f32,0xb3c32bc6,0xb3ff1e48
.long 0x33d92a3e,0x33ff1e48,0x33eaa8b2,0x3399ad05,0xb3d9aa3e,0xb3772dc2,0xb0c4326d,0xa4b533fa
.long 0x33d92a3e,0x31cbb184,0xa8b2b3ea,0xb325af32,0xb3d9aa3e,0xae7c3350,0x326d30c4,0x320fb13a
.long 0x33d92a3e,0x1e48b3ff,0xb3ea28b2,0x2d053399,0xb3d9aa3e,0x2dc23377,0x30c4b26d,0xb3faa4b5
.long 0x33d92a3e,0xb184b1cb,0x28b233ea,0x2f32b325,0xb3d9aa3e,0x33502e7c,0xb26db0c4,0x313a320f
.long 0x33d92a3e,0xb3ff9e48,0x33eaa8b2,0xb3992d05,0xb3d9aa3e,0x3377adc2,0xb0c4326d,0x24b5b3fa
.long 0x33d92a3e,0xb1cb3184,0xa8b2b3ea,0x33252f32,0xb3d9aa3e,0x2e7cb350,0x326d30c4,0xb20f313a
.long 0x33d92a3e,0x9e4833ff,0xb3ea28b2,0xad05b399,0xb3d9aa3e,0xadc2b377,0x30c4b26d,0x33fa24b5
.long 0x33d92a3e,0x318431cb,0x28b233ea,0xaf323325,0xb3d9aa3e,0xb350ae7c,0xb26db0c4,0xb13ab20f
.long 0x330eaf8b,0x324fb0ec,0x315fb1ed,0x3048b2c2,0x2f8b330e,0x32f62fe3,0x33fea248,0x328ab09b
.long 0xb30e2f8b,0xa7d633f1,0x31ed315f,0x33ceab03,0xaf8bb30e,0xb3b62c44,0x224833fe,0x33e22979
.long 0x330eaf8b,0xb0ecb24f,0xb15f31ed,0x32c23048,0x2f8b330e,0x2fe3b2f6,0xb3fe2248,0x309b328a
.long 0xb30e2f8b,0x33f127d6,0xb1edb15f,0x2b0333ce,0xaf8bb30e,0x2c4433b6,0xa248b3fe,0xa97933e2
.long 0x330eaf8b,0xb24f30ec,0x315fb1ed,0xb04832c2,0x2f8b330e,0xb2f6afe3,0x33fea248,0xb28a309b
.long 0xb30e2f8b,0x27d6b3f1,0x31ed315f,0xb3ce2b03,0xaf8bb30e,0x33b6ac44,0x224833fe,0xb3e2a979
.long 0x330eaf8b,0x30ec324f,0xb15f31ed,0xb2c2b048,0x2f8b330e,0xafe332f6,0xb3fe2248,0xb09bb28a
.long 0xb30e2f8b,0xb3f1a7d6,0xb1edb15f,0xab03b3ce,0xaf8bb30e,0xac44b3b6,0xa248b3fe,0x2979b3e2
.long 0x34008000,0x33e2a979,0x3388ad64,0x32f6afe3,0x34008000,0x32c2b048,0x2ed7b33b,0xa7d6b3f1
.long 0x34008000,0x309bb28a,0xad64b388,0xb3b6ac44,0x34008000,0x2b03b3ce,0xb33baed7,0xb0ec324f
.long 0x34008000,0xa979b3e2,0xb3882d64,0x2fe332f6,0x34008000,0xb048b2c2,0xaed7333b,0x33f1a7d6
.long 0x34008000,0xb28ab09b,0x2d643388,0x2c44b3b6,0x34008000,0xb3ceab03,0x333b2ed7,0xb24fb0ec
.long 0x34008000,0xb3e22979,0x3388ad64,0xb2f62fe3,0x34008000,0xb2c23048,0x2ed7b33b,0x27d633f1
.long 0x34008000,0xb09b328a,0xad64b388,0x33b62c44,0x34008000,0xab0333ce,0xb33baed7,0x30ecb24f
.long 0x34008000,0x297933e2,0xb3882d64,0xafe3b2f6,0x34008000,0x304832c2,0xaed7333b,0xb3f127d6
.long 0x34008000,0x328a309b,0x2d643388,0xac4433b6,0x34008000,0x33ce2b03,0x333b2ed7,0x324f30ec
.long 0x322fb113,0x313ab20f,0x301db2dd,0x2dc2b377,0xb113b22f,0xb399ad05,0xb3c32bc6,0xb18431cb
.long 0xb22f3113,0x24b533fa,0x32dd301d,0x3350ae7c,0x3113322f,0x3325af32,0xabc6b3c3,0xb3ff1e48
.long 0x322fb113,0xb20fb13a,0xb01d32dd,0x33772dc2,0xb113b22f,0xad053399,0x33c3abc6,0xb1cbb184
.long 0xb22f3113,0x33faa4b5,0xb2ddb01d,0x2e7c3350,0x3113322f,0xaf32b325,0x2bc633c3,0x9e48b3ff
.long 0x322fb113,0xb13a320f,0x301db2dd,0xadc23377,0xb113b22f,0x33992d05,0xb3c32bc6,0x3184b1cb
.long 0xb22f3113,0xa4b5b3fa,0x32dd301d,0xb3502e7c,0x3113322f,0xb3252f32,0xabc6b3c3,0x33ff9e48
.long 0x322fb113,0x320f313a,0xb01d32dd,0xb377adc2,0xb113b22f,0x2d05b399,0x33c3abc6,0x31cb3184
.long 0xb22f3113,0xb3fa24b5,0xb2ddb01d,0xae7cb350,0x3113322f,0x2f323325,0x2bc633c3,0x1e4833ff
.long 0x2a3eb3d9,0x1e48b3ff,0xa8b2b3ea,0xad05b399,0xaa3e33d9,0x2dc23377,0x326d30c4,0x33fa24b5
.long 0x2a3eb3d9,0xb184b1cb,0xb3ea28b2,0xaf323325,0xaa3e33d9,0x33502e7c,0x30c4b26d,0xb13ab20f
.long 0x2a3eb3d9,0xb3ff9e48,0x28b233ea,0x3399ad05,0xaa3e33d9,0x3377adc2,0xb26db0c4,0xa4b533fa
.long 0x2a3eb3d9,0xb1cb3184,0x33eaa8b2,0xb325af32,0xaa3e33d9,0x2e7cb350,0xb0c4326d,0x320fb13a
.long 0x2a3eb3d9,0x9e4833ff,0xa8b2b3ea,0x2d053399,0xaa3e33d9,0xadc2b377,0x326d30c4,0xb3faa4b5
.long 0x2a3eb3d9,0x318431cb,0xb3ea28b2,0x2f32b325,0xaa3e33d9,0xb350ae7c,0x30c4b26d,0x313a320f
.long 0x2a3eb3d9,0x33ff1e48,0x28b233ea,0xb3992d05,0xaa3e33d9,0xb3772dc2,0xb26db0c4,0x24b5b3fa
.long 0x2a3eb3d9,0x31cbb184,0x33eaa8b2,0x33252f32,0xaa3e33d9,0xae7c3350,0xb0c4326d,0xb20f313a
.long 0xaf8bb30e,0xb0ecb24f,0xb1edb15f,0xb2c2b048,0x330eaf8b,0x2fe3b2f6,0xa248b3fe,0xb09bb28a
.long 0x2f8b330e,0x33f127d6,0x315fb1ed,0xab03b3ce,0xb30e2f8b,0x2c4433b6,0x33fea248,0x2979b3e2
.long 0xaf8bb30e,0xb24f30ec,0x31ed315f,0x3048b2c2,0x330eaf8b,0xb2f6afe3,0x224833fe,0x328ab09b
.long 0x2f8b330e,0x27d6b3f1,0xb15f31ed,0x33ceab03,0xb30e2f8b,0x33b6ac44,0xb3fe2248,0x33e22979
.long 0xaf8bb30e,0x30ec324f,0xb1edb15f,0x32c23048,0x330eaf8b,0xafe332f6,0xa248b3fe,0x309b328a
.long 0x2f8b330e,0xb3f1a7d6,0x315fb1ed,0x2b0333ce,0xb30e2f8b,0xac44b3b6,0x33fea248,0xa97933e2
.long 0xaf8bb30e,0x324fb0ec,0x31ed315f,0xb04832c2,0x330eaf8b,0x32f62fe3,0x224833fe,0xb28a309b
.long 0x2f8b330e,0xa7d633f1,0xb15f31ed,0xb3ce2b03,0xb30e2f8b,0xb3b62c44,0xb3fe2248,0xb3e2a979
.long 0x3c013c01,0x3bfe3c00,0x25810000,0x2c202980,0x3bfd3c01,0x3bd43bee,0x2c840000,0x32bb3081
.long 0x3bf43c01,0x3b7f3bc8,0x2fa60000,0x35a03398,0x3be53c01,0x3b013b8f,0x31610000,0x37c4354e
.long 0x3bd23c01,0x3a5c3b43,0x32ec0000,0x38de36c2,0x3bba3c01,0x39933ae5,0x34390000,0x39c03813
.long 0x3b9d3c01,0x38ac3a76,0x34fa0000,0x3a8138bb,0x3b7b3c01,0x375539f7,0x35b80000,0x3b1f3957
.long 0x3b553c01,0x352a396a,0x36720000,0x3b9539e7,0x3b2a3c01,0x31c438cf,0x37280000,0x3be13a67
.long 0x3afb3c01,0x28533829,0x37da0000,0x3c003ad8,0x3ac73c01,0xaf4236f0,0x38440000,0x3bf53b38
.long 0x3a903c01,0xb421357d,0x38970000,0x3bbd3b86,0x3a543c01,0xb65b33f9,0x38e80000,0x3b5a3bc2
.long 0x3a153c01,0xb83930e5,0x39360000,0x3ace3bea,0x39d13c01,0xb92d2b13,0x39810000,0x3a1d3bff
.long 0x3bf63bfb,0x3beb3bf1,0x2ede2d7f,0x30cc301e,0x3b843bb1,0x3b0d3b4d,0x35893476,0x37983695
.long 0x3a9e3b1c,0x395c3a08,0x38833760,0x39f33945,0x39533a41,0x3615383e,0x39fc3901,0x3b693acb
.long 0x376c3928,0x29e5342d,0x3b193a21,0x3c003bbb,0x337f37b9,0xb4b2a7dc,0x3bc93b04,0x3ba83c01
.long 0xa0b834d6,0xb8cab51e,0x3c013ba2,0x3a6b3b97,0xb4092f10,0xbaacb8a7,0x3bc03bf6,0x386e3a85
.long 0xb7aead7f,0xbbc6ba58,0x3b073bfb,0x33b038e3,0xb96fb476,0xbbf8bb7d,0x39e23bb1,0xae7a35ac
.long 0xbab3b760,0xbb3bbbfd,0x38633b1c,0xb6e42c52,0xbb91b901,0xb9a5bbce,0x35423a41,0xb9aeb336
.long 0xbbfaba21,0xb6cebaf2,0x2db13928,0xbb40b7fb,0xbbe9bb04,0xae16b97d,0xb0fe37b9,0xbbf9b9d5
.long 0xbb5fbba2,0x33e1b71d,0xb64434d6,0xbbc3bb2d,0xba63bbf6,0x3878b148,0xb8d42f10,0xbaa5bbe6
.long 0x3c013c01,0x3bfe3c00,0x25810000,0x2c202980,0x3bfd3c01,0x3bd43bee,0x2c840000,0x32bb3081
.long 0x3bf43c01,0x3b7f3bc8,0x2fa60000,0x35a03398,0x3be53c01,0x3b013b8f,0x31610000,0x37c4354e
.long 0x3bd23c01,0x3a5c3b43,0x32ec0000,0x38de36c2,0x3bba3c01,0x39933ae5,0x34390000,0x39c03813
.long 0x3b9d3c01,0x38ac3a76,0x34fa0000,0x3a8138bb,0x3b7b3c01,0x375539f7,0x35b80000,0x3b1f3957
.long 0x3b553c01,0x352a396a,0x36720000,0x3b9539e7,0x3b2a3c01,0x31c438cf,0x37280000,0x3be13a67
.long 0x3afb3c01,0x28533829,0x37da0000,0x3c003ad8,0x3ac73c01,0xaf4236f0,0x38440000,0x3bf53b38
.long 0x3a903c01,0xb421357d,0x38970000,0x3bbd3b86,0x3a543c01,0xb65b33f9,0x38e80000,0x3b5a3bc2
.long 0x3a153c01,0xb83930e5,0x39360000,0x3ace3bea,0x39d13c01,0xb92d2b13,0x39810000,0x3a1d3bff
.long 0x3bf63bfb,0x3beb3bf1,0x2ede2d7f,0x30cc301e,0x3b843bb1,0x3b0d3b4d,0x35893476,0x37983695
.long 0x3a9e3b1c,0x395c3a08,0x38833760,0x39f33945,0x39533a41,0x3615383e,0x39fc3901,0x3b693acb
.long 0x376c3928,0x29e5342d,0x3b193a21,0x3c003bbb,0x337f37b9,0xb4b2a7dc,0x3bc93b04,0x3ba83c01
.long 0xa0b834d6,0xb8cab51e,0x3c013ba2,0x3a6b3b97,0xb4092f10,0xbaacb8a7,0x3bc03bf6,0x386e3a85
.long 0xb7aead7f,0xbbc6ba58,0x3b073bfb,0x33b038e3,0xb96fb476,0xbbf8bb7d,0x39e23bb1,0xae7a35ac
.long 0xbab3b760,0xbb3bbbfd,0x38633b1c,0xb6e42c52,0xbb91b901,0xb9a5bbce,0x35423a41,0xb9aeb336
.long 0xbbfaba21,0xb6cebaf2,0x2db13928,0xbb40b7fb,0xbbe9bb04,0xae16b97d,0xb0fe37b9,0xbbf9b9d5
.long 0xbb5fbba2,0x33e1b71d,0xb64434d6,0xbbc3bb2d,0xba63bbf6,0x3878b148,0xb8d42f10,0xbaa5bbe6
.long 0x3400,0x2a3e33d9,0x2e1f3364,0x307232a7,0x3400,0x307232a7,0x33642e1f,0x33d9aa3e
.long 0x3400,0x32a73072,0x3364ae1f,0x2a3eb3d9,0x3400,0x33d92a3e,0x2e1fb364,0xb2a7b072
.long 0x3400,0x33d9aa3e,0xae1fb364,0xb2a73072,0x3400,0x32a7b072,0xb364ae1f,0x2a3e33d9
.long 0x3400,0x3072b2a7,0xb3642e1f,0x33d92a3e,0x3400,0x2a3eb3d9,0xae1f3364,0x3072b2a7
.long 0x3400,0xaa3eb3d9,0x2e1f3364,0xb072b2a7,0x3400,0xb072b2a7,0x33642e1f,0xb3d92a3e
.long 0x3400,0xb2a7b072,0x3364ae1f,0xaa3e33d9,0x3400,0xb3d9aa3e,0x2e1fb364,0x32a73072
.long 0x3400,0xb3d92a3e,0xae1fb364,0x32a7b072,0x3400,0xb2a73072,0xb364ae1f,0xaa3eb3d9
.long 0x3400,0xb07232a7,0xb3642e1f,0xb3d9aa3e,0x3400,0xaa3e33d9,0xae1f3364,0xb07232a7
.long 0x31a831a8,0x32a73072,0x33642e1f,0x33d92a3e,0x31a8b1a8,0x2a3eb3d9,0xae1fb364,0xb2a7b072
.long 0xb1a8b1a8,0xb3d92a3e,0xae1f3364,0x307232a7,0xb1a831a8,0x307232a7,0x3364ae1f,0xaa3eb3d9
.long 0x31a831a8,0x3072b2a7,0xb364ae1f,0xaa3e33d9,0x31a8b1a8,0xb3d9aa3e,0x2e1f3364,0x3072b2a7
.long 0xb1a8b1a8,0x2a3e33d9,0x2e1fb364,0xb2a73072,0xb1a831a8,0x32a7b072,0xb3642e1f,0x33d9aa3e
.long 0x31a831a8,0xb2a7b072,0x33642e1f,0xb3d9aa3e,0x31a8b1a8,0xaa3e33d9,0xae1fb364,0x32a73072
.long 0xb1a8b1a8,0x33d9aa3e,0xae1f3364,0xb072b2a7,0xb1a831a8,0xb072b2a7,0x3364ae1f,0x2a3e33d9
.long 0x31a831a8,0xb07232a7,0xb364ae1f,0x2a3eb3d9,0x31a8b1a8,0x33d92a3e,0x2e1f3364,0xb07232a7
.long 0xb1a8b1a8,0xaa3eb3d9,0x2e1fb364,0x32a7b072,0xb1a831a8,0xb2a73072,0xb3642e1f,0xb3d92a3e
.long 0x34000000,0x33d9aa3e,0x3364ae1f,0x32a7b072,0xb4000000,0xb2a73072,0xae1f3364,0x2a3e33d9
.long 0x34000000,0x3072b2a7,0xae1fb364,0xb3d9aa3e,0xb4000000,0xaa3e33d9,0x33642e1f,0x3072b2a7
.long 0x34000000,0xaa3eb3d9,0xb3642e1f,0x307232a7,0xb4000000,0x307232a7,0x2e1fb364,0xb3d92a3e
.long 0x34000000,0xb2a7b072,0x2e1f3364,0x2a3eb3d9,0xb4000000,0x33d92a3e,0xb364ae1f,0x32a73072
.long 0x34000000,0xb3d92a3e,0x3364ae1f,0xb2a73072,0xb4000000,0x32a7b072,0xae1f3364,0xaa3eb3d9
.long 0x34000000,0xb07232a7,0xae1fb364,0x33d92a3e,0xb4000000,0x2a3eb3d9,0x33642e1f,0xb07232a7
.long 0x34000000,0x2a3e33d9,0xb3642e1f,0xb072b2a7,0xb4000000,0xb072b2a7,0x2e1fb364,0x33d9aa3e
.long 0x34000000,0x32a73072,0x2e1f3364,0xaa3e33d9,0xb4000000,0xb3d9aa3e,0xb364ae1f,0xb2a7b072
.long 0x31a8b1a8,0x3072b2a7,0x2e1fb364,0x2a3eb3d9,0x31a831a8,0x33d92a3e,0x3364ae1f,0x3072b2a7
.long 0xb1a831a8,0x2a3e33d9,0x33642e1f,0x32a7b072,0xb1a8b1a8,0xb2a73072,0x2e1f3364,0x33d9aa3e
.long 0x31a8b1a8,0xb2a7b072,0xae1f3364,0x33d92a3e,0x31a831a8,0x2a3eb3d9,0xb3642e1f,0x32a73072
.long 0xb1a831a8,0x33d9aa3e,0xb364ae1f,0x307232a7,0xb1a8b1a8,0x307232a7,0xae1fb364,0x2a3e33d9
.long 0x31a8b1a8,0xb07232a7,0x2e1fb364,0xaa3e33d9,0x31a831a8,0xb3d9aa3e,0x3364ae1f,0xb07232a7
.long 0xb1a831a8,0xaa3eb3d9,0x33642e1f,0xb2a73072,0xb1a8b1a8,0x32a7b072,0x2e1f3364,0xb3d92a3e
.long 0x31a8b1a8,0x32a73072,0xae1f3364,0xb3d9aa3e,0x31a831a8,0xaa3e33d9,0xb3642e1f,0xb2a7b072
.long 0xb1a831a8,0xb3d92a3e,0xb364ae1f,0xb072b2a7,0xb1a8b1a8,0xb072b2a7,0xae1fb364,0xaa3eb3d9
.long 0x34008000,0x33d9aa3e,0x3364ae1f,0x32a7b072,0x34008000,0x32a7b072,0x2e1fb364,0xaa3eb3d9
.long 0x34008000,0x3072b2a7,0xae1fb364,0xb3d9aa3e,0x34008000,0x2a3eb3d9,0xb364ae1f,0xb07232a7
.long 0x34008000,0xaa3eb3d9,0xb3642e1f,0x307232a7,0x34008000,0xb072b2a7,0xae1f3364,0x33d9aa3e
.long 0x34008000,0xb2a7b072,0x2e1f3364,0x2a3eb3d9,0x34008000,0xb3d9aa3e,0x33642e1f,0xb2a7b072
.long 0x34008000,0xb3d92a3e,0x3364ae1f,0xb2a73072,0x34008000,0xb2a73072,0x2e1fb364,0x2a3e33d9
.long 0x34008000,0xb07232a7,0xae1fb364,0x33d92a3e,0x34008000,0xaa3e33d9,0xb364ae1f,0x3072b2a7
.long 0x34008000,0x2a3e33d9,0xb3642e1f,0xb072b2a7,0x34008000,0x307232a7,0xae1f3364,0xb3d92a3e
.long 0x34008000,0x32a73072,0x2e1f3364,0xaa3e33d9,0x34008000,0x33d92a3e,0x33642e1f,0x32a73072
.long 0x31a8b1a8,0x3072b2a7,0x2e1fb364,0x2a3eb3d9,0xb1a8b1a8,0xb3d9aa3e,0xb3642e1f,0xb07232a7
.long 0xb1a831a8,0x2a3e33d9,0x33642e1f,0x32a7b072,0x31a831a8,0x32a7b072,0xae1fb364,0xb3d92a3e
.long 0x31a8b1a8,0xb2a7b072,0xae1f3364,0x33d92a3e,0xb1a8b1a8,0xaa3e33d9,0x3364ae1f,0xb2a7b072
.long 0xb1a831a8,0x33d9aa3e,0xb364ae1f,0x307232a7,0x31a831a8,0xb072b2a7,0x2e1f3364,0xaa3eb3d9
.long 0x31a8b1a8,0xb07232a7,0x2e1fb364,0xaa3e33d9,0xb1a8b1a8,0x33d92a3e,0xb3642e1f,0x3072b2a7
.long 0xb1a831a8,0xaa3eb3d9,0x33642e1f,0xb2a73072,0x31a831a8,0xb2a73072,0xae1fb364,0x33d9aa3e
.long 0x31a8b1a8,0x32a73072,0xae1f3364,0xb3d9aa3e,0xb1a8b1a8,0x2a3eb3d9,0x3364ae1f,0x32a73072
.long 0xb1a831a8,0xb3d92a3e,0xb364ae1f,0xb072b2a7,0x31a831a8,0x307232a7,0x2e1f3364,0x2a3e33d9
.long 0xb400,0xaa3eb3d9,0xae1fb364,0xb072b2a7,0x3400,0x307232a7,0x33642e1f,0x33d9aa3e
.long 0xb400,0xb2a7b072,0xb3642e1f,0xaa3e33d9,0x3400,0x33d92a3e,0x2e1fb364,0xb2a7b072
.long 0xb400,0xb3d92a3e,0x2e1f3364,0x32a7b072,0x3400,0x32a7b072,0xb364ae1f,0x2a3e33d9
.long 0xb400,0xb07232a7,0x3364ae1f,0xb3d9aa3e,0x3400,0x2a3eb3d9,0xae1f3364,0x3072b2a7
.long 0xb400,0x2a3e33d9,0xae1fb364,0x307232a7,0x3400,0xb072b2a7,0x33642e1f,0xb3d92a3e
.long 0xb400,0x32a73072,0xb3642e1f,0x2a3eb3d9,0x3400,0xb3d9aa3e,0x2e1fb364,0x32a73072
.long 0xb400,0x33d9aa3e,0x2e1f3364,0xb2a73072,0x3400,0xb2a73072,0xb364ae1f,0xaa3eb3d9
.long 0xb400,0x3072b2a7,0x3364ae1f,0x33d92a3e,0x3400,0xaa3e33d9,0xae1f3364,0xb07232a7
.long 0xb1a8b1a8,0xb2a7b072,0xb364ae1f,0xb3d9aa3e,0x31a8b1a8,0x2a3eb3d9,0xae1fb364,0xb2a7b072
.long 0x31a831a8,0x33d9aa3e,0x2e1fb364,0xb072b2a7,0xb1a831a8,0x307232a7,0x3364ae1f,0xaa3eb3d9
.long 0xb1a8b1a8,0xb07232a7,0x33642e1f,0x2a3eb3d9,0x31a8b1a8,0xb3d9aa3e,0x2e1f3364,0x3072b2a7
.long 0x31a831a8,0xaa3eb3d9,0xae1f3364,0x32a7b072,0xb1a831a8,0x32a7b072,0xb3642e1f,0x33d9aa3e
.long 0xb1a8b1a8,0x32a73072,0xb364ae1f,0x33d92a3e,0x31a8b1a8,0xaa3e33d9,0xae1fb364,0x32a73072
.long 0x31a831a8,0xb3d92a3e,0x2e1fb364,0x307232a7,0xb1a831a8,0xb072b2a7,0x3364ae1f,0x2a3e33d9
.long 0xb1a8b1a8,0x3072b2a7,0x33642e1f,0xaa3e33d9,0x31a8b1a8,0x33d92a3e,0x2e1f3364,0xb07232a7
.long 0x31a831a8,0x2a3e33d9,0xae1f3364,0xb2a73072,0xb1a831a8,0xb2a73072,0xb3642e1f,0xb3d92a3e
.long 0x3c013c01,0x3bfd3c00,0x264a0000,0x2cb72a4a,0x3bfd3c01,0x3bd03bec,0x2cb70000,0x330530b3
.long 0x3bf33c01,0x3b793bc5,0x2fd80000,0x35c433c9,0x3be43c01,0x3af83b8a,0x317a0000,0x37e53565
.long 0x3bd03c01,0x3a503b3d,0x33050000,0x38ed36d9,0x3bb83c01,0x39863ade,0x34460000,0x39cd381e
.long 0x3b9b3c01,0x389d3a6f,0x35060000,0x3a8c38c5,0x3b793c01,0x373439ef,0x35c40000,0x3b273961
.long 0x3b523c01,0x35063961,0x367e0000,0x3b9b39ef,0x3b273c01,0x317a38c5,0x37340000,0x3be43a6f
.long 0x3af83c01,0x264a381e,0x37e50000,0x3c013ade,0x3ac43c01,0xafd836d9,0x38490000,0x3bf33b3d
.long 0x3a8c3c01,0xb4463565,0x389d0000,0x3bb83b8a,0x3a503c01,0xb67e33c9,0x38ed0000,0x3b523bc5
.long 0x3a103c01,0xb84930b3,0x393b0000,0x3ac43bec,0x39cd3c01,0xb93b2a4a,0x39860000,0x3a103c00
.long 0x3bf33bf8,0x3be43bec,0x2fd82e48,0x317a30b3,0x3b793baa,0x3af83b3d,0x35c434a6,0x37e536d9
.long 0x3a8c3b10,0x393b39ef,0x389d378d,0x3a103961,0x393b3a31,0x35c4381e,0x3a103915,0x3b793ade
.long 0x37343915,0x264a33c9,0x3b273a31,0x3c013bc5,0x3305378d,0xb506aa4a,0x3bd03b10,0x3b9b3c00
.long 0xa64a34a6,0xb8edb565,0x3c013baa,0x3a503b8a,0xb4462e48,0xbac4b8c5,0x3bb83bf8,0x38493a6f
.long 0xb7e5ae48,0xbbd0ba6f,0x3af83bf8,0x330538c5,0xb986b4a6,0xbbf3bb8a,0x39cd3baa,0xafd83565
.long 0xbac4b78d,0xbb27bc00,0x38493b10,0xb7342a4a,0xbb9bb915,0xb986bbc5,0x35063a31,0xb9cdb3c9
.long 0xbbfdba31,0xb67ebade,0x2cb73915,0xbb52b81e,0xbbe4bb10,0xacb7b961,0xb17a378d,0xbbfdb9ef
.long 0xbb52bbaa,0x3446b6d9,0xb67e34a6,0xbbb8bb3d,0xba50bbf8,0x389db0b3,0xb8ed2e48,0xba8cbbec
.long 0x3c013c01,0x3bfd3c00,0x264a0000,0x2cb72a4a,0x3bfd3c01,0x3bd03bec,0x2cb70000,0x330530b3
.long 0x3bf33c01,0x3b793bc5,0x2fd80000,0x35c433c9,0x3be43c01,0x3af83b8a,0x317a0000,0x37e53565
.long 0x3bd03c01,0x3a503b3d,0x33050000,0x38ed36d9,0x3bb83c01,0x39863ade,0x34460000,0x39cd381e
.long 0x3b9b3c01,0x389d3a6f,0x35060000,0x3a8c38c5,0x3b793c01,0x373439ef,0x35c40000,0x3b273961
.long 0x3b523c01,0x35063961,0x367e0000,0x3b9b39ef,0x3b273c01,0x317a38c5,0x37340000,0x3be43a6f
.long 0x3af83c01,0x264a381e,0x37e50000,0x3c013ade,0x3ac43c01,0xafd836d9,0x38490000,0x3bf33b3d
.long 0x3a8c3c01,0xb4463565,0x389d0000,0x3bb83b8a,0x3a503c01,0xb67e33c9,0x38ed0000,0x3b523bc5
.long 0x3a103c01,0xb84930b3,0x393b0000,0x3ac43bec,0x39cd3c01,0xb93b2a4a,0x39860000,0x3a103c00
.long 0x3bf33bf8,0x3be43bec,0x2fd82e48,0x317a30b3,0x3b793baa,0x3af83b3d,0x35c434a6,0x37e536d9
.long 0x3a8c3b10,0x393b39ef,0x389d378d,0x3a103961,0x393b3a31,0x35c4381e,0x3a103915,0x3b793ade
.long 0x37343915,0x264a33c9,0x3b273a31,0x3c013bc5,0x3305378d,0xb506aa4a,0x3bd03b10,0x3b9b3c00
.long 0xa64a34a6,0xb8edb565,0x3c013baa,0x3a503b8a,0xb4462e48,0xbac4b8c5,0x3bb83bf8,0x38493a6f
.long 0xb7e5ae48,0xbbd0ba6f,0x3af83bf8,0x330538c5,0xb986b4a6,0xbbf3bb8a,0x39cd3baa,0xafd83565
.long 0xbac4b78d,0xbb27bc00,0x38493b10,0xb7342a4a,0xbb9bb915,0xb986bbc5,0x35063a31,0xb9cdb3c9
.long 0xbbfdba31,0xb67ebade,0x2cb73915,0xbb52b81e,0xbbe4bb10,0xacb7b961,0xb17a378d,0xbbfdb9ef
.long 0xbb52bbaa,0x3446b6d9,0xb67e34a6,0xbbb8bb3d,0xba50bbf8,0x389db0b3,0xb8ed2e48,0xba8cbbec
.long 0x3400,0x2b0333ce,0x2ed7333b,0x30ec324f,0x3400,0x309b328a,0x33882d64,0x33b6ac44
.long 0x3400,0x32c23048,0x333baed7,0x27d6b3f1,0x3400,0x33e22979,0x2d64b388,0xb2f6afe3
.long 0x3400,0x33ceab03,0xaed7b33b,0xb24f30ec,0x3400,0x328ab09b,0xb388ad64,0x2c4433b6
.long 0x3400,0x3048b2c2,0xb33b2ed7,0x33f127d6,0x3400,0x2979b3e2,0xad643388,0x2fe3b2f6
.long 0x3400,0xab03b3ce,0x2ed7333b,0xb0ecb24f,0x3400,0xb09bb28a,0x33882d64,0xb3b62c44
.long 0x3400,0xb2c2b048,0x333baed7,0xa7d633f1,0x3400,0xb3e2a979,0x2d64b388,0x32f62fe3
.long 0x3400,0xb3ce2b03,0xaed7b33b,0x324fb0ec,0x3400,0xb28a309b,0xb388ad64,0xac44b3b6
.long 0x3400,0xb04832c2,0xb33b2ed7,0xb3f1a7d6,0x3400,0xa97933e2,0xad643388,0xafe332f6
.long 0x322f3113,0x33252f32,0x33c32bc6,0x33ff1e48,0x3113b22f,0x24b5b3fa,0xb01db2dd,0xb350ae7c
.long 0xb22fb113,0xb3992d05,0xabc633c3,0x318431cb,0xb113322f,0x313a320f,0x32ddb01d,0xadc2b377
.long 0x322f3113,0x2f32b325,0xb3c3abc6,0x9e4833ff,0x3113b22f,0xb3faa4b5,0x301d32dd,0x2e7cb350
.long 0xb22fb113,0x2d053399,0x2bc6b3c3,0xb1cb3184,0xb113322f,0x320fb13a,0xb2dd301d,0x3377adc2
.long 0x322f3113,0xb325af32,0x33c32bc6,0xb3ff9e48,0x3113b22f,0xa4b533fa,0xb01db2dd,0x33502e7c
.long 0xb22fb113,0x3399ad05,0xabc633c3,0xb184b1cb,0xb113322f,0xb13ab20f,0x32ddb01d,0x2dc23377
.long 0x322f3113,0xaf323325,0xb3c3abc6,0x1e48b3ff,0x3113b22f,0x33fa24b5,0x301d32dd,0xae7c3350
.long 0xb22fb113,0xad05b399,0x2bc6b3c3,0x31cbb184,0xb113322f,0xb20f313a,0xb2dd301d,0xb3772dc2
.long 0x33d9aa3e,0x3350ae7c,0x326db0c4,0x313ab20f,0xb3d92a3e,0xb18431cb,0xa8b233ea,0x2f323325
.long 0x33d9aa3e,0x2dc2b377,0xb0c4b26d,0xb3fa24b5,0xb3d92a3e,0x1e4833ff,0x33ea28b2,0x2d05b399
.long 0x33d9aa3e,0xae7cb350,0xb26d30c4,0x320f313a,0xb3d92a3e,0x31cb3184,0x28b2b3ea,0xb3252f32
.long 0x33d9aa3e,0xb377adc2,0x30c4326d,0xa4b5b3fa,0xb3d92a3e,0x33ff9e48,0xb3eaa8b2,0x33992d05
.long 0x33d9aa3e,0xb3502e7c,0x326db0c4,0xb13a320f,0xb3d92a3e,0x3184b1cb,0xa8b233ea,0xaf32b325
.long 0x33d9aa3e,0xadc23377,0xb0c4b26d,0x33faa4b5,0xb3d92a3e,0x9e48b3ff,0x33ea28b2,0xad053399
.long 0x33d9aa3e,0x2e7c3350,0xb26d30c4,0xb20fb13a,0xb3d92a3e,0xb1cbb184,0x28b2b3ea,0x3325af32
.long 0x33d9aa3e,0x33772dc2,0x30c4326d,0x24b533fa,0xb3d92a3e,0xb3ff1e48,0xb3eaa8b2,0xb399ad05
.long 0x2f8bb30e,0x2c44b3b6,0x2248b3fe,0xa979b3e2,0x330e2f8b,0x33f1a7d6,0x31edb15f,0x2b03b3ce
.long 0xaf8b330e,0x2fe332f6,0x33fe2248,0x309bb28a,0xb30eaf8b,0xb0ec324f,0x315f31ed,0x32c2b048
.long 0x2f8bb30e,0xb3b6ac44,0xa24833fe,0x33e2a979,0x330e2f8b,0xa7d6b3f1,0xb1ed315f,0x33ce2b03
.long 0xaf8b330e,0x32f6afe3,0xb3fea248,0x328a309b,0xb30eaf8b,0x324f30ec,0xb15fb1ed,0x304832c2
.long 0x2f8bb30e,0xac4433b6,0x2248b3fe,0x297933e2,0x330e2f8b,0xb3f127d6,0x31edb15f,0xab0333ce
.long 0xaf8b330e,0xafe3b2f6,0x33fe2248,0xb09b328a,0xb30eaf8b,0x30ecb24f,0x315f31ed,0xb2c23048
.long 0x2f8bb30e,0x33b62c44,0xa24833fe,0xb3e22979,0x330e2f8b,0x27d633f1,0xb1ed315f,0xb3ceab03
.long 0xaf8b330e,0xb2f62fe3,0xb3fea248,0xb28ab09b,0xb30eaf8b,0xb24fb0ec,0xb15fb1ed,0xb048b2c2
.long 0x34008000,0x33ceab03,0x333baed7,0x324fb0ec,0x34008000,0x328ab09b,0x2d64b388,0xac44b3b6
.long 0x34008000,0x3048b2c2,0xaed7b33b,0xb3f1a7d6,0x34008000,0x2979b3e2,0xb388ad64,0xafe332f6
.long 0x34008000,0xab03b3ce,0xb33b2ed7,0x30ec324f,0x34008000,0xb09bb28a,0xad643388,0x33b6ac44
.long 0x34008000,0xb2c2b048,0x2ed7333b,0x27d6b3f1,0x34008000,0xb3e2a979,0x33882d64,0xb2f6afe3
.long 0x34008000,0xb3ce2b03,0x333baed7,0xb24f30ec,0x34008000,0xb28a309b,0x2d64b388,0x2c4433b6
.long 0x34008000,0xb04832c2,0xaed7b33b,0x33f127d6,0x34008000,0xa97933e2,0xb388ad64,0x2fe3b2f6
.long 0x34008000,0x2b0333ce,0xb33b2ed7,0xb0ecb24f,0x34008000,0x309b328a,0xad643388,0xb3b62c44
.long 0x34008000,0x32c23048,0x2ed7333b,0xa7d633f1,0x34008000,0x33e22979,0x33882d64,0x32f62fe3
.long 0x3113b22f,0x2f32b325,0x2bc6b3c3,0x1e48b3ff,0xb22fb113,0xb3faa4b5,0xb2dd301d,0xae7c3350
.long 0xb113322f,0x2d053399,0x33c32bc6,0x31cbb184,0x322f3113,0x320fb13a,0xb01db2dd,0xb3772dc2
.long 0x3113b22f,0xb325af32,0xabc633c3,0x33ff1e48,0xb22fb113,0xa4b533fa,0x32ddb01d,0xb350ae7c
.long 0xb113322f,0x3399ad05,0xb3c3abc6,0x318431cb,0x322f3113,0xb13ab20f,0x301d32dd,0xadc2b377
.long 0x3113b22f,0xaf323325,0x2bc6b3c3,0x9e4833ff,0xb22fb113,0x33fa24b5,0xb2dd301d,0x2e7cb350
.long 0xb113322f,0xad05b399,0x33c32bc6,0xb1cb3184,0x322f3113,0xb20f313a,0xb01db2dd,0x3377adc2
.long 0x3113b22f,0x33252f32,0xabc633c3,0xb3ff9e48,0xb22fb113,0x24b5b3fa,0x32ddb01d,0x33502e7c
.long 0xb113322f,0xb3992d05,0xb3c3abc6,0xb184b1cb,0x322f3113,0x313a320f,0x301d32dd,0x2dc23377
.long 0xaa3eb3d9,0xae7cb350,0xb0c4b26d,0xb20fb13a,0x2a3e33d9,0x31cb3184,0x33ea28b2,0x3325af32
.long 0xaa3eb3d9,0xb377adc2,0xb26d30c4,0x24b533fa,0x2a3e33d9,0x33ff9e48,0x28b2b3ea,0xb399ad05
.long 0xaa3eb3d9,0xb3502e7c,0x30c4326d,0x313ab20f,0x2a3e33d9,0x3184b1cb,0xb3eaa8b2,0x2f323325
.long 0xaa3eb3d9,0xadc23377,0x326db0c4,0xb3fa24b5,0x2a3e33d9,0x9e48b3ff,0xa8b233ea,0x2d05b399
.long 0xaa3eb3d9,0x2e7c3350,0xb0c4b26d,0x320f313a,0x2a3e33d9,0xb1cbb184,0x33ea28b2,0xb3252f32
.long 0xaa3eb3d9,0x33772dc2,0xb26d30c4,0xa4b5b3fa,0x2a3e33d9,0xb3ff1e48,0x28b2b3ea,0x33992d05
.long 0xaa3eb3d9,0x3350ae7c,0x30c4326d,0xb13a320f,0x2a3e33d9,0xb18431cb,0xb3eaa8b2,0xaf32b325
.long 0xaa3eb3d9,0x2dc2b377,0x326db0c4,0x33faa4b5,0x2a3e33d9,0x1e4833ff,0xa8b233ea,0xad053399
.long 0xb30eaf8b,0xb3b6ac44,0xb3fea248,0xb3e22979,0x2f8bb30e,0xa7d6b3f1,0xb15fb1ed,0xb3ceab03
.long 0x330e2f8b,0x32f6afe3,0x2248b3fe,0xb28ab09b,0xaf8b330e,0x324f30ec,0x31edb15f,0xb048b2c2
.long 0xb30eaf8b,0xac4433b6,0x33fe2248,0xa979b3e2,0x2f8bb30e,0xb3f127d6,0x315f31ed,0x2b03b3ce
.long 0x330e2f8b,0xafe3b2f6,0xa24833fe,0x309bb28a,0xaf8b330e,0x30ecb24f,0xb1ed315f,0x32c2b048
.long 0xb30eaf8b,0x33b62c44,0xb3fea248,0x33e2a979,0x2f8bb30e,0x27d633f1,0xb15fb1ed,0x33ce2b03
.long 0x330e2f8b,0xb2f62fe3,0x2248b3fe,0x328a309b,0xaf8b330e,0xb24fb0ec,0x31edb15f,0x304832c2
.long 0xb30eaf8b,0x2c44b3b6,0x33fe2248,0x297933e2,0x2f8bb30e,0x33f1a7d6,0x315f31ed,0xab0333ce
.long 0x330e2f8b,0x2fe332f6,0xa24833fe,0xb09b328a,0xaf8b330e,0xb0ec324f,0xb1ed315f,0xb2c23048
.long 0x3c013c01,0x3bfb3bff,0x27130000,0x2d4d2b13,0x3bfc3c01,0x3bcc3bea,0x2ce90000,0x334e30e5
.long 0x3bf23c01,0x3b723bc2,0x30050000,0x35e733f9,0x3be33c01,0x3aee3b86,0x31930000,0x3803357d
.long 0x3bcf3c01,0x3a453b38,0x331d0000,0x38fc36f0,0x3bb63c01,0x39783ad8,0x34520000,0x39da3829
.long 0x3b993c01,0x388d3a67,0x35120000,0x3a9738cf,0x3b773c01,0x371239e7,0x35cf0000,0x3b30396a
.long 0x3b503c01,0x34e23957,0x36890000,0x3ba139f7,0x3b243c01,0x313038bb,0x373f0000,0x3be73a76
.long 0x3af53c01,0x23dd3813,0x37f00000,0x3c013ae5,0x3ac13c01,0xb03736c2,0x384e0000,0x3bf03b43
.long 0x3a893c01,0xb46a354e,0x38a20000,0x3bb33b8f,0x3a4c3c01,0xb6a03398,0x38f20000,0x3b4b3bc8
.long 0x3a0c3c01,0xb8593081,0x39400000,0x3aba3bee,0x39c83c01,0xb9492980,0x398a0000,0x3a043c00
.long 0x3bef3bf6,0x3bdc3be6,0x30692f10,0x32273148,0x3b6d3ba2,0x3ae23b2d,0x35fe34d6,0x3819371d
.long 0x3a7a3b04,0x391939d5,0x38b637b9,0x3a2d397d,0x39233a21,0x357137fb,0x3a253928,0x3b883af2
.long 0x36fb3901,0x1a4a3336,0x3b353a41,0x3c013bce,0x328a3760,0xb55aac52,0x3bd73b1c,0x3b8c3bfd
.long 0xa91c3476,0xb910b5ac,0x3c003bb1,0x3a353b7d,0xb4822d7f,0xbadbb8e3,0x3baf3bfb,0x38233a58
.long 0xb80eaf10,0xbbdaba85,0x3ae83bf6,0x325938a7,0xb99cb4d6,0xbbedbb97,0x39b73ba2,0xb09a351e
.long 0xbad5b7b9,0xbb13bc01,0x382e3b04,0xb78227dc,0xbba4b928,0xb965bbbb,0x34ca3a21,0xb9ebb42d
.long 0xbbffba41,0xb62dbacb,0x2b773901,0xbb64b83e,0xbbdebb1c,0xaaaeb945,0xb1f63760,0xbbffba08
.long 0xbb45bbb1,0x349ab695,0xb6b73476,0xbbacbb4d,0xba3dbbfb,0x38c0b01e,0xb9062d7f,0xba72bbf1
.long 0x3c013c01,0x3bfb3bff,0x27130000,0x2d4d2b13,0x3bfc3c01,0x3bcc3bea,0x2ce90000,0x334e30e5
.long 0x3bf23c01,0x3b723bc2,0x30050000,0x35e733f9,0x3be33c01,0x3aee3b86,0x31930000,0x3803357d
.long 0x3bcf3c01,0x3a453b38,0x331d0000,0x38fc36f0,0x3bb63c01,0x39783ad8,0x34520000,0x39da3829
.long 0x3b993c01,0x388d3a67,0x35120000,0x3a9738cf,0x3b773c01,0x371239e7,0x35cf0000,0x3b30396a
.long 0x3b503c01,0x34e23957,0x36890000,0x3ba139f7,0x3b243c01,0x313038bb,0x373f0000,0x3be73a76
.long 0x3af53c01,0x23dd3813,0x37f00000,0x3c013ae5,0x3ac13c01,0xb03736c2,0x384e0000,0x3bf03b43
.long 0x3a893c01,0xb46a354e,0x38a20000,0x3bb33b8f,0x3a4c3c01,0xb6a03398,0x38f20000,0x3b4b3bc8
.long 0x3a0c3c01,0xb8593081,0x39400000,0x3aba3bee,0x39c83c01,0xb9492980,0x398a0000,0x3a043c00
.long 0x3bef3bf6,0x3bdc3be6,0x30692f10,0x32273148,0x3b6d3ba2,0x3ae23b2d,0x35fe34d6,0x3819371d
.long 0x3a7a3b04,0x391939d5,0x38b637b9,0x3a2d397d,0x39233a21,0x357137fb,0x3a253928,0x3b883af2
.long 0x36fb3901,0x1a4a3336,0x3b353a41,0x3c013bce,0x328a3760,0xb55aac52,0x3bd73b1c,0x3b8c3bfd
.long 0xa91c3476,0xb910b5ac,0x3c003bb1,0x3a353b7d,0xb4822d7f,0xbadbb8e3,0x3baf3bfb,0x38233a58
.long 0xb80eaf10,0xbbdaba85,0x3ae83bf6,0x325938a7,0xb99cb4d6,0xbbedbb97,0x39b73ba2,0xb09a351e
.long 0xbad5b7b9,0xbb13bc01,0x382e3b04,0xb78227dc,0xbba4b928,0xb965bbbb,0x34ca3a21,0xb9ebb42d
.long 0xbbffba41,0xb62dbacb,0x2b773901,0xbb64b83e,0xbbdebb1c,0xaaaeb945,0xb1f63760,0xbbffba08
.long 0xbb45bbb1,0x349ab695,0xb6b73476,0xbbacbb4d,0xba3dbbfb,0x38c0b01e,0xb9062d7f,0xba72bbf1
.long 0x3400,0x2bc633c3,0x2f8b330e,0x315f31ed,0x3400,0x30c4326d,0x33a82ca5,0x3388ad64
.long 0x3400,0x32dd301d,0x330eaf8b,0x2248b3fe,0x3400,0x33ea28b2,0x2ca5b3a8,0xb33baed7
.long 0x3400,0x33c3abc6,0xaf8bb30e,0xb1ed315f,0x3400,0x326db0c4,0xb3a8aca5,0x2d643388
.long 0x3400,0x301db2dd,0xb30e2f8b,0x33fe2248,0x3400,0x28b2b3ea,0xaca533a8,0x2ed7b33b
.long 0x3400,0xabc6b3c3,0x2f8b330e,0xb15fb1ed,0x3400,0xb0c4b26d,0x33a82ca5,0xb3882d64
.long 0x3400,0xb2ddb01d,0x330eaf8b,0xa24833fe,0x3400,0xb3eaa8b2,0x2ca5b3a8,0x333b2ed7
.long 0x3400,0xb3c32bc6,0xaf8bb30e,0x31edb15f,0x3400,0xb26d30c4,0xb3a8aca5,0xad64b388
.long 0x3400,0xb01d32dd,0xb30e2f8b,0xb3fea248,0x3400,0xa8b233ea,0xaca533a8,0xaed7333b
.long 0x32a73072,0x33882d64,0x33f62646,0x33eaa8b2,0x3072b2a7,0xa248b3fe,0xb113b22f,0xb3c3abc6
.long 0xb2a7b072,0xb33b2ed7,0xa64633f6,0x326d30c4,0xb07232a7,0x31ed315f,0x322fb113,0xb01db2dd
.long 0x32a73072,0x2d64b388,0xb3f6a646,0x28b233ea,0x3072b2a7,0xb3fe2248,0x3113322f,0x2bc6b3c3
.long 0xb2a7b072,0x2ed7333b,0x2646b3f6,0xb0c4326d,0xb07232a7,0x315fb1ed,0xb22f3113,0x32ddb01d
.long 0x32a73072,0xb388ad64,0x33f62646,0xb3ea28b2,0x3072b2a7,0x224833fe,0xb113b22f,0x33c32bc6
.long 0xb2a7b072,0x333baed7,0xa64633f6,0xb26db0c4,0xb07232a7,0xb1edb15f,0x322fb113,0x301d32dd
.long 0x32a73072,0xad643388,0xb3f6a646,0xa8b2b3ea,0x3072b2a7,0x33fea248,0x3113322f,0xabc633c3
.long 0xb2a7b072,0xaed7b33b,0x2646b3f6,0x30c4b26d,0xb07232a7,0xb15f31ed,0xb22f3113,0xb2dd301d
.long 0x3364ae1f,0x326db0c4,0x3113b22f,0x2ed7b33b,0xb3642e1f,0xb01d32dd,0x264633f6,0x315f31ed
.long 0x3364ae1f,0x28b2b3ea,0xb22fb113,0xb3882d64,0xb3642e1f,0x2bc633c3,0x33f6a646,0x2248b3fe
.long 0x3364ae1f,0xb0c4b26d,0xb113322f,0x333b2ed7,0xb3642e1f,0x32dd301d,0xa646b3f6,0xb1ed315f
.long 0x3364ae1f,0xb3eaa8b2,0x322f3113,0xad64b388,0xb3642e1f,0x33c3abc6,0xb3f62646,0x33fe2248
.long 0x3364ae1f,0xb26d30c4,0x3113b22f,0xaed7333b,0xb3642e1f,0x301db2dd,0x264633f6,0xb15fb1ed
.long 0x3364ae1f,0xa8b233ea,0xb22fb113,0x3388ad64,0xb3642e1f,0xabc6b3c3,0x33f6a646,0xa24833fe
.long 0x3364ae1f,0x30c4326d,0xb113322f,0xb33baed7,0xb3642e1f,0xb2ddb01d,0xa646b3f6,0x31edb15f
.long 0x3364ae1f,0x33ea28b2,0x322f3113,0x2d643388,0xb3642e1f,0xb3c32bc6,0xb3f62646,0xb3fea248
.long 0x2a3eb3d9,0xa248b3fe,0xaca5b3a8,0xb01db2dd,0x33d92a3e,0x333baed7,0x2f8bb30e,0xa8b2b3ea
.long 0xaa3e33d9,0x31ed315f,0x33a8aca5,0x2bc6b3c3,0xb3d9aa3e,0xad643388,0x330e2f8b,0x30c4b26d
.long 0x2a3eb3d9,0xb3fe2248,0x2ca533a8,0x32ddb01d,0x33d92a3e,0xaed7b33b,0xaf8b330e,0x33eaa8b2
.long 0xaa3e33d9,0x315fb1ed,0xb3a82ca5,0x33c32bc6,0xb3d9aa3e,0x33882d64,0xb30eaf8b,0x326d30c4
.long 0x2a3eb3d9,0x224833fe,0xaca5b3a8,0x301d32dd,0x33d92a3e,0xb33b2ed7,0x2f8bb30e,0x28b233ea
.long 0xaa3e33d9,0xb1edb15f,0x33a8aca5,0xabc633c3,0xb3d9aa3e,0x2d64b388,0x330e2f8b,0xb0c4326d
.long 0x2a3eb3d9,0x33fea248,0x2ca533a8,0xb2dd301d,0x33d92a3e,0x2ed7333b,0xaf8b330e,0xb3ea28b2
.long 0xaa3e33d9,0xb15f31ed,0xb3a82ca5,0xb3c3abc6,0xb3d9aa3e,0xb388ad64,0xb30eaf8b,0xb26db0c4
.long 0x34008000,0x33c3abc6,0x330eaf8b,0x31edb15f,0x34008000,0x326db0c4,0x2ca5b3a8,0xad64b388
.long 0x34008000,0x301db2dd,0xaf8bb30e,0xb3fea248,0x34008000,0x28b2b3ea,0xb3a8aca5,0xaed7333b
.long 0x34008000,0xabc6b3c3,0xb30e2f8b,0x315f31ed,0x34008000,0xb0c4b26d,0xaca533a8,0x3388ad64
.long 0x34008000,0xb2ddb01d,0x2f8b330e,0x2248b3fe,0x34008000,0xb3eaa8b2,0x33a82ca5,0xb33baed7
.long 0x34008000,0xb3c32bc6,0x330eaf8b,0xb1ed315f,0x34008000,0xb26d30c4,0x2ca5b3a8,0x2d643388
.long 0x34008000,0xb01d32dd,0xaf8bb30e,0x33fe2248,0x34008000,0xa8b233ea,0xb3a8aca5,0x2ed7b33b
.long 0x34008000,0x2bc633c3,0xb30e2f8b,0xb15fb1ed,0x34008000,0x30c4326d,0xaca533a8,0xb3882d64
.long 0x34008000,0x32dd301d,0x2f8b330e,0xa24833fe,0x34008000,0x33ea28b2,0x33a82ca5,0x333b2ed7
.long 0x3072b2a7,0x2d64b388,0x2646b3f6,0xa8b2b3ea,0xb2a7b072,0xb3fe2248,0xb22f3113,0xabc633c3
.long 0xb07232a7,0x2ed7333b,0x33f62646,0x30c4b26d,0x32a73072,0x315fb1ed,0xb113b22f,0xb2dd301d
.long 0x3072b2a7,0xb388ad64,0xa64633f6,0x33eaa8b2,0xb2a7b072,0x224833fe,0x322fb113,0xb3c3abc6
.long 0xb07232a7,0x333baed7,0xb3f6a646,0x326d30c4,0x32a73072,0xb1edb15f,0x3113322f,0xb01db2dd
.long 0x3072b2a7,0xad643388,0x2646b3f6,0x28b233ea,0xb2a7b072,0x33fea248,0xb22f3113,0x2bc6b3c3
.long 0xb07232a7,0xaed7b33b,0x33f62646,0xb0c4326d,0x32a73072,0xb15f31ed,0xb113b22f,0x32ddb01d
.long 0x3072b2a7,0x33882d64,0xa64633f6,0xb3ea28b2,0xb2a7b072,0xa248b3fe,0x322fb113,0x33c32bc6
.long 0xb07232a7,0xb33b2ed7,0xb3f6a646,0xb26db0c4,0x32a73072,0x31ed315f,0x3113322f,0x301d32dd
.long 0xae1fb364,0xb0c4b26d,0xb22fb113,0xb33baed7,0x2e1f3364,0x32dd301d,0x33f6a646,0x31edb15f
.long 0xae1fb364,0xb3eaa8b2,0xb113322f,0x2d643388,0x2e1f3364,0x33c3abc6,0xa646b3f6,0xb3fea248
.long 0xae1fb364,0xb26d30c4,0x322f3113,0x2ed7b33b,0x2e1f3364,0x301db2dd,0xb3f62646,0x315f31ed
.long 0xae1fb364,0xa8b233ea,0x3113b22f,0xb3882d64,0x2e1f3364,0xabc6b3c3,0x264633f6,0x2248b3fe
.long 0xae1fb364,0x30c4326d,0xb22fb113,0x333b2ed7,0x2e1f3364,0xb2ddb01d,0x33f6a646,0xb1ed315f
.long 0xae1fb364,0x33ea28b2,0xb113322f,0xad64b388,0x2e1f3364,0xb3c32bc6,0xa646b3f6,0x33fe2248
.long 0xae1fb364,0x326db0c4,0x322f3113,0xaed7333b,0x2e1f3364,0xb01d32dd,0xb3f62646,0xb15fb1ed
.long 0xae1fb364,0x28b2b3ea,0x3113b22f,0x3388ad64,0x2e1f3364,0x2bc633c3,0x264633f6,0xa24833fe
.long 0xb3d9aa3e,0xb3fe2248,0xb3a82ca5,0xb2dd301d,0x2a3eb3d9,0xaed7b33b,0xb30eaf8b,0xb3ea28b2
.long 0x33d92a3e,0x315fb1ed,0xaca5b3a8,0xb3c3abc6,0xaa3e33d9,0x33882d64,0x2f8bb30e,0xb26db0c4
.long 0xb3d9aa3e,0x224833fe,0x33a8aca5,0xb01db2dd,0x2a3eb3d9,0xb33b2ed7,0x330e2f8b,0xa8b2b3ea
.long 0x33d92a3e,0xb1edb15f,0x2ca533a8,0x2bc6b3c3,0xaa3e33d9,0x2d64b388,0xaf8b330e,0x30c4b26d
.long 0xb3d9aa3e,0x33fea248,0xb3a82ca5,0x32ddb01d,0x2a3eb3d9,0x2ed7333b,0xb30eaf8b,0x33eaa8b2
.long 0x33d92a3e,0xb15f31ed,0xaca5b3a8,0x33c32bc6,0xaa3e33d9,0xb388ad64,0x2f8bb30e,0x326d30c4
.long 0xb3d9aa3e,0xa248b3fe,0x33a8aca5,0x301d32dd,0x2a3eb3d9,0x333baed7,0x330e2f8b,0x28b233ea
.long 0x33d92a3e,0x31ed315f,0x2ca533a8,0xabc633c3,0xaa3e33d9,0xad643388,0xaf8b330e,0xb0c4326d
.long 0x3c013c01,0x3bf93bfe,0x27dc0000,0x2de32bdb,0x3bfc3c01,0x3bc83be8,0x2d1b0000,0x33983117
.long 0x3bf13c01,0x3b6b3bbe,0x301e0000,0x360a3415,0x3be23c01,0x3ae53b82,0x31ac0000,0x38133595
.long 0x3bce3c01,0x3a393b32,0x33360000,0x390b3706,0x3bb53c01,0x396a3ad1,0x345e0000,0x39e73833
.long 0x3b973c01,0x387d3a60,0x351e0000,0x3aa238d9,0x3b743c01,0x36f039de,0x35db0000,0x3b383973
.long 0x3b4d3c01,0x34be394e,0x36950000,0x3ba63a00,0x3b223c01,0x30e538b1,0x374a0000,0x3bea3a7e
.long 0x3af23c01,0x1e4a3808,0x37fb0000,0x3c013aeb,0x3abd3c01,0xb08136ab,0x38530000,0x3bee3b48
.long 0x3a853c01,0xb48e3536,0x38a70000,0x3bad3b93,0x3a483c01,0xb6c23367,0x38f70000,0x3b433bcb
.long 0x3a083c01,0xb8693050,0x39450000,0x3ab03bf0,0x39c43c01,0xb95728b7,0x398f0000,0x39f73c00
.long 0x3bea3bf3,0x3bd33be0,0x30e52fd8,0x32d431dd,0x3b613b9b,0x3acb3b1c,0x36383506,0x383e3760
.long 0x3a673af8,0x38f739bb,0x38cf37e5,0x3a483998,0x390b3a10,0x351e37b9,0x3a39393b,0x3b973b04
.long 0x36c238ed,0xa4b832a2,0x3b433a50,0x3c013bd6,0x320e3734,0xb5acad7f,0x3bdd3b27,0x3b7d3bfb
.long 0xab133446,0xb932b5f3,0x3bff3bb8,0x3a193b70,0xb4be2cb7,0xbaf2b901,0x3ba63bfd,0x37fb3a41
.long 0xb829afd8,0xbbe2ba9b,0x3ad83bf3,0x31ac3888,0xb9b3b506,0xbbe6bba2,0x39a13b9b,0xb14834d6
.long 0xbae5b7e5,0xbafebc01,0x38133af8,0xb7cf224a,0xbbadb93b,0xb945bbb1,0x348e3a10,0xba08b476
.long 0xbc00ba50,0xb5dbbab6,0x298038ed,0xbb74b85e,0xbbd8bb27,0xa7dcb928,0xb2713734,0xbc01ba21
.long 0xbb38bbb8,0x34eeb64f,0xb6f03446,0xbb9fbb5c,0xba29bbfd,0x38e3af10,0xb91e2cb7,0xba58bbf6
.long 0x3c013c01,0x3bf93bfe,0x27dc0000,0x2de32bdb,0x3bfc3c01,0x3bc83be8,0x2d1b0000,0x33983117
.long 0x3bf13c01,0x3b6b3bbe,0x301e0000,0x360a3415,0x3be23c01,0x3ae53b82,0x31ac0000,0x38133595
.long 0x3bce3c01,0x3a393b32,0x33360000,0x390b3706,0x3bb53c01,0x396a3ad1,0x345e0000,0x39e73833
.long 0x3b973c01,0x387d3a60,0x351e0000,0x3aa238d9,0x3b743c01,0x36f039de,0x35db0000,0x3b383973
.long 0x3b4d3c01,0x34be394e,0x36950000,0x3ba63a00,0x3b223c01,0x30e538b1,0x374a0000,0x3bea3a7e
.long 0x3af23c01,0x1e4a3808,0x37fb0000,0x3c013aeb,0x3abd3c01,0xb08136ab,0x38530000,0x3bee3b48
.long 0x3a853c01,0xb48e3536,0x38a70000,0x3bad3b93,0x3a483c01,0xb6c23367,0x38f70000,0x3b433bcb
.long 0x3a083c01,0xb8693050,0x39450000,0x3ab03bf0,0x39c43c01,0xb95728b7,0x398f0000,0x39f73c00
.long 0x3bea3bf3,0x3bd33be0,0x30e52fd8,0x32d431dd,0x3b613b9b,0x3acb3b1c,0x36383506,0x383e3760
.long 0x3a673af8,0x38f739bb,0x38cf37e5,0x3a483998,0x390b3a10,0x351e37b9,0x3a39393b,0x3b973b04
.long 0x36c238ed,0xa4b832a2,0x3b433a50,0x3c013bd6,0x320e3734,0xb5acad7f,0x3bdd3b27,0x3b7d3bfb
.long 0xab133446,0xb932b5f3,0x3bff3bb8,0x3a193b70,0xb4be2cb7,0xbaf2b901,0x3ba63bfd,0x37fb3a41
.long 0xb829afd8,0xbbe2ba9b,0x3ad83bf3,0x31ac3888,0xb9b3b506,0xbbe6bba2,0x39a13b9b,0xb14834d6
.long 0xbae5b7e5,0xbafebc01,0x38133af8,0xb7cf224a,0xbbadb93b,0xb945bbb1,0x348e3a10,0xba08b476
.long 0xbc00ba50,0xb5dbbab6,0x298038ed,0xbb74b85e,0xbbd8bb27,0xa7dcb928,0xb2713734,0xbc01ba21
.long 0xbb38bbb8,0x34eeb64f,0xb6f03446,0xbb9fbb5c,0xba29bbfd,0x38e3af10,0xb91e2cb7,0xba58bbf6
.long 0x3400,0x2c4433b6,0x301d32dd,0x31cb3184,0x3400,0x30ec324f,0x33c32bc6,0x3350ae7c
.long 0x3400,0x32f62fe3,0x32ddb01d,0x9e48b3ff,0x3400,0x33f127d6,0x2bc6b3c3,0xb377adc2
.long 0x3400,0x33b6ac44,0xb01db2dd,0xb18431cb,0x3400,0x324fb0ec,0xb3c3abc6,0x2e7c3350
.long 0x3400,0x2fe3b2f6,0xb2dd301d,0x33ff9e48,0x3400,0x27d6b3f1,0xabc633c3,0x2dc2b377
.long 0x3400,0xac44b3b6,0x301d32dd,0xb1cbb184,0x3400,0xb0ecb24f,0x33c32bc6,0xb3502e7c
.long 0x3400,0xb2f6afe3,0x32ddb01d,0x1e4833ff,0x3400,0xb3f1a7d6,0x2bc6b3c3,0x33772dc2
.long 0x3400,0xb3b62c44,0xb01db2dd,0x3184b1cb,0x3400,0xb24f30ec,0xb3c3abc6,0xae7cb350
.long 0x3400,0xafe332f6,0xb2dd301d,0xb3ff1e48,0x3400,0xa7d633f1,0xabc633c3,0xadc23377
.long 0x330e2f8b,0x33ce2b03,0x33fea248,0x3399ad05,0x2f8bb30e,0xa979b3e2,0xb1edb15f,0xb3faa4b5
.long 0xb30eaf8b,0xb2c23048,0x224833fe,0x33252f32,0xaf8b330e,0x328a309b,0x315fb1ed,0xb13ab20f
.long 0x330e2f8b,0x2b03b3ce,0xb3fe2248,0x2d053399,0x2f8bb30e,0xb3e22979,0x31ed315f,0x24b5b3fa
.long 0xb30eaf8b,0x304832c2,0xa248b3fe,0xaf323325,0xaf8b330e,0x309bb28a,0xb15f31ed,0x320fb13a
.long 0x330e2f8b,0xb3ceab03,0x33fea248,0xb3992d05,0x2f8bb30e,0x297933e2,0xb1edb15f,0x33fa24b5
.long 0xb30eaf8b,0x32c2b048,0x224833fe,0xb325af32,0xaf8b330e,0xb28ab09b,0x315fb1ed,0x313a320f
.long 0x330e2f8b,0xab0333ce,0xb3fe2248,0xad05b399,0x2f8bb30e,0x33e2a979,0x31ed315f,0xa4b533fa
.long 0xb30eaf8b,0xb048b2c2,0xa248b3fe,0x2f32b325,0xaf8b330e,0xb09b328a,0xb15f31ed,0xb20f313a
.long 0x32a7b072,0x313ab20f,0x2ed7b33b,0x2979b3e2,0xb2a73072,0xad053399,0x2d643388,0x32c23048
.long 0x32a7b072,0xa4b5b3fa,0xb33baed7,0xb28a309b,0xb2a73072,0x2f323325,0x3388ad64,0xab03b3ce
.long 0x32a7b072,0xb20fb13a,0xaed7333b,0x33e22979,0xb2a73072,0x33992d05,0xad64b388,0xb04832c2
.long 0x32a7b072,0xb3fa24b5,0x333b2ed7,0xb09bb28a,0xb2a73072,0x3325af32,0xb3882d64,0x33ceab03
.long 0x32a7b072,0xb13a320f,0x2ed7b33b,0xa97933e2,0xb2a73072,0x2d05b399,0x2d643388,0xb2c2b048
.long 0x32a7b072,0x24b533fa,0xb33baed7,0x328ab09b,0xb2a73072,0xaf32b325,0x3388ad64,0x2b0333ce
.long 0x32a7b072,0x320f313a,0xaed7333b,0xb3e2a979,0xb2a73072,0xb399ad05,0xad64b388,0x3048b2c2
.long 0x32a7b072,0x33faa4b5,0x333b2ed7,0x309b328a,0xb2a73072,0xb3252f32,0xb3882d64,0xb3ce2b03
.long 0xa646b3f6,0xadc2b377,0xb0c4b26d,0xb24fb0ec,0x33f6a646,0x31cbb184,0x28b2b3ea,0xafe3b2f6
.long 0x264633f6,0x33502e7c,0x326db0c4,0xa7d6b3f1,0xb3f62646,0x9e4833ff,0x33ea28b2,0x2c44b3b6
.long 0xa646b3f6,0xb3772dc2,0x30c4326d,0x30ecb24f,0x33f6a646,0xb184b1cb,0xa8b233ea,0x32f6afe3
.long 0x264633f6,0x2e7cb350,0xb26d30c4,0x33f1a7d6,0xb3f62646,0x33ff1e48,0xb3eaa8b2,0x33b62c44
.long 0xa646b3f6,0x2dc23377,0xb0c4b26d,0x324f30ec,0x33f6a646,0xb1cb3184,0x28b2b3ea,0x2fe332f6
.long 0x264633f6,0xb350ae7c,0x326db0c4,0x27d633f1,0xb3f62646,0x1e48b3ff,0x33ea28b2,0xac4433b6
.long 0xa646b3f6,0x3377adc2,0x30c4326d,0xb0ec324f,0x33f6a646,0x318431cb,0xa8b233ea,0xb2f62fe3
.long 0x264633f6,0xae7c3350,0xb26d30c4,0xb3f127d6,0xb3f62646,0xb3ff9e48,0xb3eaa8b2,0xb3b6ac44
.long 0x34008000,0x33b6ac44,0x32ddb01d,0x3184b1cb,0x34008000,0x324fb0ec,0x2bc6b3c3,0xae7cb350
.long 0x34008000,0x2fe3b2f6,0xb01db2dd,0xb3ff1e48,0x34008000,0x27d6b3f1,0xb3c3abc6,0xadc23377
.long 0x34008000,0xac44b3b6,0xb2dd301d,0x31cb3184,0x34008000,0xb0ecb24f,0xabc633c3,0x3350ae7c
.long 0x34008000,0xb2f6afe3,0x301d32dd,0x9e48b3ff,0x34008000,0xb3f1a7d6,0x33c32bc6,0xb377adc2
.long 0x34008000,0xb3b62c44,0x32ddb01d,0xb18431cb,0x34008000,0xb24f30ec,0x2bc6b3c3,0x2e7c3350
.long 0x34008000,0xafe332f6,0xb01db2dd,0x33ff9e48,0x34008000,0xa7d633f1,0xb3c3abc6,0x2dc2b377
.long 0x34008000,0x2c4433b6,0xb2dd301d,0xb1cbb184,0x34008000,0x30ec324f,0xabc633c3,0xb3502e7c
.long 0x34008000,0x32f62fe3,0x301d32dd,0x1e4833ff,0x34008000,0x33f127d6,0x33c32bc6,0x33772dc2
.long 0x2f8bb30e,0x2b03b3ce,0xa248b3fe,0xad05b399,0xb30eaf8b,0xb3e22979,0xb15f31ed,0xa4b533fa
.long 0xaf8b330e,0x304832c2,0x33fea248,0x2f32b325,0x330e2f8b,0x309bb28a,0xb1edb15f,0xb20f313a
.long 0x2f8bb30e,0xb3ceab03,0x224833fe,0x3399ad05,0xb30eaf8b,0x297933e2,0x315fb1ed,0xb3faa4b5
.long 0xaf8b330e,0x32c2b048,0xb3fe2248,0x33252f32,0x330e2f8b,0xb28ab09b,0x31ed315f,0xb13ab20f
.long 0x2f8bb30e,0xab0333ce,0xa248b3fe,0x2d053399,0xb30eaf8b,0x33e2a979,0xb15f31ed,0x24b5b3fa
.long 0xaf8b330e,0xb048b2c2,0x33fea248,0xaf323325,0x330e2f8b,0xb09b328a,0xb1edb15f,0x320fb13a
.long 0x2f8bb30e,0x33ce2b03,0x224833fe,0xb3992d05,0xb30eaf8b,0xa979b3e2,0x315fb1ed,0x33fa24b5
.long 0xaf8b330e,0xb2c23048,0xb3fe2248,0xb325af32,0x330e2f8b,0x328a309b,0x31ed315f,0x313a320f
.long 0xb072b2a7,0xb20fb13a,0xb33baed7,0xb3e2a979,0x307232a7,0x33992d05,0x3388ad64,0x3048b2c2
.long 0xb072b2a7,0xb3fa24b5,0xaed7333b,0x309b328a,0x307232a7,0x3325af32,0xad64b388,0xb3ce2b03
.long 0xb072b2a7,0xb13a320f,0x333b2ed7,0x2979b3e2,0x307232a7,0x2d05b399,0xb3882d64,0x32c23048
.long 0xb072b2a7,0x24b533fa,0x2ed7b33b,0xb28a309b,0x307232a7,0xaf32b325,0x2d643388,0xab03b3ce
.long 0xb072b2a7,0x320f313a,0xb33baed7,0x33e22979,0x307232a7,0xb399ad05,0x3388ad64,0xb04832c2
.long 0xb072b2a7,0x33faa4b5,0xaed7333b,0xb09bb28a,0x307232a7,0xb3252f32,0xad64b388,0x33ceab03
.long 0xb072b2a7,0x313ab20f,0x333b2ed7,0xa97933e2,0x307232a7,0xad053399,0xb3882d64,0xb2c2b048
.long 0xb072b2a7,0xa4b5b3fa,0x2ed7b33b,0x328ab09b,0x307232a7,0x2f323325,0x2d643388,0x2b0333ce
.long 0xb3f62646,0xb3772dc2,0xb26d30c4,0xb0ec324f,0xa646b3f6,0xb184b1cb,0xb3eaa8b2,0xb2f62fe3
.long 0x33f6a646,0x2e7cb350,0xb0c4b26d,0xb3f127d6,0x264633f6,0x33ff1e48,0x28b2b3ea,0xb3b6ac44
.long 0xb3f62646,0x2dc23377,0x326db0c4,0xb24fb0ec,0xa646b3f6,0xb1cb3184,0x33ea28b2,0xafe3b2f6
.long 0x33f6a646,0xb350ae7c,0x30c4326d,0xa7d6b3f1,0x264633f6,0x1e48b3ff,0xa8b233ea,0x2c44b3b6
.long 0xb3f62646,0x3377adc2,0xb26d30c4,0x30ecb24f,0xa646b3f6,0x318431cb,0xb3eaa8b2,0x32f6afe3
.long 0x33f6a646,0xae7c3350,0xb0c4b26d,0x33f1a7d6,0x264633f6,0xb3ff9e48,0x28b2b3ea,0x33b62c44
.long 0xb3f62646,0xadc2b377,0x326db0c4,0x324f30ec,0xa646b3f6,0x31cbb184,0x33ea28b2,0x2fe332f6
.long 0x33f6a646,0x33502e7c,0x30c4326d,0x27d633f1,0x264633f6,0x9e4833ff,0xa8b233ea,0xac4433b6
.long 0x3c003c01,0x3bf83bfd,0x28530000,0x2e7a2c52,0x3bfb3c01,0x3bc33be6,0x2d4d0000,0x33e13148
.long 0x3bf03c01,0x3b643bbb,0x30370000,0x362d342d,0x3be13c01,0x3adb3b7d,0x31c40000,0x382335ac
.long 0x3bcc3c01,0x3a2d3b2d,0x334e0000,0x3919371d,0x3bb33c01,0x395c3acb,0x346a0000,0x39f3383e
.long 0x3b953c01,0x386e3a58,0x352a0000,0x3aac38e3,0x3b723c01,0x36ce39d5,0x35e70000,0x3b40397d
.long 0x3b4b3c01,0x349a3945,0x36a00000,0x3bac3a08,0x3b1f3c01,0x309a38a7,0x37550000,0x3bed3a85
.long 0x3aee3c01,0x9a4a37fb,0x38030000,0x3c013af2,0x3aba3c01,0xb0cc3695,0x38590000,0x3beb3b4d
.long 0x3a813c01,0xb4b2351e,0x38ac0000,0x3ba83b97,0x3a453c01,0xb6e43336,0x38fc0000,0x3b3b3bce
.long 0x3a043c01,0xb878301e,0x39490000,0x3aa53bf1,0x39c03c01,0xb96527dc,0x39930000,0x39eb3c01
.long 0x3be53bf0,0x3bc93bd8,0x31613050,0x337f3271,0x3b553b93,0x3ab33b0a,0x36723536,0x386337a3
.long 0x3a543aeb,0x38d439a1,0x38e83808,0x3a6339b3,0x38f23a00,0x34ca3777,0x3a4c394e,0x3ba43b16
.long 0x368938d9,0xa91c320e,0x3b503a60,0x3c003bdd,0x31933706,0xb5feaeac,0x3be33b32,0x3b6d3bf7
.long 0xac843415,0xb953b638,0x3bfd3bbe,0x39fc3b61,0xb4fa2bdb,0xbb07b91e,0x3b9d3bfe,0x37ae3a29
.long 0xb844b050,0xbbe9bab0,0x3ac73bf0,0x30fe3869,0xb9c8b536,0xbbdebbad,0x398a3b93,0xb1f6348e
.long 0xbaf5b808,0xbae8bc01,0x37f03aeb,0xb80e9e4a,0xbbb6b94e,0xb923bba6,0x34523a00,0xba25b4be
.long 0xbc01ba60,0xb589baa2,0x271338d9,0xbb84b87d,0xbbd2bb32,0xa0b8b90b,0xb2ec3706,0xbc01ba39
.long 0xbb2abbbe,0x3542b60a,0xb7283415,0xbb91bb6b,0xba15bbfe,0x3906ade3,0xb9362bdb,0xba3dbbf9
.long 0x3c003c01,0x3bf83bfd,0x28530000,0x2e7a2c52,0x3bfb3c01,0x3bc33be6,0x2d4d0000,0x33e13148
.long 0x3bf03c01,0x3b643bbb,0x30370000,0x362d342d,0x3be13c01,0x3adb3b7d,0x31c40000,0x382335ac
.long 0x3bcc3c01,0x3a2d3b2d,0x334e0000,0x3919371d,0x3bb33c01,0x395c3acb,0x346a0000,0x39f3383e
.long 0x3b953c01,0x386e3a58,0x352a0000,0x3aac38e3,0x3b723c01,0x36ce39d5,0x35e70000,0x3b40397d
.long 0x3b4b3c01,0x349a3945,0x36a00000,0x3bac3a08,0x3b1f3c01,0x309a38a7,0x37550000,0x3bed3a85
.long 0x3aee3c01,0x9a4a37fb,0x38030000,0x3c013af2,0x3aba3c01,0xb0cc3695,0x38590000,0x3beb3b4d
.long 0x3a813c01,0xb4b2351e,0x38ac0000,0x3ba83b97,0x3a453c01,0xb6e43336,0x38fc0000,0x3b3b3bce
.long 0x3a043c01,0xb878301e,0x39490000,0x3aa53bf1,0x39c03c01,0xb96527dc,0x39930000,0x39eb3c01
.long 0x3be53bf0,0x3bc93bd8,0x31613050,0x337f3271,0x3b553b93,0x3ab33b0a,0x36723536,0x386337a3
.long 0x3a543aeb,0x38d439a1,0x38e83808,0x3a6339b3,0x38f23a00,0x34ca3777,0x3a4c394e,0x3ba43b16
.long 0x368938d9,0xa91c320e,0x3b503a60,0x3c003bdd,0x31933706,0xb5feaeac,0x3be33b32,0x3b6d3bf7
.long 0xac843415,0xb953b638,0x3bfd3bbe,0x39fc3b61,0xb4fa2bdb,0xbb07b91e,0x3b9d3bfe,0x37ae3a29
.long 0xb844b050,0xbbe9bab0,0x3ac73bf0,0x30fe3869,0xb9c8b536,0xbbdebbad,0x398a3b93,0xb1f6348e
.long 0xbaf5b808,0xbae8bc01,0x37f03aeb,0xb80e9e4a,0xbbb6b94e,0xb923bba6,0x34523a00,0xba25b4be
.long 0xbc01ba60,0xb589baa2,0x271338d9,0xbb84b87d,0xbbd2bb32,0xa0b8b90b,0xb2ec3706,0xbc01ba39
.long 0xbb2abbbe,0x3542b60a,0xb7283415,0xbb91bb6b,0xba15bbfe,0x3906ade3,0xb9362bdb,0xba3dbbf9
.long 0x3400,0x2ca533a8,0x307232a7,0x322f3113,0x3400,0x3113322f,0x33d92a3e,0x330eaf8b
.long 0x3400,0x330e2f8b,0x32a7b072,0xa646b3f6,0x3400,0x33f62646,0x2a3eb3d9,0xb3a8aca5
.long 0x3400,0x33a8aca5,0xb072b2a7,0xb113322f,0x3400,0x322fb113,0xb3d9aa3e,0x2f8b330e
.long 0x3400,0x2f8bb30e,0xb2a73072,0x33f6a646,0x3400,0x2646b3f6,0xaa3e33d9,0x2ca5b3a8
.long 0x3400,0xaca5b3a8,0x307232a7,0xb22fb113,0x3400,0xb113b22f,0x33d92a3e,0xb30e2f8b
.long 0x3400,0xb30eaf8b,0x32a7b072,0x264633f6,0x3400,0xb3f6a646,0x2a3eb3d9,0x33a82ca5
.long 0x3400,0xb3a82ca5,0xb072b2a7,0x3113b22f,0x3400,0xb22f3113,0xb3d9aa3e,0xaf8bb30e
.long 0x3400,0xaf8b330e,0xb2a73072,0xb3f62646,0x3400,0xa64633f6,0xaa3e33d9,0xaca533a8
.long 0x33642e1f,0x33f62646,0x33d9aa3e,0x330eaf8b,0x2e1fb364,0xaca5b3a8,0xb2a7b072,0xb3f62646
.long 0xb364ae1f,0xb22f3113,0x2a3e33d9,0x33a82ca5,0xae1f3364,0x330e2f8b,0x3072b2a7,0xb22fb113
.long 0x33642e1f,0x2646b3f6,0xb3d92a3e,0x2f8b330e,0x2e1fb364,0xb3a82ca5,0x32a73072,0xa646b3f6
.long 0xb364ae1f,0x3113322f,0xaa3eb3d9,0xaca533a8,0xae1f3364,0x2f8bb30e,0xb07232a7,0x3113b22f
.long 0x33642e1f,0xb3f6a646,0x33d9aa3e,0xb30e2f8b,0x2e1fb364,0x2ca533a8,0xb2a7b072,0x33f6a646
.long 0xb364ae1f,0x322fb113,0x2a3e33d9,0xb3a8aca5,0xae1f3364,0xb30eaf8b,0x3072b2a7,0x322f3113
.long 0x33642e1f,0xa64633f6,0xb3d92a3e,0xaf8bb30e,0x2e1fb364,0x33a8aca5,0x32a73072,0x264633f6
.long 0xb364ae1f,0xb113b22f,0xaa3eb3d9,0x2ca5b3a8,0xae1f3364,0xaf8b330e,0xb07232a7,0xb113322f
.long 0x31a8b1a8,0x2f8bb30e,0x2a3eb3d9,0xa646b3f6,0xb1a831a8,0xa64633f6,0x307232a7,0x33a82ca5
.long 0x31a8b1a8,0xaca5b3a8,0xb3d9aa3e,0xb113322f,0xb1a831a8,0x3113322f,0x32a7b072,0xaf8bb30e
.long 0x31a8b1a8,0xb30eaf8b,0xaa3e33d9,0x33f6a646,0xb1a831a8,0x33f62646,0xb072b2a7,0xaca533a8
.long 0x31a8b1a8,0xb3a82ca5,0x33d92a3e,0xb22fb113,0xb1a831a8,0x322fb113,0xb2a73072,0x330eaf8b
.long 0x31a8b1a8,0xaf8b330e,0x2a3eb3d9,0x264633f6,0xb1a831a8,0x2646b3f6,0x307232a7,0xb3a8aca5
.long 0x31a8b1a8,0x2ca533a8,0xb3d9aa3e,0x3113b22f,0xb1a831a8,0xb113b22f,0x32a7b072,0x2f8b330e
.long 0x31a8b1a8,0x330e2f8b,0xaa3e33d9,0xb3f62646,0xb1a831a8,0xb3f6a646,0xb072b2a7,0x2ca5b3a8
.long 0x31a8b1a8,0x33a8aca5,0x33d92a3e,0x322f3113,0xb1a831a8,0xb22f3113,0xb2a73072,0xb30e2f8b
.long 0xae1fb364,0xb113b22f,0xb2a7b072,0xb3a8aca5,0x3364ae1f,0x2f8bb30e,0xaa3eb3d9,0xb22fb113
.long 0x2e1f3364,0x33f62646,0x3072b2a7,0xaf8bb30e,0xb3642e1f,0x2ca533a8,0x33d9aa3e,0xa646b3f6
.long 0xae1fb364,0xb22f3113,0x32a73072,0x2ca5b3a8,0x3364ae1f,0xb30eaf8b,0x2a3e33d9,0x3113b22f
.long 0x2e1f3364,0x2646b3f6,0xb07232a7,0x330eaf8b,0xb3642e1f,0x33a8aca5,0xb3d92a3e,0x33f6a646
.long 0xae1fb364,0x3113322f,0xb2a7b072,0x33a82ca5,0x3364ae1f,0xaf8b330e,0xaa3eb3d9,0x322f3113
.long 0x2e1f3364,0xb3f6a646,0x3072b2a7,0x2f8b330e,0xb3642e1f,0xaca5b3a8,0x33d9aa3e,0x264633f6
.long 0xae1fb364,0x322fb113,0x32a73072,0xaca533a8,0x3364ae1f,0x330e2f8b,0x2a3e33d9,0xb113322f
.long 0x2e1f3364,0xa64633f6,0xb07232a7,0xb30e2f8b,0xb3642e1f,0xb3a82ca5,0xb3d92a3e,0xb3f62646
.long 0x34008000,0x33a8aca5,0x32a7b072,0x3113b22f,0x34008000,0x322fb113,0x2a3eb3d9,0xaf8bb30e
.long 0x34008000,0x2f8bb30e,0xb072b2a7,0xb3f62646,0x34008000,0x2646b3f6,0xb3d9aa3e,0xaca533a8
.long 0x34008000,0xaca5b3a8,0xb2a73072,0x322f3113,0x34008000,0xb113b22f,0xaa3e33d9,0x330eaf8b
.long 0x34008000,0xb30eaf8b,0x307232a7,0xa646b3f6,0x34008000,0xb3f6a646,0x33d92a3e,0xb3a8aca5
.long 0x34008000,0xb3a82ca5,0x32a7b072,0xb113322f,0x34008000,0xb22f3113,0x2a3eb3d9,0x2f8b330e
.long 0x34008000,0xaf8b330e,0xb072b2a7,0x33f6a646,0x34008000,0xa64633f6,0xb3d9aa3e,0x2ca5b3a8
.long 0x34008000,0x2ca533a8,0xb2a73072,0xb22fb113,0x34008000,0x3113322f,0xaa3e33d9,0xb30e2f8b
.long 0x34008000,0x330e2f8b,0x307232a7,0x264633f6,0x34008000,0x33f62646,0x33d92a3e,0x33a82ca5
.long 0x2e1fb364,0x2646b3f6,0xaa3eb3d9,0xaf8bb30e,0xb364ae1f,0xb3a82ca5,0xb07232a7,0x264633f6
.long 0xae1f3364,0x3113322f,0x33d9aa3e,0x2ca5b3a8,0x33642e1f,0x2f8bb30e,0xb2a7b072,0xb113322f
.long 0x2e1fb364,0xb3f6a646,0x2a3e33d9,0x330eaf8b,0xb364ae1f,0x2ca533a8,0x3072b2a7,0xb3f62646
.long 0xae1f3364,0x322fb113,0xb3d92a3e,0x33a82ca5,0x33642e1f,0xb30eaf8b,0x32a73072,0xb22fb113
.long 0x2e1fb364,0xa64633f6,0xaa3eb3d9,0x2f8b330e,0xb364ae1f,0x33a8aca5,0xb07232a7,0xa646b3f6
.long 0xae1f3364,0xb113b22f,0x33d9aa3e,0xaca533a8,0x33642e1f,0xaf8b330e,0xb2a7b072,0x3113b22f
.long 0x2e1fb364,0x33f62646,0x2a3e33d9,0xb30e2f8b,0xb364ae1f,0xaca5b3a8,0x3072b2a7,0x33f6a646
.long 0xae1f3364,0xb22f3113,0xb3d92a3e,0xb3a8aca5,0x33642e1f,0x330e2f8b,0x32a73072,0x322f3113
.long 0xb1a8b1a8,0xb30eaf8b,0xb3d9aa3e,0xb3f62646,0x31a831a8,0x33f62646,0x32a7b072,0x2ca5b3a8
.long 0xb1a8b1a8,0xb3a82ca5,0xaa3e33d9,0x322f3113,0x31a831a8,0x322fb113,0xb072b2a7,0xb30e2f8b
.long 0xb1a8b1a8,0xaf8b330e,0x33d92a3e,0xa646b3f6,0x31a831a8,0x2646b3f6,0xb2a73072,0x33a82ca5
.long 0xb1a8b1a8,0x2ca533a8,0x2a3eb3d9,0xb113322f,0x31a831a8,0xb113b22f,0x307232a7,0xaf8bb30e
.long 0xb1a8b1a8,0x330e2f8b,0xb3d9aa3e,0x33f6a646,0x31a831a8,0xb3f6a646,0x32a7b072,0xaca533a8
.long 0xb1a8b1a8,0x33a8aca5,0xaa3e33d9,0xb22fb113,0x31a831a8,0xb22f3113,0xb072b2a7,0x330eaf8b
.long 0xb1a8b1a8,0x2f8bb30e,0x33d92a3e,0x264633f6,0x31a831a8,0xa64633f6,0xb2a73072,0xb3a8aca5
.long 0xb1a8b1a8,0xaca5b3a8,0x2a3eb3d9,0x3113b22f,0x31a831a8,0x3113322f,0x307232a7,0x2f8b330e
.long 0xb3642e1f,0xb22f3113,0xb07232a7,0xaca533a8,0xae1fb364,0xb30eaf8b,0xb3d92a3e,0xb113322f
.long 0x3364ae1f,0x2646b3f6,0xb2a7b072,0xb30e2f8b,0x2e1f3364,0x33a8aca5,0xaa3eb3d9,0xb3f62646
.long 0xb3642e1f,0x3113322f,0x3072b2a7,0xb3a8aca5,0xae1fb364,0xaf8b330e,0x33d9aa3e,0xb22fb113
.long 0x3364ae1f,0xb3f6a646,0x32a73072,0xaf8bb30e,0x2e1f3364,0xaca5b3a8,0x2a3e33d9,0xa646b3f6
.long 0xb3642e1f,0x322fb113,0xb07232a7,0x2ca5b3a8,0xae1fb364,0x330e2f8b,0xb3d92a3e,0x3113b22f
.long 0x3364ae1f,0xa64633f6,0xb2a7b072,0x330eaf8b,0x2e1f3364,0xb3a82ca5,0xaa3eb3d9,0x33f6a646
.long 0xb3642e1f,0xb113b22f,0x3072b2a7,0x33a82ca5,0xae1fb364,0x2f8bb30e,0x33d9aa3e,0x322f3113
.long 0x3364ae1f,0x33f62646,0x32a73072,0x2f8b330e,0x2e1f3364,0x2ca533a8,0x2a3e33d9,0x264633f6
.long 0x3c003c01,0x3bf63bfd,0x28b70000,0x2f102cb7,0x3bfb3c01,0x3bbe3be4,0x2d7f0000,0x3415317a
.long 0x3bf03c01,0x3b5c3bb8,0x30500000,0x364f3446,0x3be03c01,0x3ad13b79,0x31dd0000,0x383335c4
.long 0x3bcb3c01,0x3a213b27,0x33670000,0x39283734,0x3bb13c01,0x394e3ac4,0x34760000,0x3a003849
.long 0x3b933c01,0x385e3a50,0x35360000,0x3ab638ed,0x3b703c01,0x36ab39cd,0x35f30000,0x3b483986
.long 0x3b483c01,0x3476393b,0x36ab0000,0x3bb13a10,0x3b1c3c01,0x3050389d,0x37600000,0x3bf03a8c
.long 0x3aeb3c01,0xa24a37e5,0x38080000,0x3c013af8,0x3ab63c01,0xb117367e,0x385e0000,0x3be83b52
.long 0x3a7e3c01,0xb4d63506,0x38b10000,0x3ba23b9b,0x3a413c01,0xb7063305,0x39010000,0x3b323bd0
.long 0x3a003c01,0xb8882fd8,0x394e0000,0x3a9b3bf3,0x39bb3c01,0xb973264a,0x39980000,0x39de3c01
.long 0x3be03bec,0x3bbe3bd0,0x31dd30b3,0x34153305,0x3b483b8a,0x3a9b3af8,0x36ab3565,0x388837e5
.long 0x3a413ade,0x38b13986,0x3901381e,0x3a7e39cd,0x38d939ef,0x34763734,0x3a603961,0x3bb13b27
.long 0x364f38c5,0xabdb317a,0x3b5c3a6f,0x3bfe3be4,0x311736d9,0xb64fafd8,0x3be83b3d,0x3b5c3bf3
.long 0xad7f33c9,0xb973b67e,0x3bfb3bc5,0x39de3b52,0xb5362a4a,0xbb1cb93b,0x3b933c00,0x37603a10
.long 0xb85eb0b3,0xbbf0bac4,0x3ab63bec,0x30503849,0xb9deb565,0xbbd6bbb8,0x39733b8a,0xb2a23446
.long 0xbb04b81e,0xbad1bc01,0x37b93ade,0xb833a64a,0xbbbeb961,0xb901bb9b,0x341539ef,0xba41b506
.long 0xbc01ba6f,0xb536ba8c,0x224a38c5,0xbb93b89d,0xbbcbbb3d,0x224ab8ed,0xb36736d9,0xbc01ba50
.long 0xbb1cbbc5,0x3595b5c4,0xb76033c9,0xbb82bb79,0xba00bc00,0x3928acb7,0xb94e2a4a,0xba21bbfd
.long 0x3c003c01,0x3bf63bfd,0x28b70000,0x2f102cb7,0x3bfb3c01,0x3bbe3be4,0x2d7f0000,0x3415317a
.long 0x3bf03c01,0x3b5c3bb8,0x30500000,0x364f3446,0x3be03c01,0x3ad13b79,0x31dd0000,0x383335c4
.long 0x3bcb3c01,0x3a213b27,0x33670000,0x39283734,0x3bb13c01,0x394e3ac4,0x34760000,0x3a003849
.long 0x3b933c01,0x385e3a50,0x35360000,0x3ab638ed,0x3b703c01,0x36ab39cd,0x35f30000,0x3b483986
.long 0x3b483c01,0x3476393b,0x36ab0000,0x3bb13a10,0x3b1c3c01,0x3050389d,0x37600000,0x3bf03a8c
.long 0x3aeb3c01,0xa24a37e5,0x38080000,0x3c013af8,0x3ab63c01,0xb117367e,0x385e0000,0x3be83b52
.long 0x3a7e3c01,0xb4d63506,0x38b10000,0x3ba23b9b,0x3a413c01,0xb7063305,0x39010000,0x3b323bd0
.long 0x3a003c01,0xb8882fd8,0x394e0000,0x3a9b3bf3,0x39bb3c01,0xb973264a,0x39980000,0x39de3c01
.long 0x3be03bec,0x3bbe3bd0,0x31dd30b3,0x34153305,0x3b483b8a,0x3a9b3af8,0x36ab3565,0x388837e5
.long 0x3a413ade,0x38b13986,0x3901381e,0x3a7e39cd,0x38d939ef,0x34763734,0x3a603961,0x3bb13b27
.long 0x364f38c5,0xabdb317a,0x3b5c3a6f,0x3bfe3be4,0x311736d9,0xb64fafd8,0x3be83b3d,0x3b5c3bf3
.long 0xad7f33c9,0xb973b67e,0x3bfb3bc5,0x39de3b52,0xb5362a4a,0xbb1cb93b,0x3b933c00,0x37603a10
.long 0xb85eb0b3,0xbbf0bac4,0x3ab63bec,0x30503849,0xb9deb565,0xbbd6bbb8,0x39733b8a,0xb2a23446
.long 0xbb04b81e,0xbad1bc01,0x37b93ade,0xb833a64a,0xbbbeb961,0xb901bb9b,0x341539ef,0xba41b506
.long 0xbc01ba6f,0xb536ba8c,0x224a38c5,0xbb93b89d,0xbbcbbb3d,0x224ab8ed,0xb36736d9,0xbc01ba50
.long 0xbb1cbbc5,0x3595b5c4,0xb76033c9,0xbb82bb79,0xba00bc00,0x3928acb7,0xb94e2a4a,0xba21bbfd
.long 0x3400,0x2d053399,0x30c4326d,0x328a309b,0x3400,0x313a320f,0x33ea28b2,0x32c2b048
.long 0x3400,0x33252f32,0x326db0c4,0xa979b3e2,0x3400,0x33fa24b5,0x28b2b3ea,0xb3ceab03
.long 0x3400,0x3399ad05,0xb0c4b26d,0xb09b328a,0x3400,0x320fb13a,0xb3eaa8b2,0x304832c2
.long 0x3400,0x2f32b325,0xb26d30c4,0x33e2a979,0x3400,0x24b5b3fa,0xa8b233ea,0x2b03b3ce
.long 0x3400,0xad05b399,0x30c4326d,0xb28ab09b,0x3400,0xb13ab20f,0x33ea28b2,0xb2c23048
.long 0x3400,0xb325af32,0x326db0c4,0x297933e2,0x3400,0xb3faa4b5,0x28b2b3ea,0x33ce2b03
.long 0x3400,0xb3992d05,0xb0c4b26d,0x309bb28a,0x3400,0xb20f313a,0xb3eaa8b2,0xb048b2c2
.long 0x3400,0xaf323325,0xb26d30c4,0xb3e22979,0x3400,0xa4b533fa,0xa8b233ea,0xab0333ce
.long 0x33a82ca5,0x33ff9e48,0x3388ad64,0x324fb0ec,0x2ca5b3a8,0xae7cb350,0xb33baed7,0xb3b62c44
.long 0xb3a8aca5,0xb18431cb,0x2d643388,0x33f127d6,0xaca533a8,0x33772dc2,0x2ed7b33b,0xb2f6afe3
.long 0x33a82ca5,0x9e48b3ff,0xb3882d64,0x30ec324f,0x2ca5b3a8,0xb3502e7c,0x333b2ed7,0xac44b3b6
.long 0xb3a8aca5,0x31cb3184,0xad64b388,0xa7d633f1,0xaca533a8,0x2dc2b377,0xaed7333b,0x2fe3b2f6
.long 0x33a82ca5,0xb3ff1e48,0x3388ad64,0xb24f30ec,0x2ca5b3a8,0x2e7c3350,0xb33baed7,0x33b6ac44
.long 0xb3a8aca5,0x3184b1cb,0x2d643388,0xb3f1a7d6,0xaca533a8,0xb377adc2,0x2ed7b33b,0x32f62fe3
.long 0x33a82ca5,0x1e4833ff,0xb3882d64,0xb0ecb24f,0x2ca5b3a8,0x3350ae7c,0x333b2ed7,0x2c4433b6
.long 0xb3a8aca5,0xb1cbb184,0xad64b388,0x27d6b3f1,0xaca533a8,0xadc23377,0xaed7333b,0xafe332f6
.long 0x3072b2a7,0x2c44b3b6,0xa248b3fe,0xadc2b377,0xb07232a7,0x27d633f1,0x31ed315f,0x33ff1e48
.long 0x3072b2a7,0xafe3b2f6,0xb3fe2248,0xae7c3350,0xb07232a7,0x324f30ec,0x315fb1ed,0xb184b1cb
.long 0x3072b2a7,0xb3b6ac44,0x224833fe,0x3377adc2,0xb07232a7,0x33f1a7d6,0xb1edb15f,0x9e4833ff
.long 0x3072b2a7,0xb2f62fe3,0x33fea248,0xb350ae7c,0xb07232a7,0x30ecb24f,0xb15f31ed,0x31cbb184
.long 0x3072b2a7,0xac4433b6,0xa248b3fe,0x2dc23377,0xb07232a7,0xa7d6b3f1,0x31ed315f,0xb3ff9e48
.long 0x3072b2a7,0x2fe332f6,0xb3fe2248,0x2e7cb350,0xb07232a7,0xb24fb0ec,0x315fb1ed,0x318431cb
.long 0x3072b2a7,0x33b62c44,0x224833fe,0xb3772dc2,0xb07232a7,0xb3f127d6,0xb1edb15f,0x1e48b3ff
.long 0x3072b2a7,0x32f6afe3,0x33fea248,0x33502e7c,0xb07232a7,0xb0ec324f,0xb15f31ed,0xb1cb3184
.long 0xb113b22f,0xb2c2b048,0xb3c3abc6,0xb3fa24b5,0x322fb113,0x2979b3e2,0xb01db2dd,0xb399ad05
.long 0x3113322f,0x33ceab03,0x2bc6b3c3,0xb20fb13a,0xb22f3113,0x309b328a,0x32ddb01d,0xaf32b325
.long 0xb113b22f,0xb04832c2,0x33c32bc6,0xa4b5b3fa,0x322fb113,0xb3e2a979,0x301d32dd,0x2d05b399
.long 0x3113322f,0xab03b3ce,0xabc633c3,0x313ab20f,0xb22f3113,0x328ab09b,0xb2dd301d,0x3325af32
.long 0xb113b22f,0x32c23048,0xb3c3abc6,0x33faa4b5,0x322fb113,0xa97933e2,0xb01db2dd,0x33992d05
.long 0x3113322f,0xb3ce2b03,0x2bc6b3c3,0x320f313a,0xb22f3113,0xb09bb28a,0x32ddb01d,0x2f323325
.long 0xb113b22f,0x3048b2c2,0x33c32bc6,0x24b533fa,0x322fb113,0x33e22979,0x301d32dd,0xad053399
.long 0x3113322f,0x2b0333ce,0xabc633c3,0xb13a320f,0xb22f3113,0xb28a309b,0xb2dd301d,0xb3252f32
.long 0x34008000,0x3399ad05,0x326db0c4,0x309bb28a,0x34008000,0x320fb13a,0x28b2b3ea,0xb048b2c2
.long 0x34008000,0x2f32b325,0xb0c4b26d,0xb3e22979,0x34008000,0x24b5b3fa,0xb3eaa8b2,0xab0333ce
.long 0x34008000,0xad05b399,0xb26d30c4,0x328a309b,0x34008000,0xb13ab20f,0xa8b233ea,0x32c2b048
.long 0x34008000,0xb325af32,0x30c4326d,0xa979b3e2,0x34008000,0xb3faa4b5,0x33ea28b2,0xb3ceab03
.long 0x34008000,0xb3992d05,0x326db0c4,0xb09b328a,0x34008000,0xb20f313a,0x28b2b3ea,0x304832c2
.long 0x34008000,0xaf323325,0xb0c4b26d,0x33e2a979,0x34008000,0xa4b533fa,0xb3eaa8b2,0x2b03b3ce
.long 0x34008000,0x2d053399,0xb26d30c4,0xb28ab09b,0x34008000,0x313a320f,0xa8b233ea,0xb2c23048
.long 0x34008000,0x33252f32,0x30c4326d,0x297933e2,0x34008000,0x33fa24b5,0x33ea28b2,0x33ce2b03
.long 0x2ca5b3a8,0x9e48b3ff,0xad64b388,0xb0ecb24f,0xb3a8aca5,0xb3502e7c,0xaed7333b,0x2c4433b6
.long 0xaca533a8,0x31cb3184,0x3388ad64,0x27d6b3f1,0x33a82ca5,0x2dc2b377,0xb33baed7,0xafe332f6
.long 0x2ca5b3a8,0xb3ff1e48,0x2d643388,0x324fb0ec,0xb3a8aca5,0x2e7c3350,0x2ed7b33b,0xb3b62c44
.long 0xaca533a8,0x3184b1cb,0xb3882d64,0x33f127d6,0x33a82ca5,0xb377adc2,0x333b2ed7,0xb2f6afe3
.long 0x2ca5b3a8,0x1e4833ff,0xad64b388,0x30ec324f,0xb3a8aca5,0x3350ae7c,0xaed7333b,0xac44b3b6
.long 0xaca533a8,0xb1cbb184,0x3388ad64,0xa7d633f1,0x33a82ca5,0xadc23377,0xb33baed7,0x2fe3b2f6
.long 0x2ca5b3a8,0x33ff9e48,0x2d643388,0xb24f30ec,0xb3a8aca5,0xae7cb350,0x2ed7b33b,0x33b6ac44
.long 0xaca533a8,0xb18431cb,0xb3882d64,0xb3f1a7d6,0x33a82ca5,0x33772dc2,0x333b2ed7,0x32f62fe3
.long 0xb2a7b072,0xb3b6ac44,0xb3fe2248,0xb3772dc2,0x32a73072,0x33f1a7d6,0x315fb1ed,0x1e48b3ff
.long 0xb2a7b072,0xb2f62fe3,0x224833fe,0x33502e7c,0x32a73072,0x30ecb24f,0xb1edb15f,0xb1cb3184
.long 0xb2a7b072,0xac4433b6,0x33fea248,0xadc2b377,0x32a73072,0xa7d6b3f1,0xb15f31ed,0x33ff1e48
.long 0xb2a7b072,0x2fe332f6,0xa248b3fe,0xae7c3350,0x32a73072,0xb24fb0ec,0x31ed315f,0xb184b1cb
.long 0xb2a7b072,0x33b62c44,0xb3fe2248,0x3377adc2,0x32a73072,0xb3f127d6,0x315fb1ed,0x9e4833ff
.long 0xb2a7b072,0x32f6afe3,0x224833fe,0xb350ae7c,0x32a73072,0xb0ec324f,0xb1edb15f,0x31cbb184
.long 0xb2a7b072,0x2c44b3b6,0x33fea248,0x2dc23377,0x32a73072,0x27d633f1,0xb15f31ed,0xb3ff9e48
.long 0xb2a7b072,0xafe3b2f6,0xa248b3fe,0x2e7cb350,0x32a73072,0x324f30ec,0x31ed315f,0x318431cb
.long 0xb22f3113,0xb04832c2,0xabc633c3,0x24b533fa,0xb113b22f,0xb3e2a979,0xb2dd301d,0xad053399
.long 0x322fb113,0xab03b3ce,0xb3c3abc6,0xb13a320f,0x3113322f,0x328ab09b,0xb01db2dd,0xb3252f32
.long 0xb22f3113,0x32c23048,0x2bc6b3c3,0xb3fa24b5,0xb113b22f,0xa97933e2,0x32ddb01d,0xb399ad05
.long 0x322fb113,0xb3ce2b03,0x33c32bc6,0xb20fb13a,0x3113322f,0xb09bb28a,0x301d32dd,0xaf32b325
.long 0xb22f3113,0x3048b2c2,0xabc633c3,0xa4b5b3fa,0xb113b22f,0x33e22979,0xb2dd301d,0x2d05b399
.long 0x322fb113,0x2b0333ce,0xb3c3abc6,0x313ab20f,0x3113322f,0xb28a309b,0xb01db2dd,0x3325af32
.long 0xb22f3113,0xb2c2b048,0x2bc6b3c3,0x33faa4b5,0xb113b22f,0x2979b3e2,0x32ddb01d,0x33992d05
.long 0x322fb113,0x33ceab03,0x33c32bc6,0x320f313a,0x3113322f,0x309b328a,0x301d32dd,0x2f323325
.long 0x3c003c01,0x3bf43bfc,0x291c0000,0x2fa62d1b,0x3bfa3c01,0x3bba3be2,0x2db10000,0x343931ac
.long 0x3bef3c01,0x3b553bb5,0x30690000,0x3672345e,0x3bde3c01,0x3ac73b74,0x31f60000,0x384435db
.long 0x3bc93c01,0x3a153b22,0x337f0000,0x3936374a,0x3baf3c01,0x39403abd,0x34820000,0x3a0c3853
.long 0x3b913c01,0x384e3a48,0x35420000,0x3ac138f7,0x3b6d3c01,0x368939c4,0x35fe0000,0x3b50398f
.long 0x3b453c01,0x34523932,0x36b70000,0x3bb63a19,0x3b193c01,0x30053892,0x376c0000,0x3bf23a93
.long 0x3ae83c01,0xa58137cf,0x380e0000,0x3c013afe,0x3ab33c01,0xb1613667,0x38630000,0x3be53b57
.long 0x3a7a3c01,0xb4fa34ee,0x38b60000,0x3b9d3b9f,0x3a3d3c01,0xb72832d4,0x39060000,0x3b2a3bd3
.long 0x39fc3c01,0xb8972f74,0x39530000,0x3a903bf4,0x39b73c01,0xb98124b8,0x399c0000,0x39d13c01
.long 0x3bda3be8,0x3bb33bc8,0x32593117,0x346a3398,0x3b3b3b82,0x3a813ae5,0x36e43595,0x38ac3813
.long 0x3a2d3ad1,0x388d396a,0x39193833,0x3a9739e7,0x38c039de,0x342136f0,0x3a723973,0x3bbd3b38
.long 0x361538b1,0xad4d30e5,0x3b693a7e,0x3bfb3bea,0x309a36ab,0xb6a0b081,0x3bed3b48,0x3b4b3bee
.long 0xae7a3367,0xb993b6c2,0x3bf83bcb,0x39c03b43,0xb57128b7,0xbb30b957,0x3b883c00,0x371239f7
.long 0xb878b117,0xbbf5bad8,0x3aa53be8,0x2f423829,0xb9f3b595,0xbbccbbc2,0x395c3b82,0xb34e33f9
.long 0xbb13b833,0xbababc00,0x37823ad1,0xb859a980,0xbbc6b973,0xb8debb8f,0x33b039de,0xba5cb54e
.long 0xbc01ba7e,0xb4e2ba76,0x9a4a38b1,0xbba1b8bb,0xbbc3bb48,0x2853b8cf,0xb3e136ab,0xbc00ba67
.long 0xbb0dbbcb,0x35e7b57d,0xb7983367,0xbb72bb86,0xb9ebbc00,0x3949ab13,0xb96528b7,0xba04bbff
.long 0x3c003c01,0x3bf43bfc,0x291c0000,0x2fa62d1b,0x3bfa3c01,0x3bba3be2,0x2db10000,0x343931ac
.long 0x3bef3c01,0x3b553bb5,0x30690000,0x3672345e,0x3bde3c01,0x3ac73b74,0x31f60000,0x384435db
.long 0x3bc93c01,0x3a153b22,0x337f0000,0x3936374a,0x3baf3c01,0x39403abd,0x34820000,0x3a0c3853
.long 0x3b913c01,0x384e3a48,0x35420000,0x3ac138f7,0x3b6d3c01,0x368939c4,0x35fe0000,0x3b50398f
.long 0x3b453c01,0x34523932,0x36b70000,0x3bb63a19,0x3b193c01,0x30053892,0x376c0000,0x3bf23a93
.long 0x3ae83c01,0xa58137cf,0x380e0000,0x3c013afe,0x3ab33c01,0xb1613667,0x38630000,0x3be53b57
.long 0x3a7a3c01,0xb4fa34ee,0x38b60000,0x3b9d3b9f,0x3a3d3c01,0xb72832d4,0x39060000,0x3b2a3bd3
.long 0x39fc3c01,0xb8972f74,0x39530000,0x3a903bf4,0x39b73c01,0xb98124b8,0x399c0000,0x39d13c01
.long 0x3bda3be8,0x3bb33bc8,0x32593117,0x346a3398,0x3b3b3b82,0x3a813ae5,0x36e43595,0x38ac3813
.long 0x3a2d3ad1,0x388d396a,0x39193833,0x3a9739e7,0x38c039de,0x342136f0,0x3a723973,0x3bbd3b38
.long 0x361538b1,0xad4d30e5,0x3b693a7e,0x3bfb3bea,0x309a36ab,0xb6a0b081,0x3bed3b48,0x3b4b3bee
.long 0xae7a3367,0xb993b6c2,0x3bf83bcb,0x39c03b43,0xb57128b7,0xbb30b957,0x3b883c00,0x371239f7
.long 0xb878b117,0xbbf5bad8,0x3aa53be8,0x2f423829,0xb9f3b595,0xbbccbbc2,0x395c3b82,0xb34e33f9
.long 0xbb13b833,0xbababc00,0x37823ad1,0xb859a980,0xbbc6b973,0xb8debb8f,0x33b039de,0xba5cb54e
.long 0xbc01ba7e,0xb4e2ba76,0x9a4a38b1,0xbba1b8bb,0xbbc3bb48,0x2853b8cf,0xb3e136ab,0xbc00ba67
.long 0xbb0dbbcb,0x35e7b57d,0xb7983367,0xbb72bb86,0xb9ebbc00,0x3949ab13,0xb96528b7,0xba04bbff
.long 0x3400,0x2d643388,0x3113322f,0x32dd301d,0x3400,0x315f31ed,0x33f62646,0x326db0c4
.long 0x3400,0x333b2ed7,0x322fb113,0xabc6b3c3,0x3400,0x33fe2248,0x2646b3f6,0xb3eaa8b2
.long 0x3400,0x3388ad64,0xb113b22f,0xb01d32dd,0x3400,0x31edb15f,0xb3f6a646,0x30c4326d
.long 0x3400,0x2ed7b33b,0xb22f3113,0x33c3abc6,0x3400,0x2248b3fe,0xa64633f6,0x28b2b3ea
.long 0x3400,0xad64b388,0x3113322f,0xb2ddb01d,0x3400,0xb15fb1ed,0x33f62646,0xb26d30c4
.long 0x3400,0xb33baed7,0x322fb113,0x2bc633c3,0x3400,0xb3fea248,0x2646b3f6,0x33ea28b2
.long 0x3400,0xb3882d64,0xb113b22f,0x301db2dd,0x3400,0xb1ed315f,0xb3f6a646,0xb0c4b26d
.long 0x3400,0xaed7333b,0xb22f3113,0xb3c32bc6,0x3400,0xa24833fe,0xa64633f6,0xa8b233ea
.long 0x33d92a3e,0x33eaa8b2,0x330eaf8b,0x315fb1ed,0x2a3eb3d9,0xb01db2dd,0xb3a8aca5,0xb33b2ed7
.long 0xb3d9aa3e,0xb0c4326d,0x2f8b330e,0x33fea248,0xaa3e33d9,0x33c32bc6,0x2ca5b3a8,0xb388ad64
.long 0x33d92a3e,0xa8b2b3ea,0xb30e2f8b,0x31ed315f,0x2a3eb3d9,0xb2dd301d,0x33a82ca5,0xaed7b33b
.long 0xb3d9aa3e,0x326d30c4,0xaf8bb30e,0x224833fe,0xaa3e33d9,0x2bc6b3c3,0xaca533a8,0x2d64b388
.long 0x33d92a3e,0xb3ea28b2,0x330eaf8b,0xb15f31ed,0x2a3eb3d9,0x301d32dd,0xb3a8aca5,0x333baed7
.long 0xb3d9aa3e,0x30c4b26d,0x2f8b330e,0xb3fe2248,0xaa3e33d9,0xb3c3abc6,0x2ca5b3a8,0x33882d64
.long 0x33d92a3e,0x28b233ea,0xb30e2f8b,0xb1edb15f,0x2a3eb3d9,0x32ddb01d,0x33a82ca5,0x2ed7333b
.long 0xb3d9aa3e,0xb26db0c4,0xaf8bb30e,0xa248b3fe,0xaa3e33d9,0xabc633c3,0xaca533a8,0xad643388
.long 0x2e1fb364,0x2248b3fe,0xaca5b3a8,0xb0c4b26d,0xae1f3364,0x2d643388,0x330e2f8b,0x33c3abc6
.long 0x2e1fb364,0xb15fb1ed,0xb3a82ca5,0xa8b233ea,0xae1f3364,0x333b2ed7,0x2f8bb30e,0xb2ddb01d
.long 0x2e1fb364,0xb3fea248,0x2ca533a8,0x326db0c4,0xae1f3364,0x3388ad64,0xb30eaf8b,0x2bc633c3
.long 0x2e1fb364,0xb1ed315f,0x33a8aca5,0xb3eaa8b2,0xae1f3364,0x2ed7b33b,0xaf8b330e,0x301db2dd
.long 0x2e1fb364,0xa24833fe,0xaca5b3a8,0x30c4326d,0xae1f3364,0xad64b388,0x330e2f8b,0xb3c32bc6
.long 0x2e1fb364,0x315f31ed,0xb3a82ca5,0x28b2b3ea,0xae1f3364,0xb33baed7,0x2f8bb30e,0x32dd301d
.long 0x2e1fb364,0x33fe2248,0x2ca533a8,0xb26d30c4,0xae1f3364,0xb3882d64,0xb30eaf8b,0xabc6b3c3
.long 0x2e1fb364,0x31edb15f,0x33a8aca5,0x33ea28b2,0xae1f3364,0xaed7333b,0xaf8b330e,0xb01d32dd
.long 0xb2a7b072,0xb3c3abc6,0xb3f62646,0xb33b2ed7,0x3072b2a7,0xa8b2b3ea,0xb22fb113,0xb3fe2248
.long 0x32a73072,0x32ddb01d,0xa646b3f6,0xb388ad64,0xb07232a7,0x326d30c4,0x3113b22f,0xb1edb15f
.long 0xb2a7b072,0xabc633c3,0x33f6a646,0xaed7b33b,0x3072b2a7,0xb3ea28b2,0x322f3113,0xa248b3fe
.long 0x32a73072,0xb01db2dd,0x264633f6,0x2d64b388,0xb07232a7,0x30c4b26d,0xb113322f,0x315fb1ed
.long 0xb2a7b072,0x33c32bc6,0xb3f62646,0x333baed7,0x3072b2a7,0x28b233ea,0xb22fb113,0x33fea248
.long 0x32a73072,0xb2dd301d,0xa646b3f6,0x33882d64,0xb07232a7,0xb26db0c4,0x3113b22f,0x31ed315f
.long 0xb2a7b072,0x2bc6b3c3,0x33f6a646,0x2ed7333b,0x3072b2a7,0x33eaa8b2,0x322f3113,0x224833fe
.long 0x32a73072,0x301d32dd,0x264633f6,0xad643388,0xb07232a7,0xb0c4326d,0xb113322f,0xb15f31ed
.long 0x34008000,0x3388ad64,0x322fb113,0x301db2dd,0x34008000,0x31edb15f,0x2646b3f6,0xb0c4b26d
.long 0x34008000,0x2ed7b33b,0xb113b22f,0xb3c32bc6,0x34008000,0x2248b3fe,0xb3f6a646,0xa8b233ea
.long 0x34008000,0xad64b388,0xb22f3113,0x32dd301d,0x34008000,0xb15fb1ed,0xa64633f6,0x326db0c4
.long 0x34008000,0xb33baed7,0x3113322f,0xabc6b3c3,0x34008000,0xb3fea248,0x33f62646,0xb3eaa8b2
.long 0x34008000,0xb3882d64,0x322fb113,0xb01d32dd,0x34008000,0xb1ed315f,0x2646b3f6,0x30c4326d
.long 0x34008000,0xaed7333b,0xb113b22f,0x33c3abc6,0x34008000,0xa24833fe,0xb3f6a646,0x28b2b3ea
.long 0x34008000,0x2d643388,0xb22f3113,0xb2ddb01d,0x34008000,0x315f31ed,0xa64633f6,0xb26d30c4
.long 0x34008000,0x333b2ed7,0x3113322f,0x2bc633c3,0x34008000,0x33fe2248,0x33f62646,0x33ea28b2
.long 0x2a3eb3d9,0xa8b2b3ea,0xaf8bb30e,0xb1edb15f,0xb3d9aa3e,0xb2dd301d,0xaca533a8,0x2ed7333b
.long 0xaa3e33d9,0x326d30c4,0x330eaf8b,0xa248b3fe,0x33d92a3e,0x2bc6b3c3,0xb3a8aca5,0xad643388
.long 0x2a3eb3d9,0xb3ea28b2,0x2f8b330e,0x315fb1ed,0xb3d9aa3e,0x301d32dd,0x2ca5b3a8,0xb33b2ed7
.long 0xaa3e33d9,0x30c4b26d,0xb30e2f8b,0x33fea248,0x33d92a3e,0xb3c3abc6,0x33a82ca5,0xb388ad64
.long 0x2a3eb3d9,0x28b233ea,0xaf8bb30e,0x31ed315f,0xb3d9aa3e,0x32ddb01d,0xaca533a8,0xaed7b33b
.long 0xaa3e33d9,0xb26db0c4,0x330eaf8b,0x224833fe,0x33d92a3e,0xabc633c3,0xb3a8aca5,0x2d64b388
.long 0x2a3eb3d9,0x33eaa8b2,0x2f8b330e,0xb15f31ed,0xb3d9aa3e,0xb01db2dd,0x2ca5b3a8,0x333baed7
.long 0xaa3e33d9,0xb0c4326d,0xb30e2f8b,0xb3fe2248,0x33d92a3e,0x33c32bc6,0x33a82ca5,0x33882d64
.long 0xb364ae1f,0xb3fea248,0xb3a82ca5,0xb26d30c4,0x33642e1f,0x3388ad64,0x2f8bb30e,0xabc6b3c3
.long 0xb364ae1f,0xb1ed315f,0x2ca533a8,0x33ea28b2,0x33642e1f,0x2ed7b33b,0xb30eaf8b,0xb01d32dd
.long 0xb364ae1f,0xa24833fe,0x33a8aca5,0xb0c4b26d,0x33642e1f,0xad64b388,0xaf8b330e,0x33c3abc6
.long 0xb364ae1f,0x315f31ed,0xaca5b3a8,0xa8b233ea,0x33642e1f,0xb33baed7,0x330e2f8b,0xb2ddb01d
.long 0xb364ae1f,0x33fe2248,0xb3a82ca5,0x326db0c4,0x33642e1f,0xb3882d64,0x2f8bb30e,0x2bc633c3
.long 0xb364ae1f,0x31edb15f,0x2ca533a8,0xb3eaa8b2,0x33642e1f,0xaed7333b,0xb30eaf8b,0x301db2dd
.long 0xb364ae1f,0x2248b3fe,0x33a8aca5,0x30c4326d,0x33642e1f,0x2d643388,0xaf8b330e,0xb3c32bc6
.long 0xb364ae1f,0xb15fb1ed,0xaca5b3a8,0x28b2b3ea,0x33642e1f,0x333b2ed7,0x330e2f8b,0x32dd301d
.long 0xb07232a7,0xabc633c3,0x264633f6,0x2ed7333b,0xb2a7b072,0xb3ea28b2,0xb113322f,0x224833fe
.long 0x3072b2a7,0xb01db2dd,0xb3f62646,0xad643388,0x32a73072,0x30c4b26d,0xb22fb113,0xb15f31ed
.long 0xb07232a7,0x33c32bc6,0xa646b3f6,0xb33b2ed7,0xb2a7b072,0x28b233ea,0x3113b22f,0xb3fe2248
.long 0x3072b2a7,0xb2dd301d,0x33f6a646,0xb388ad64,0x32a73072,0xb26db0c4,0x322f3113,0xb1edb15f
.long 0xb07232a7,0x2bc6b3c3,0x264633f6,0xaed7b33b,0xb2a7b072,0x33eaa8b2,0xb113322f,0xa248b3fe
.long 0x3072b2a7,0x301d32dd,0xb3f62646,0x2d64b388,0x32a73072,0xb0c4326d,0xb22fb113,0x315fb1ed
.long 0xb07232a7,0xb3c3abc6,0xa646b3f6,0x333baed7,0xb2a7b072,0xa8b2b3ea,0x3113b22f,0x33fea248
.long 0x3072b2a7,0x32ddb01d,0x33f6a646,0x33882d64,0x32a73072,0x326d30c4,0x322f3113,0x31ed315f
.long 0x3c003c01,0x3bf13bfb,0x29800000,0x301e2d7f,0x3bf93c01,0x3bb53be0,0x2de30000,0x345e31dd
.long 0x3bee3c01,0x3b4d3bb1,0x30810000,0x36953476,0x3bdd3c01,0x3abd3b70,0x320e0000,0x385335f3
.long 0x3bc83c01,0x3a083b1c,0x33980000,0x39453760,0x3bad3c01,0x39323ab6,0x348e0000,0x3a19385e
.long 0x3b8f3c01,0x383e3a41,0x354e0000,0x3acb3901,0x3b6b3c01,0x366739bb,0x360a0000,0x3b573998
.long 0x3b433c01,0x342d3928,0x36c20000,0x3bbb3a21,0x3b163c01,0x2f743888,0x37770000,0x3bf43a9b
.long 0x3ae53c01,0xa7dc37b9,0x38130000,0x3c013b04,0x3ab03c01,0xb1ac364f,0x38690000,0x3be23b5c
.long 0x3a763c01,0xb51e34d6,0x38bb0000,0x3b973ba2,0x3a393c01,0xb74a32a2,0x390b0000,0x3b223bd6
.long 0x39f73c01,0xb8a72f10,0x39570000,0x3a853bf6,0x39b33c01,0xb98f224a,0x39a10000,0x39c43c01
.long 0x3bd33be4,0x3ba63bbe,0x32d4317a,0x34be3415,0x3b2d3b79,0x3a673ad1,0x371d35c4,0x38cf3833
.long 0x3a193ac4,0x3869394e,0x39323849,0x3ab03a00,0x38a739cd,0x339836ab,0x3a853986,0x3bc83b48
.long 0x35db389d,0xaeac3050,0x3b743a8c,0x3bf73bf0,0x301e367e,0xb6f0b117,0x3bf13b52,0x3b383be8
.long 0xaf743305,0xb9b3b706,0x3bf43bd0,0x39a13b32,0xb5ac264a,0xbb43b973,0x3b7d3c01,0x36c239de
.long 0xb892b17a,0xbbf9baeb,0x3a933be4,0x2de33808,0xba08b5c4,0xbbc2bbcb,0x39453b79,0xb3f93367
.long 0xbb22b849,0xbaa2bbfe,0x374a3ac4,0xb87dabdb,0xbbceb986,0xb8bbbb82,0x333639cd,0xba76b595
.long 0xbc01ba8c,0xb48eba60,0xa4b8389d,0xbbadb8d9,0xbbbbbb52,0x2b13b8b1,0xb42d367e,0xbbffba7e
.long 0xbafebbd0,0x3638b536,0xb7cf3305,0xbb61bb93,0xb9d5bc01,0x396aa8b7,0xb97d264a,0xb9e7bc00
.long 0x3c003c01,0x3bf13bfb,0x29800000,0x301e2d7f,0x3bf93c01,0x3bb53be0,0x2de30000,0x345e31dd
.long 0x3bee3c01,0x3b4d3bb1,0x30810000,0x36953476,0x3bdd3c01,0x3abd3b70,0x320e0000,0x385335f3
.long 0x3bc83c01,0x3a083b1c,0x33980000,0x39453760,0x3bad3c01,0x39323ab6,0x348e0000,0x3a19385e
.long 0x3b8f3c01,0x383e3a41,0x354e0000,0x3acb3901,0x3b6b3c01,0x366739bb,0x360a0000,0x3b573998
.long 0x3b433c01,0x342d3928,0x36c20000,0x3bbb3a21,0x3b163c01,0x2f743888,0x37770000,0x3bf43a9b
.long 0x3ae53c01,0xa7dc37b9,0x38130000,0x3c013b04,0x3ab03c01,0xb1ac364f,0x38690000,0x3be23b5c
.long 0x3a763c01,0xb51e34d6,0x38bb0000,0x3b973ba2,0x3a393c01,0xb74a32a2,0x390b0000,0x3b223bd6
.long 0x39f73c01,0xb8a72f10,0x39570000,0x3a853bf6,0x39b33c01,0xb98f224a,0x39a10000,0x39c43c01
.long 0x3bd33be4,0x3ba63bbe,0x32d4317a,0x34be3415,0x3b2d3b79,0x3a673ad1,0x371d35c4,0x38cf3833
.long 0x3a193ac4,0x3869394e,0x39323849,0x3ab03a00,0x38a739cd,0x339836ab,0x3a853986,0x3bc83b48
.long 0x35db389d,0xaeac3050,0x3b743a8c,0x3bf73bf0,0x301e367e,0xb6f0b117,0x3bf13b52,0x3b383be8
.long 0xaf743305,0xb9b3b706,0x3bf43bd0,0x39a13b32,0xb5ac264a,0xbb43b973,0x3b7d3c01,0x36c239de
.long 0xb892b17a,0xbbf9baeb,0x3a933be4,0x2de33808,0xba08b5c4,0xbbc2bbcb,0x39453b79,0xb3f93367
.long 0xbb22b849,0xbaa2bbfe,0x374a3ac4,0xb87dabdb,0xbbceb986,0xb8bbbb82,0x333639cd,0xba76b595
.long 0xbc01ba8c,0xb48eba60,0xa4b8389d,0xbbadb8d9,0xbbbbbb52,0x2b13b8b1,0xb42d367e,0xbbffba7e
.long 0xbafebbd0,0x3638b536,0xb7cf3305,0xbb61bb93,0xb9d5bc01,0x396aa8b7,0xb97d264a,0xb9e7bc00
.long 0x3400,0x2dc23377,0x315f31ed,0x33252f32,0x3400,0x318431cb,0x33fe2248,0x320fb13a
.long 0x3400,0x33502e7c,0x31edb15f,0xad05b399,0x3400,0x33ff1e48,0x2248b3fe,0xb3faa4b5
.long 0x3400,0x3377adc2,0xb15fb1ed,0xaf323325,0x3400,0x31cbb184,0xb3fea248,0x313a320f
.long 0x3400,0x2e7cb350,0xb1ed315f,0x3399ad05,0x3400,0x1e48b3ff,0xa24833fe,0x24b5b3fa
.long 0x3400,0xadc2b377,0x315f31ed,0xb325af32,0x3400,0xb184b1cb,0x33fe2248,0xb20f313a
.long 0x3400,0xb350ae7c,0x31edb15f,0x2d053399,0x3400,0xb3ff9e48,0x2248b3fe,0x33fa24b5
.long 0x3400,0xb3772dc2,0xb15fb1ed,0x2f32b325,0x3400,0xb1cb3184,0xb3fea248,0xb13ab20f
.long 0x3400,0xae7c3350,0xb1ed315f,0xb3992d05,0x3400,0x9e4833ff,0xa24833fe,0xa4b533fa
.long 0x33f62646,0x33b6ac44,0x326db0c4,0x3048b2c2,0x2646b3f6,0xb0ecb24f,0xb3eaa8b2,0xb28a309b
.long 0xb3f6a646,0xafe332f6,0x30c4326d,0x33ceab03,0xa64633f6,0x33f127d6,0x28b2b3ea,0xb3e2a979
.long 0x33f62646,0xac44b3b6,0xb26d30c4,0x32c23048,0x2646b3f6,0xb24f30ec,0x33ea28b2,0xb09bb28a
.long 0xb3f6a646,0x32f62fe3,0xb0c4b26d,0x2b0333ce,0xa64633f6,0x27d6b3f1,0xa8b233ea,0x2979b3e2
.long 0x33f62646,0xb3b62c44,0x326db0c4,0xb04832c2,0x2646b3f6,0x30ec324f,0xb3eaa8b2,0x328ab09b
.long 0xb3f6a646,0x2fe3b2f6,0x30c4326d,0xb3ce2b03,0xa64633f6,0xb3f1a7d6,0x28b2b3ea,0x33e22979
.long 0x33f62646,0x2c4433b6,0xb26d30c4,0xb2c2b048,0x2646b3f6,0x324fb0ec,0x33ea28b2,0x309b328a
.long 0xb3f6a646,0xb2f6afe3,0xb0c4b26d,0xab03b3ce,0xa64633f6,0xa7d633f1,0xa8b233ea,0xa97933e2
.long 0x2a3eb3d9,0xa979b3e2,0xb01db2dd,0xb24fb0ec,0xaa3e33d9,0x304832c2,0x33c32bc6,0x32f6afe3
.long 0x2a3eb3d9,0xb28ab09b,0xb2dd301d,0x27d633f1,0xaa3e33d9,0x33ce2b03,0x2bc6b3c3,0xb3b6ac44
.long 0x2a3eb3d9,0xb3e22979,0x301d32dd,0x30ecb24f,0xaa3e33d9,0x32c2b048,0xb3c3abc6,0x2fe332f6
.long 0x2a3eb3d9,0xb09b328a,0x32ddb01d,0xb3f127d6,0xaa3e33d9,0x2b03b3ce,0xabc633c3,0x2c44b3b6
.long 0x2a3eb3d9,0x297933e2,0xb01db2dd,0x324f30ec,0xaa3e33d9,0xb048b2c2,0x33c32bc6,0xb2f62fe3
.long 0x2a3eb3d9,0x328a309b,0xb2dd301d,0xa7d6b3f1,0xaa3e33d9,0xb3ceab03,0x2bc6b3c3,0x33b62c44
.long 0x2a3eb3d9,0x33e2a979,0x301d32dd,0xb0ec324f,0xaa3e33d9,0xb2c23048,0xb3c3abc6,0xafe3b2f6
.long 0x2a3eb3d9,0x309bb28a,0x32ddb01d,0x33f1a7d6,0xaa3e33d9,0xab0333ce,0xabc633c3,0xac4433b6
.long 0xb3a8aca5,0xb3fa24b5,0xb33b2ed7,0xb18431cb,0x2ca5b3a8,0xaf32b325,0xb388ad64,0xb3502e7c
.long 0x33a82ca5,0x313ab20f,0xaed7b33b,0xb3ff1e48,0xaca533a8,0x33992d05,0x2d64b388,0xb377adc2
.long 0xb3a8aca5,0x24b533fa,0x333baed7,0xb1cbb184,0x2ca5b3a8,0xb3252f32,0x33882d64,0xae7cb350
.long 0x33a82ca5,0xb20fb13a,0x2ed7333b,0x9e48b3ff,0xaca533a8,0x2d05b399,0xad643388,0x2dc2b377
.long 0xb3a8aca5,0x33faa4b5,0xb33b2ed7,0x3184b1cb,0x2ca5b3a8,0x2f323325,0xb388ad64,0x3350ae7c
.long 0x33a82ca5,0xb13a320f,0xaed7b33b,0x33ff9e48,0xaca533a8,0xb399ad05,0x2d64b388,0x33772dc2
.long 0xb3a8aca5,0xa4b5b3fa,0x333baed7,0x31cb3184,0x2ca5b3a8,0x3325af32,0x33882d64,0x2e7c3350
.long 0x33a82ca5,0x320f313a,0x2ed7333b,0x1e4833ff,0xaca533a8,0xad053399,0xad643388,0xadc23377
.long 0x34008000,0x3377adc2,0x31edb15f,0x2f32b325,0x34008000,0x31cbb184,0x2248b3fe,0xb13ab20f
.long 0x34008000,0x2e7cb350,0xb15fb1ed,0xb3992d05,0x34008000,0x1e48b3ff,0xb3fea248,0xa4b533fa
.long 0x34008000,0xadc2b377,0xb1ed315f,0x33252f32,0x34008000,0xb184b1cb,0xa24833fe,0x320fb13a
.long 0x34008000,0xb350ae7c,0x315f31ed,0xad05b399,0x34008000,0xb3ff9e48,0x33fe2248,0xb3faa4b5
.long 0x34008000,0xb3772dc2,0x31edb15f,0xaf323325,0x34008000,0xb1cb3184,0x2248b3fe,0x313a320f
.long 0x34008000,0xae7c3350,0xb15fb1ed,0x3399ad05,0x34008000,0x9e4833ff,0xb3fea248,0x24b5b3fa
.long 0x34008000,0x2dc23377,0xb1ed315f,0xb325af32,0x34008000,0x318431cb,0xa24833fe,0xb20f313a
.long 0x34008000,0x33502e7c,0x315f31ed,0x2d053399,0x34008000,0x33ff1e48,0x33fe2248,0x33fa24b5
.long 0x2646b3f6,0xac44b3b6,0xb0c4b26d,0xb2c2b048,0xb3f6a646,0xb24f30ec,0xa8b233ea,0x309b328a
.long 0xa64633f6,0x32f62fe3,0x326db0c4,0xab03b3ce,0x33f62646,0x27d6b3f1,0xb3eaa8b2,0xa97933e2
.long 0x2646b3f6,0xb3b62c44,0x30c4326d,0x3048b2c2,0xb3f6a646,0x30ec324f,0x28b2b3ea,0xb28a309b
.long 0xa64633f6,0x2fe3b2f6,0xb26d30c4,0x33ceab03,0x33f62646,0xb3f1a7d6,0x33ea28b2,0xb3e2a979
.long 0x2646b3f6,0x2c4433b6,0xb0c4b26d,0x32c23048,0xb3f6a646,0x324fb0ec,0xa8b233ea,0xb09bb28a
.long 0xa64633f6,0xb2f6afe3,0x326db0c4,0x2b0333ce,0x33f62646,0xa7d633f1,0xb3eaa8b2,0x2979b3e2
.long 0x2646b3f6,0x33b6ac44,0x30c4326d,0xb04832c2,0xb3f6a646,0xb0ecb24f,0x28b2b3ea,0x328ab09b
.long 0xa64633f6,0xafe332f6,0xb26d30c4,0xb3ce2b03,0x33f62646,0x33f127d6,0x33ea28b2,0x33e22979
.long 0xb3d9aa3e,0xb3e22979,0xb2dd301d,0xb0ec324f,0x33d92a3e,0x32c2b048,0x2bc6b3c3,0xafe3b2f6
.long 0xb3d9aa3e,0xb09b328a,0x301d32dd,0x33f1a7d6,0x33d92a3e,0x2b03b3ce,0xb3c3abc6,0xac4433b6
.long 0xb3d9aa3e,0x297933e2,0x32ddb01d,0xb24fb0ec,0x33d92a3e,0xb048b2c2,0xabc633c3,0x32f6afe3
.long 0xb3d9aa3e,0x328a309b,0xb01db2dd,0x27d633f1,0x33d92a3e,0xb3ceab03,0x33c32bc6,0xb3b6ac44
.long 0xb3d9aa3e,0x33e2a979,0xb2dd301d,0x30ecb24f,0x33d92a3e,0xb2c23048,0x2bc6b3c3,0x2fe332f6
.long 0xb3d9aa3e,0x309bb28a,0x301d32dd,0xb3f127d6,0x33d92a3e,0xab0333ce,0xb3c3abc6,0x2c44b3b6
.long 0xb3d9aa3e,0xa979b3e2,0x32ddb01d,0x324f30ec,0x33d92a3e,0x304832c2,0xabc633c3,0xb2f62fe3
.long 0xb3d9aa3e,0xb28ab09b,0xb01db2dd,0xa7d6b3f1,0x33d92a3e,0x33ce2b03,0x33c32bc6,0x33b62c44
.long 0xaca533a8,0x24b533fa,0x2ed7333b,0x31cb3184,0xb3a8aca5,0xb3252f32,0xad643388,0x2e7c3350
.long 0x2ca5b3a8,0xb20fb13a,0xb33b2ed7,0x1e4833ff,0x33a82ca5,0x2d05b399,0xb388ad64,0xadc23377
.long 0xaca533a8,0x33faa4b5,0xaed7b33b,0xb18431cb,0xb3a8aca5,0x2f323325,0x2d64b388,0xb3502e7c
.long 0x2ca5b3a8,0xb13a320f,0x333baed7,0xb3ff1e48,0x33a82ca5,0xb399ad05,0x33882d64,0xb377adc2
.long 0xaca533a8,0xa4b5b3fa,0x2ed7333b,0xb1cbb184,0xb3a8aca5,0x3325af32,0xad643388,0xae7cb350
.long 0x2ca5b3a8,0x320f313a,0xb33b2ed7,0x9e48b3ff,0x33a82ca5,0xad053399,0xb388ad64,0x2dc2b377
.long 0xaca533a8,0xb3fa24b5,0xaed7b33b,0x3184b1cb,0xb3a8aca5,0xaf32b325,0x2d64b388,0x3350ae7c
.long 0x2ca5b3a8,0x313ab20f,0x333baed7,0x33ff9e48,0x33a82ca5,0x33992d05,0x33882d64,0x33772dc2
.long 0x3c003c01,0x3bef3bf9,0x29e50000,0x30692de3,0x3bf93c01,0x3baf3bdd,0x2e160000,0x3482320e
.long 0x3bed3c01,0x3b453bad,0x309a0000,0x36b7348e,0x3bdc3c01,0x3ab33b6b,0x32270000,0x3863360a
.long 0x3bc63c01,0x39fc3b16,0x33b00000,0x39533777,0x3bac3c01,0x39233ab0,0x349a0000,0x3a253869
.long 0x3b8c3c01,0x382e3a39,0x355a0000,0x3ad5390b,0x3b693c01,0x364439b3,0x36150000,0x3b5f39a1
.long 0x3b403c01,0x3409391e,0x36ce0000,0x3bc03a29,0x3b133c01,0x2ede387d,0x37820000,0x3bf63aa2
.long 0x3ae23c01,0xa91c37a3,0x38190000,0x3c003b0a,0x3aac3c01,0xb1f63638,0x386e0000,0x3bde3b61
.long 0x3a723c01,0xb54234be,0x38c00000,0x3b913ba6,0x3a353c01,0xb76c3271,0x39100000,0x3b193bd8
.long 0x39f33c01,0xb8b62eac,0x395c0000,0x3a7a3bf7,0x39ae3c01,0xb99c1e4a,0x39a50000,0x39b73c01
.long 0x3bcc3be0,0x3b993bb5,0x334e31dd,0x3512345e,0x3b1f3b70,0x3a4c3abd,0x375535f3,0x38f23853
.long 0x3a043ab6,0x38443932,0x3949385e,0x3ac73a19,0x388d39bb,0x32ec3667,0x3a973998,0x3bd23b57
.long 0x35a03888,0xb0052f74,0x3b7f3a9b,0x3bf23bf4,0x2f42364f,0xb73fb1ac,0x3bf53b5c,0x3b243be2
.long 0xb03732a2,0xb9d1b74a,0x3bf03bd6,0x39813b22,0xb5e7224a,0xbb55b98f,0x3b723c01,0x367239c4
.long 0xb8acb1dd,0xbbfdbafe,0x3a813be0,0x2c8437cf,0xba1db5f3,0xbbb6bbd3,0x392d3b70,0xb45232d4
.long 0xbb30b85e,0xba89bbfc,0x37123ab6,0xb8a2ad1b,0xbbd4b998,0xb897bb74,0x32bb39bb,0xba90b5db
.long 0xbc00ba9b,0xb439ba48,0xa8533888,0xbbbab8f7,0xbbb3bb5c,0x2ce9b892,0xb46a364f,0xbbfcba93
.long 0xbaeebbd6,0x3689b4ee,0xb80332a2,0xbb50bb9f,0xb9c0bc01,0x398aa4b8,0xb993224a,0xb9c8bc01
.long 0x3c003c01,0x3bef3bf9,0x29e50000,0x30692de3,0x3bf93c01,0x3baf3bdd,0x2e160000,0x3482320e
.long 0x3bed3c01,0x3b453bad,0x309a0000,0x36b7348e,0x3bdc3c01,0x3ab33b6b,0x32270000,0x3863360a
.long 0x3bc63c01,0x39fc3b16,0x33b00000,0x39533777,0x3bac3c01,0x39233ab0,0x349a0000,0x3a253869
.long 0x3b8c3c01,0x382e3a39,0x355a0000,0x3ad5390b,0x3b693c01,0x364439b3,0x36150000,0x3b5f39a1
.long 0x3b403c01,0x3409391e,0x36ce0000,0x3bc03a29,0x3b133c01,0x2ede387d,0x37820000,0x3bf63aa2
.long 0x3ae23c01,0xa91c37a3,0x38190000,0x3c003b0a,0x3aac3c01,0xb1f63638,0x386e0000,0x3bde3b61
.long 0x3a723c01,0xb54234be,0x38c00000,0x3b913ba6,0x3a353c01,0xb76c3271,0x39100000,0x3b193bd8
.long 0x39f33c01,0xb8b62eac,0x395c0000,0x3a7a3bf7,0x39ae3c01,0xb99c1e4a,0x39a50000,0x39b73c01
.long 0x3bcc3be0,0x3b993bb5,0x334e31dd,0x3512345e,0x3b1f3b70,0x3a4c3abd,0x375535f3,0x38f23853
.long 0x3a043ab6,0x38443932,0x3949385e,0x3ac73a19,0x388d39bb,0x32ec3667,0x3a973998,0x3bd23b57
.long 0x35a03888,0xb0052f74,0x3b7f3a9b,0x3bf23bf4,0x2f42364f,0xb73fb1ac,0x3bf53b5c,0x3b243be2
.long 0xb03732a2,0xb9d1b74a,0x3bf03bd6,0x39813b22,0xb5e7224a,0xbb55b98f,0x3b723c01,0x367239c4
.long 0xb8acb1dd,0xbbfdbafe,0x3a813be0,0x2c8437cf,0xba1db5f3,0xbbb6bbd3,0x392d3b70,0xb45232d4
.long 0xbb30b85e,0xba89bbfc,0x37123ab6,0xb8a2ad1b,0xbbd4b998,0xb897bb74,0x32bb39bb,0xba90b5db
.long 0xbc00ba9b,0xb439ba48,0xa8533888,0xbbbab8f7,0xbbb3bb5c,0x2ce9b892,0xb46a364f,0xbbfcba93
.long 0xbaeebbd6,0x3689b4ee,0xb80332a2,0xbb50bb9f,0xb9c0bc01,0x398aa4b8,0xb993224a,0xb9c8bc01
.size T_fft, 59392
.section .rodata,"a"
.p2align 6
.amdhsa_kernel parallel_sum__spectral_fnet__moe_arch_mod__prompt_kernel
  .amdhsa_next_free_vgpr 124
  .amdhsa_next_free_sgpr 102
  .amdhsa_accum_offset 124
  .amdhsa_group_segment_fixed_size 0
  .amdhsa_kernarg_size 104
  .amdhsa_user_sgpr_count 2
  .amdhsa_user_sgpr_kernarg_segment_ptr 1
  .amdhsa_system_sgpr_workgroup_id_x 1
.end_amdhsa_kernel
```
